```python
import torch

def _softmax(x, axis=-1):
    return torch.softmax(x, dim=axis)
def _gelu(x):
    return torch.nn.functional.gelu(x, approximate="tanh")
def _silu(x):
    return torch.nn.functional.silu(x)
def _sigmoid(x):
    return torch.sigmoid(x)
def _layernorm(x, axis=-1, eps=1e-5):
    m = x.mean(dim=axis, keepdim=True)
    v = x.var(dim=axis, keepdim=True, unbiased=False)
    return (x - m) / torch.sqrt(v + eps)
def _scatter_add(tgt, idx, src, axis=0):
    return tgt.clone().index_add_(axis, idx, src)
def _segment_sum(src, seg, n):
    out = torch.zeros((n,) + src.shape[1:], dtype=src.dtype)
    return out.index_add_(0, seg, src)
def _pad(x, pw):
    flat = tuple(v for pair in reversed(pw) for v in pair)
    return torch.nn.functional.pad(x, flat)

kernel_name = 'recurrent_scan__linear_attn_block__dense_activation_silu__prompt'

def setup_inputs():

    _w = (lambda a: (lambda t: t.to(torch.bfloat16) if t.is_floating_point() else t)(torch.as_tensor(a)))
    def _A_setup():
        B, S, D = 1, 2048, 640
        return {
            "x": _w((lambda *s: torch.randn(*s, dtype=torch.bfloat16) * 0.05)(B, S, D)),
            "wqkv": _w((lambda *s: torch.randn(*s, dtype=torch.bfloat16) * 0.2)(D, 3 * D)),
            "wo": _w((lambda *s: torch.randn(*s, dtype=torch.bfloat16) * 0.2)(D, D)),
        }
    _A_in = _A_setup()

    def _B_setup():
        B, S, D, F = 1, 2048, 640, 1728
        return {
            "x": _w((lambda *s: torch.randn(*s, dtype=torch.bfloat16) * 0.05)(B, S, D)),
            "w1": _w((lambda *s: torch.randn(*s, dtype=torch.bfloat16) * 0.8)(D, F) * (D ** -0.5)),
            "w2": _w((lambda *s: torch.randn(*s, dtype=torch.bfloat16) * 0.1)(F, D) * (F ** -0.5)),
        }
    _B_in = _B_setup()

    return {
        "A_x": _A_in["x"],
        "A_wqkv": _A_in["wqkv"],
        "A_wo": _A_in["wo"],
        "B_x": _B_in["x"],
        "B_w1": _B_in["w1"],
        "B_w2": _B_in["w2"],
    }

def reference(A_x, A_wqkv, A_wo, B_x, B_w1, B_w2):
    def _A_ref(x, wqkv, wo):
        B, S, D = x.shape
        H = 32; Dh = D // H
        qkv = (lambda x, *d: x.permute(*d))((x @ wqkv).reshape(B, S, 3, H, Dh), 2, 0, 3, 1, 4)
        q, k, v = qkv[0], qkv[1], qkv[2]
        phi = lambda t: torch.where(t > 0, t + 1, torch.exp(t)) + 1e-6
        pq, pk = phi(q), phi(k)
        kv = torch.einsum("bhsd,bhse->bhde", pk, v)
        z = torch.einsum("bhsd->bhd", pk)
        num = torch.einsum("bhqd,bhde->bhqe", pq, kv)
        den = torch.einsum("bhqd,bhd->bhq", pq, z)[..., None] + 1e-6
        o = num / den
        return (lambda x, *d: x.permute(*d))(o, 0, 2, 1, 3).reshape(B, S, D) @ wo

    def _B_ref(x, w1, w2):
        h = torch.einsum("bsd,df->bsf", x, w1)
        h = _silu(h)
        out = torch.einsum("bsf,fd->bsd", h, w2)
        return out

    x = A_x
    xn = _layernorm(x, axis=-1)
    s = _A_ref(xn, A_wqkv, A_wo)
    g = _silu(_B_ref(xn, B_w1, B_w2))
    return x + s * g
```

```asm
; @launch grid=(256,1,1) block=(256,1,1) lds=163840
.amdgcn_target "amdgcn-amd-amdhsa--gfx950"
.text
.globl recurrent_scan__linear_attn_block__dense_activation_silu__prompt_kernel
.p2align 8
.type recurrent_scan__linear_attn_block__dense_activation_silu__prompt_kernel,@function
recurrent_scan__linear_attn_block__dense_activation_silu__prompt_kernel:
  s_load_dwordx16 s[60:75], s[0:1], 0
  s_load_dwordx2 s[26:27], s[0:1], 64
  s_cmp_ge_u32 s2, 256
  s_cbranch_scc1 k_end
  s_getpc_b64 s[36:37]
  s_cmp_ge_u32 s2, 16
  s_cbranch_scc1 k_nocp0
  s_lshr_b32 s3, s2, 3
  s_lshl_b32 s3, s3, 12
  v_lshl_add_u32 v1, v0, 4, s3
  global_load_dwordx4 v[132:135], v1, s[36:37] offset:0
k_nocp0:
  s_and_b32 s3, s2, 7
  s_lshl_b32 s3, s3, 5
  s_lshr_b32 s21, s2, 3
  s_add_u32 s3, s3, s21
  s_mul_i32 s35, s2, 10240
  v_lshrrev_b32 v1, 5, v0
  v_mul_u32_u24 v1, 768, v1
  v_lshl_add_u32 v52, v0, 4, v1
  v_and_b32 v1, 16, v0
  v_lshl_add_u32 v53, v1, 26, v52
  s_mov_b32 s10, 2621440
  s_mov_b32 s11, 0x20000
  s_getpc_b64 s[36:37]
  v_cmp_eq_u32 s[32:33], 0, v1
  v_lshrrev_b32 v1, 6, v0
  v_and_b32 v7, 63, v0
  v_readfirstlane_b32 s20, v1
  s_lshr_b32 s23, s3, 5
  s_min_u32 s23, s23, 2
  s_sub_u32 s23, s3, s23
  s_cmp_lt_u32 s3, 118
  s_cselect_b32 s28, 1, 116
  s_mov_b32 s29, 10923
  s_cselect_b32 s29, 13108, s29
  s_cselect_b32 s30, 5, 6
  s_cselect_b32 s31, 0, 5
  s_sub_u32 s28, s23, s28
  s_mul_i32 s22, s28, s29
  s_lshr_b32 s22, s22, 16
  s_mul_i32 s30, s22, s30
  s_sub_u32 s21, s28, s30
  s_add_u32 s21, s21, s31
  s_cmp_lt_u32 s2, 3
  s_cselect_b32 s21, 11, s21
  s_min_u32 s54, s21, 9
  s_sub_u32 s28, 22, s22
  s_cmp_lt_u32 s3, 118
  s_cselect_b32 s22, s22, s28
  s_mul_i32 s28, s22, 43
  s_lshr_b32 s28, s28, 8
  s_mul_i32 s29, s28, 6
  s_sub_u32 s29, s22, s29
  s_mul_i32 s30, s28, 3
  s_add_u32 s30, s30, s29
  s_add_u32 s30, s30, 9
  s_lshl_b32 s31, s28, 1
  s_add_u32 s31, s31, s29
  s_sub_u32 s31, s31, 1
  s_add_u32 s28, s28, 8
  s_cmp_lt_u32 s29, 3
  s_cselect_b32 s22, s31, s30
  s_cmp_eq_u32 s29, 0
  s_cselect_b32 s22, s28, s22
  s_cmp_lt_u32 s2, 3
  s_cselect_b32 s22, 12, s22
  s_waitcnt lgkmcnt(0)
  s_mov_b32 s8, s60
  s_and_b32 s9, s61, 0xffff
  buffer_load_dwordx4 v[8:11], v52, s[8:11], s35 offen offset:0
  buffer_load_dwordx4 v[12:15], v52, s[8:11], s35 offen offset:512
  buffer_load_dwordx4 v[16:19], v53, s[8:11], s35 offen offset:1024
  s_lshl_b32 s28, s21, 2
  s_add_u32 s28, s28, s20
  s_mul_i32 s28, s28, 61440
  v_lshrrev_b32 v1, 3, v7
  v_lshrrev_b32 v2, 1, v1
  v_and_b32 v3, 7, v7
  v_xor_b32 v2, v2, v3
  v_mul_u32_u24 v1, 1280, v1
  v_lshl_add_u32 v252, v3, 4, v1
  v_add_u32 v1, s28, v1
  v_lshl_add_u32 v236, v2, 4, v1
  v_xor_b32 v2, 4, v2
  v_lshl_add_u32 v6, v2, 4, v1
  v_add_u32 v237, 9216, v6
  v_add_u32 v238, 18432, v236
  v_add_u32 v239, 27648, v6
  v_add_u32 v240, 40960, v236
  v_add_u32 v241, 50176, v6
  s_mul_i32 s40, s20, 6144
  s_lshl_b32 s42, s54, 7
  s_add_u32 m0, s40, 0
  s_nop 0
  buffer_load_dwordx4 v236, s[8:11], s42 offen offset:0 lds
  buffer_load_dwordx4 v237, s[8:11], s42 offen offset:1024 lds
  buffer_load_dwordx4 v238, s[8:11], s42 offen offset:2048 lds
  buffer_load_dwordx4 v239, s[8:11], s42 offen offset:3072 lds
  s_add_u32 m0, s40, 4096
  s_nop 0
  buffer_load_dwordx4 v240, s[8:11], s42 offen offset:0 lds
  buffer_load_dwordx4 v241, s[8:11], s42 offen offset:1024 lds
  s_cmp_lt_u32 s22, 12
  s_cselect_b32 s12, s62, s68
  s_cselect_b32 s13, s63, s69
  s_mov_b32 s14, 2211840
  s_cselect_b32 s14, 2457600, s14
  s_mov_b32 s50, 3456
  s_cselect_b32 s50, 3840, s50
  s_cselect_b32 s28, 8, 12
  s_and_b32 s13, s13, 0xffff
  s_mov_b32 s15, 0x20000
  s_lshl_b32 s45, s50, 6
  s_sub_u32 s23, s22, s28
  s_mul_i32 s29, s23, 320
  s_mul_i32 s30, s22, 160
  s_add_u32 s30, s30, 1280
  s_cmp_lt_u32 s22, 8
  s_cselect_b32 s29, s30, s29
  s_cselect_b32 s30, 1200, 0
  s_cselect_b32 s31, -80, 0
  s_lshl_b32 s28, s20, 4
  s_mul_i32 s28, s28, s50
  s_add_u32 s29, s29, s28
  s_mul_i32 s41, s20, 5120
  s_add_u32 s41, s41, 24576
  s_mul_i32 s43, s54, s45
  s_movk_i32 s28, -20
  v_xor_b32 v54, 2, v7
  v_lshrrev_b32 v55, 4, v7
  v_and_b32 v55, 2, v55
  v_xor_b32 v55, v55, v7
  v_mul_u32_u24 v2, 3277, v7
  v_lshrrev_b32 v2, 16, v2
  v_mad_i32_i24 v3, v2, s28, v7
  v_mul_u32_u24 v2, s50, v2
  v_lshl_add_u32 v2, v3, 4, v2
  v_mul_u32_u24 v3, 205, v3
  v_bfe_u32 v1, v3, 10, 1
  v_lshrrev_b32 v3, 11, v3
  v_mad_u32_u24 v2, v1, s30, v2
  v_mad_i32_i24 v2, v3, s31, v2
  v_add_u32 v242, s29, v2
  s_sub_u32 s29, s29, 1024
  v_add_u32 v1, 64, v7
  v_mul_u32_u24 v2, 3277, v1
  v_lshrrev_b32 v2, 16, v2
  v_mad_i32_i24 v3, v2, s28, v1
  v_mul_u32_u24 v2, s50, v2
  v_lshl_add_u32 v2, v3, 4, v2
  v_mul_u32_u24 v3, 205, v3
  v_bfe_u32 v1, v3, 10, 1
  v_lshrrev_b32 v3, 11, v3
  v_mad_u32_u24 v2, v1, s30, v2
  v_mad_i32_i24 v2, v3, s31, v2
  v_add_u32 v243, s29, v2
  s_sub_u32 s29, s29, 1024
  v_add_u32 v1, 128, v55
  v_mul_u32_u24 v2, 3277, v1
  v_lshrrev_b32 v2, 16, v2
  v_mad_i32_i24 v3, v2, s28, v1
  v_mul_u32_u24 v2, s50, v2
  v_lshl_add_u32 v2, v3, 4, v2
  v_mul_u32_u24 v3, 205, v3
  v_bfe_u32 v1, v3, 10, 1
  v_lshrrev_b32 v3, 11, v3
  v_mad_u32_u24 v2, v1, s30, v2
  v_mad_i32_i24 v2, v3, s31, v2
  v_add_u32 v244, s29, v2
  s_sub_u32 s29, s29, 1024
  v_add_u32 v1, 192, v54
  v_mul_u32_u24 v2, 3277, v1
  v_lshrrev_b32 v2, 16, v2
  v_mad_i32_i24 v3, v2, s28, v1
  v_mul_u32_u24 v2, s50, v2
  v_lshl_add_u32 v2, v3, 4, v2
  v_mul_u32_u24 v3, 205, v3
  v_bfe_u32 v1, v3, 10, 1
  v_lshrrev_b32 v3, 11, v3
  v_mad_u32_u24 v2, v1, s30, v2
  v_mad_i32_i24 v2, v3, s31, v2
  v_add_u32 v245, s29, v2
  s_add_u32 s29, s29, 3072
  v_add_u32 v1, 256, v54
  v_mul_u32_u24 v2, 3277, v1
  v_lshrrev_b32 v2, 16, v2
  v_mad_i32_i24 v3, v2, s28, v1
  v_mul_u32_u24 v2, s50, v2
  v_lshl_add_u32 v2, v3, 4, v2
  v_mul_u32_u24 v3, 205, v3
  v_bfe_u32 v1, v3, 10, 1
  v_lshrrev_b32 v3, 11, v3
  v_mad_u32_u24 v2, v1, s30, v2
  v_mad_i32_i24 v2, v3, s31, v2
  v_add_u32 v246, s29, v2
  s_load_dword s39, s[26:27], 0
  v_lshlrev_b32 v4, 4, v7
  s_lshl_b32 s48, s2, 2
  s_add_u32 s48, s48, s20
  s_and_b32 s36, s36, 0xffffff00
  s_lshr_b32 s28, s2, 3
  s_lshl_b32 s29, s20, 5
  s_add_u32 s28, s28, s29
  s_add_u32 s28, s28, 2
  s_mov_b64 s[0:1], s[36:37]
  s_lshl_b32 s50, s28, 10
  s_cmp_ge_u32 s28, 48
  s_cbranch_scc1 k_nocp
  v_add_u32 v1, s50, v4
  v_min_u32 v1, 48336, v1
  global_load_dwordx4 v[128:131], v1, s[0:1]
k_nocp:
  s_add_u32 m0, s41, 0
  s_nop 0
  buffer_load_dwordx4 v242, s[12:15], s43 offen offset:0 lds
  s_mov_b32 s16, s26
  s_and_b32 s17, s27, 0xffff
  s_mov_b32 s18, 31457280
  s_mov_b32 s19, 0x20000
  s_lshr_b32 s51, s20, 1
  s_and_b32 s52, s20, 1
  v_lshrrev_b32 v59, 4, v7
  v_bfe_u32 v56, v7, 2, 2
  v_and_b32 v57, 3, v7
  v_and_b32 v58, 1, v59
  v_and_b32 v3, 15, v7
  v_lshrrev_b32 v6, 1, v3
  v_xor_b32 v6, v6, v59
  s_mul_i32 s28, s51, 12288
  v_lshl_add_u32 v55, v3, 7, s28
  v_lshl_add_u32 v247, v6, 4, v55
  v_xor_b32 v6, 4, v6
  v_lshl_add_u32 v248, v6, 4, v55
  v_lshl_add_u32 v55, v59, 3, v56
  v_mul_u32_u24 v55, 320, v55
  v_lshl_add_u32 v55, v57, 3, v55
  v_add_u32 v55, 24576, v55
  s_cmp_lt_u32 s22, 8
  s_cselect_b32 s34, 5, 6
  s_cselect_b32 s35, 9, 5
  s_cmp_eq_u32 s52, 0
  s_cselect_b32 s34, 0, s34
  s_cselect_b32 s35, 4, s35
  s_add_u32 s30, s34, 1
  v_xor_b32 v6, s34, v58
  v_lshl_add_u32 v249, v6, 5, v55
  v_xor_b32 v6, s30, v58
  v_lshl_add_u32 v250, v6, 5, v55
  v_xor_b32 v6, s35, v58
  v_lshl_add_u32 v251, v6, 5, v55
  v_mov_b32 v6, 0x3f803f80
  v_accvgpr_write_b32 a240, v6
  v_accvgpr_write_b32 a241, v6
  v_accvgpr_write_b32 a242, v6
  v_accvgpr_write_b32 a243, v6
  s_mul_i32 s36, s21, -15
  s_add_u32 s36, s36, s22
  s_add_u32 s36, s36, 142
  s_lshr_b32 s37, s36, 1
  s_and_b32 s38, s36, 1
  s_cmp_lt_u32 s37, 54
  s_cselect_b32 s56, s70, s64
  s_cselect_b32 s57, s71, s65
  s_cmp_lt_u32 s37, 54
  s_mov_b32 s58, 819200
  s_cselect_b32 s58, 2211840, s58
  s_cmp_lt_u32 s37, 54
  s_cselect_b32 s28, 0, 54
  s_and_b32 s57, s57, 0xffff
  s_mov_b32 s59, 0x20000
  s_sub_u32 s28, s37, s28
  s_mul_i32 s28, s28, 40960
  s_mul_i32 s29, s38, 640
  s_add_u32 s55, s28, s29
  s_mul_i32 s29, s20, 10240
  s_add_u32 s55, s55, s29
  s_mul_i32 s53, s20, 5120
  s_add_u32 s53, s53, 135168
  s_lshl_b32 s34, s34, 6
  s_lshl_b32 s35, s35, 6
  v_lshl_add_u32 v253, v7, 2, s34
  v_lshl_add_u32 v254, v7, 2, s35
  v_and_b32 v6, 48, v7
  v_lshl_add_u32 v254, v6, 22, v254
  s_add_u32 s34, s34, 143360
  s_add_u32 s35, s35, 143360
  s_mul_i32 s62, s22, 6400
  s_add_u32 s62, s62, 81920
  s_mul_i32 s64, s21, 640
  s_add_u32 s64, s64, s62
  s_cmp_ge_u32 s21, 10
  s_cselect_b32 s64, 1073741824, s64
  s_cmp_eq_u32 s51, 1
  s_cselect_b32 s64, 1073741824, s64
  v_add_u32 v5, 4096, v4
  s_mul_i32 s28, s37, 205
  s_lshr_b32 s28, s28, 10
  s_mul_i32 s30, s28, 5
  s_sub_u32 s30, s37, s30
  buffer_load_dwordx4 v243, s[12:15], s43 offen offset:1024 lds
  s_lshl_b32 s29, s30, 3
  s_lshr_b32 s47, 0x01001600, s29
  s_and_b32 s47, s47, 255
  s_cmp_eq_u32 s30, 4
  s_cselect_b32 s47, 23, s47
  s_lshl_b32 s29, s28, 1
  s_add_u32 s47, s47, s29
  s_add_u32 s28, s28, 43
  s_cmp_eq_u32 s30, 2
  s_cselect_b32 s31, 1, 0
  s_cselect_b32 s47, s28, s47
  s_cmp_ge_u32 s37, 54
  s_cselect_b32 s31, 1, s31
  s_cselect_b32 s47, s37, s47
  s_lshl_b32 s28, 5120, s31
  s_mul_i32 s29, s31, 4608
  s_add_u32 s29, s29, 512
  s_mul_i32 s30, s31, -9728
  s_add_u32 s30, s30, 10240
  v_lshrrev_b32 v3, 5, v7
  v_mul_u32_u24 v1, s28, v3
  v_bfe_u32 v3, v7, 4, 1
  v_mad_u32_u24 v1, v3, s29, v1
  v_bfe_u32 v3, v7, 2, 2
  v_lshl_add_u32 v1, v3, 7, v1
  v_and_b32 v3, 3, v7
  v_lshl_add_u32 v1, v3, 3, v1
  s_mul_i32 s28, s20, 1056
  s_add_u32 s28, s28, 135168
  v_add_u32 v1, s28, v1
  v_add_u32 v2, s30, v1
  s_lshl_b32 s28, s38, 2
  s_add_u32 s28, s28, s20
  s_add_u32 s28, s28, 1
  s_lshl_b32 s28, s28, 21
  s_lshl_b32 s29, s47, 14
  s_add_u32 s28, s28, s29
  s_bfe_u32 s29, s47, 0x10001
  s_mul_i32 s29, s29, 11264
  s_add_u32 s28, s28, s29
  s_cmp_ge_u32 s36, 148
  s_cselect_b32 s60, 1073741824, s28
  s_and_b32 s76, s2, 3
  s_lshl_b32 s76, s76, 2
  s_bfe_u32 s28, s2, 0x20003
  s_add_u32 s76, s76, s28
  s_and_b32 s78, s2, 4
  s_lshl_b32 s78, s78, 1
  s_lshr_b32 s28, s2, 5
  s_add_u32 s78, s78, s28
  s_and_b32 s24, s2, 6
  s_lshl_b32 s24, s24, 2
  s_add_u32 s24, s24, s28
  s_mul_i32 s77, s76, 5
  s_lshr_b32 s77, s77, 2
  s_mul_i32 s25, s20, 15360
  s_add_u32 s25, s25, 102400
  s_and_b32 s28, s24, 30
  s_mul_i32 s83, s28, 21846
  s_lshr_b32 s83, s83, 16
  s_add_u32 s83, s83, 144
  s_add_u32 s28, s28, 1
  s_mul_i32 s28, s28, 21846
  s_lshr_b32 s28, s28, 16
  s_add_u32 s28, s28, 12
  s_lshr_b32 s29, s76, 1
  s_mul_i32 s29, s29, 12
  s_sub_u32 s29, s29, 22
  s_lshl_b32 s30, s78, 1
  s_mul_i32 s31, s30, 21846
  s_lshr_b32 s31, s31, 16
  s_add_u32 s30, s30, 1
  s_mul_i32 s30, s30, 21846
  s_lshr_b32 s30, s30, 16
  s_lshr_b32 s82, s76, 2
  s_mul_i32 s82, s82, 12
  s_add_u32 s82, s82, 96
  s_add_u32 s31, s31, s82
  s_add_u32 s30, s30, s82
  v_min_u32 v64, 21, v7
  buffer_load_dwordx4 v244, s[12:15], s43 offen offset:2048 lds
  v_mad_u32_u24 v65, v64, 12, s83
  v_mad_u32_u24 v66, v64, 12, s28
  v_cmp_le_u32 vcc, 11, v7
  s_nop 1
  v_cndmask_b32 v65, v65, v66, vcc
  v_lshlrev_b32 v66, 7, v65
  v_add_u32 v184, 1001472, v66
  v_add_u32 v66, s29, v7
  v_cmp_le_u32 vcc, 22, v7
  s_nop 1
  v_cndmask_b32 v65, v65, v66, vcc
  v_mov_b32 v66, s31
  v_cmp_le_u32 vcc, 33, v7
  s_nop 1
  v_cndmask_b32 v65, v65, v66, vcc
  v_mov_b32 v66, s30
  v_cmp_le_u32 vcc, 34, v7
  s_nop 1
  v_cndmask_b32 v65, v65, v66, vcc
  v_lshlrev_b32 v65, 7, v65
  v_add_u32 v185, 983040, v65
  v_and_b32 v64, 15, v7
  v_lshrrev_b32 v65, 4, v7
  v_lshrrev_b32 v66, 2, v64
  v_and_b32 v212, 3, v64
  v_lshl_add_u32 v67, v66, 3, v212
  v_cmp_le_u32 vcc, 20, v67
  s_nop 1
  v_cndmask_b32 v216, 0, 5, vcc
  v_lshlrev_b32 v220, 2, v216
  v_sub_u32 v220, v67, v220
  v_add_u32 v67, 4, v67
  v_cmp_le_u32 vcc, 20, v67
  s_nop 1
  v_cndmask_b32 v217, 0, 5, vcc
  v_lshlrev_b32 v221, 2, v217
  v_sub_u32 v221, v67, v221
  v_cmp_gt_u32 vcc, 8, v64
  s_nop 1
  v_cndmask_b32 v218, 64, 5, vcc
  v_add_u32 v222, 12, v64
  v_add_u32 v67, v66, v212
  v_cmp_le_u32 vcc, 3, v67
  v_cmp_le_u32 s[82:83], 2, v212
  s_nop 0
  s_or_b64 vcc, vcc, s[82:83]
  v_cndmask_b32 v219, 0, 5, vcc
  v_mov_b32 v223, 20
  v_mov_b32 v213, 255
  s_mov_b32 s47, 102400
  s_add_u32 s31, s77, 0
  s_mul_i32 s80, s31, 205
  s_lshr_b32 s80, s80, 10
  s_mul_i32 s80, s80, 5
  s_sub_u32 s80, s31, s80
  s_cmp_eq_u32 s80, 2
  s_cselect_b32 s81, 1, 0
  s_cselect_b32 s46, 1, 4
  s_lshl_b32 s31, s31, 3
  s_mul_i32 s80, s76, 10
  s_sub_u32 s31, s31, s80
  v_lshlrev_b32 v66, s81, v65
  v_add_u32 v66, s31, v66
  v_sub_u32 v212, v66, v216
  v_cmp_gt_u32 vcc, 5, v212
  v_mad_u32_u24 v212, v66, 21, v220
  s_nop 0
  v_cndmask_b32 v212, v213, v212, vcc
  v_lshl_add_u32 v168, v212, 3, s47
  v_sub_u32 v212, v66, v217
  v_cmp_gt_u32 vcc, 5, v212
  v_mad_u32_u24 v212, v66, 21, v221
  s_nop 0
  v_cndmask_b32 v212, v213, v212, vcc
  v_lshl_add_u32 v172, v212, 3, s47
  v_sub_u32 v212, v66, v218
  v_cmp_gt_u32 vcc, 5, v212
  v_mad_u32_u24 v212, v66, 21, v222
  s_nop 0
  v_cndmask_b32 v212, v213, v212, vcc
  v_lshl_add_u32 v176, v212, 3, s47
  v_sub_u32 v212, v66, v219
  v_cmp_gt_u32 vcc, 5, v212
  v_mad_u32_u24 v212, v66, 21, v223
  s_nop 0
  v_cndmask_b32 v212, v213, v212, vcc
  v_lshl_add_u32 v180, v212, 3, s47
  v_add_u32 v66, s46, v66
  buffer_load_dwordx4 v245, s[12:15], s43 offen offset:3072 lds
  v_sub_u32 v212, v66, v216
  v_cmp_gt_u32 vcc, 5, v212
  v_mad_u32_u24 v212, v66, 21, v220
  s_nop 0
  v_cndmask_b32 v212, v213, v212, vcc
  v_lshl_add_u32 v169, v212, 3, s47
  v_sub_u32 v212, v66, v217
  v_cmp_gt_u32 vcc, 5, v212
  v_mad_u32_u24 v212, v66, 21, v221
  s_nop 0
  v_cndmask_b32 v212, v213, v212, vcc
  v_lshl_add_u32 v173, v212, 3, s47
  v_sub_u32 v212, v66, v218
  v_cmp_gt_u32 vcc, 5, v212
  v_mad_u32_u24 v212, v66, 21, v222
  s_nop 0
  v_cndmask_b32 v212, v213, v212, vcc
  v_lshl_add_u32 v177, v212, 3, s47
  v_sub_u32 v212, v66, v219
  v_cmp_gt_u32 vcc, 5, v212
  v_mad_u32_u24 v212, v66, 21, v223
  s_nop 0
  v_cndmask_b32 v212, v213, v212, vcc
  v_lshl_add_u32 v181, v212, 3, s47
  s_add_u32 s31, s77, 1
  s_mul_i32 s80, s31, 205
  s_lshr_b32 s80, s80, 10
  s_mul_i32 s80, s80, 5
  s_sub_u32 s80, s31, s80
  s_cmp_eq_u32 s80, 2
  s_cselect_b32 s81, 1, 0
  s_cselect_b32 s46, 1, 4
  s_lshl_b32 s31, s31, 3
  s_mul_i32 s80, s76, 10
  s_sub_u32 s31, s31, s80
  v_lshlrev_b32 v66, s81, v65
  v_add_u32 v66, s31, v66
  v_sub_u32 v212, v66, v216
  v_cmp_gt_u32 vcc, 5, v212
  v_mad_u32_u24 v212, v66, 21, v220
  s_nop 0
  v_cndmask_b32 v212, v213, v212, vcc
  v_lshl_add_u32 v170, v212, 3, s47
  v_sub_u32 v212, v66, v217
  v_cmp_gt_u32 vcc, 5, v212
  v_mad_u32_u24 v212, v66, 21, v221
  s_nop 0
  v_cndmask_b32 v212, v213, v212, vcc
  v_lshl_add_u32 v174, v212, 3, s47
  v_sub_u32 v212, v66, v218
  v_cmp_gt_u32 vcc, 5, v212
  v_mad_u32_u24 v212, v66, 21, v222
  s_nop 0
  v_cndmask_b32 v212, v213, v212, vcc
  v_lshl_add_u32 v178, v212, 3, s47
  v_sub_u32 v212, v66, v219
  v_cmp_gt_u32 vcc, 5, v212
  v_mad_u32_u24 v212, v66, 21, v223
  s_nop 0
  v_cndmask_b32 v212, v213, v212, vcc
  v_lshl_add_u32 v182, v212, 3, s47
  v_add_u32 v66, s46, v66
  v_sub_u32 v212, v66, v216
  v_cmp_gt_u32 vcc, 5, v212
  v_mad_u32_u24 v212, v66, 21, v220
  s_nop 0
  v_cndmask_b32 v212, v213, v212, vcc
  v_lshl_add_u32 v171, v212, 3, s47
  v_sub_u32 v212, v66, v217
  v_cmp_gt_u32 vcc, 5, v212
  v_mad_u32_u24 v212, v66, 21, v221
  s_nop 0
  v_cndmask_b32 v212, v213, v212, vcc
  v_lshl_add_u32 v175, v212, 3, s47
  v_sub_u32 v212, v66, v218
  v_cmp_gt_u32 vcc, 5, v212
  v_mad_u32_u24 v212, v66, 21, v222
  s_nop 0
  v_cndmask_b32 v212, v213, v212, vcc
  v_lshl_add_u32 v179, v212, 3, s47
  v_sub_u32 v212, v66, v219
  v_cmp_gt_u32 vcc, 5, v212
  v_mad_u32_u24 v212, v66, 21, v223
  s_nop 0
  v_cndmask_b32 v212, v213, v212, vcc
  v_lshl_add_u32 v183, v212, 3, s47
  v_add_u32 v67, 0, v7
  v_mul_u32_u24 v64, 6554, v67
  s_add_u32 m0, s41, 4096
  s_nop 0
  buffer_load_dwordx4 v246, s[12:15], s43 offen offset:0 lds
  v_lshrrev_b32 v64, 16, v64
  v_mul_u32_u24 v66, 1120, v64
  v_lshl_add_u32 v66, v67, 4, v66
  v_cmp_gt_u32 vcc, 160, v67
  v_add_u32 v64, v64, v67
  v_mov_b32 v67, 1073741824
  v_lshl_add_u32 v186, v64, 4, s25
  v_cndmask_b32 v189, v67, v66, vcc
  v_add_u32 v67, 64, v7
  v_mul_u32_u24 v64, 6554, v67
  v_lshrrev_b32 v64, 16, v64
  v_mul_u32_u24 v66, 1120, v64
  v_lshl_add_u32 v66, v67, 4, v66
  v_cmp_gt_u32 vcc, 160, v67
  v_add_u32 v64, v64, v67
  v_mov_b32 v67, 1073741824
  v_lshl_add_u32 v187, v64, 4, s25
  v_cndmask_b32 v190, v67, v66, vcc
  v_add_u32 v67, 128, v7
  v_mul_u32_u24 v64, 6554, v67
  v_lshrrev_b32 v64, 16, v64
  v_mul_u32_u24 v66, 1120, v64
  v_lshl_add_u32 v66, v67, 4, v66
  v_cmp_gt_u32 vcc, 160, v67
  v_add_u32 v64, v64, v67
  v_mov_b32 v67, 1073741824
  v_lshl_add_u32 v188, v64, 4, s25
  v_cndmask_b32 v191, v67, v66, vcc
  v_accvgpr_write_b32 a204, v168
  v_accvgpr_write_b32 a205, v169
  v_accvgpr_write_b32 a206, v170
  v_accvgpr_write_b32 a207, v171
  v_accvgpr_write_b32 a208, v172
  v_accvgpr_write_b32 a209, v173
  v_accvgpr_write_b32 a210, v174
  v_accvgpr_write_b32 a211, v175
  v_accvgpr_write_b32 a212, v176
  v_accvgpr_write_b32 a213, v177
  v_accvgpr_write_b32 a214, v178
  v_accvgpr_write_b32 a215, v179
  v_accvgpr_write_b32 a216, v180
  v_accvgpr_write_b32 a217, v181
  v_accvgpr_write_b32 a218, v182
  v_accvgpr_write_b32 a219, v183
  v_accvgpr_write_b32 a220, v184
  v_accvgpr_write_b32 a221, v185
  v_accvgpr_write_b32 a222, v186
  v_accvgpr_write_b32 a223, v187
  v_accvgpr_write_b32 a224, v188
  v_accvgpr_write_b32 a225, v189
  v_accvgpr_write_b32 a226, v190
  v_accvgpr_write_b32 a227, v191
  s_mov_b64 s[36:37], s[74:75]
  s_lshl_b32 s49, s2, 4
  s_add_u32 s49, s49, 32768
  s_cmp_eq_u32 s20, 0
  s_cselect_b32 s49, s49, 1073741824
  v_add_u32 v5, 4096, v4
  s_mov_b32 s4, s72
  s_and_b32 s5, s73, 0xffff
  s_mov_b32 s6, 2621440
  s_mov_b32 s7, 0x20000
  s_mul_i32 s74, s22, 6400
  s_add_u32 s74, s74, 81920
  s_add_u32 s73, s2, s20
  s_cmp_eq_u32 s73, 0
  s_cselect_b32 s73, 0, 1073741824
  s_and_b32 s24, s2, 6
  s_lshl_b32 s24, s24, 2
  s_lshr_b32 s28, s2, 5
  s_add_u32 s24, s24, s28
  s_bfe_u32 s25, s2, 0x20003
  s_and_b32 s28, s2, 1
  s_lshl_b32 s28, s28, 2
  s_add_u32 s25, s25, s28
  s_add_u32 s29, s25, 1
  s_cmp_le_u32 s54, 0
  s_cselect_b32 s44, 1, 0
  s_lshl_b32 s42, s44, 7
  s_mul_i32 s43, s44, s45
  s_waitcnt vmcnt(11)
  s_add_u32 m0, s40, 45056
  s_nop 0
  buffer_load_dwordx4 v236, s[8:11], s42 offen offset:0 lds
  s_lshl_b32 s29, s29, 21
  s_and_b32 s47, s24, 1
  s_lshl_b32 s28, s20, 1
  s_add_u32 s47, s47, s28
  s_lshl_b32 s28, s47, 14
  s_add_u32 s46, s29, s28
  s_mul_i32 s28, s52, 11264
  s_add_u32 s46, s46, s28
  s_lshl_b32 s28, s20, 14
  s_add_u32 s70, s29, s28
  s_mul_i32 s28, s51, 11264
  s_sub_u32 s70, s70, s28
  s_add_u32 s70, s70, 896000
  s_mul_i32 s69, s20, 5120
  s_lshl_b32 s72, s20, 10
  s_add_u32 s72, s72, 135168
  s_mul_i32 s65, s21, 768
  s_add_u32 s65, s65, 63232
  s_movk_i32 s66, 192
  buffer_load_dwordx4 v237, s[8:11], s42 offen offset:1024 lds
  s_mul_i32 s67, s22, 12
  s_add_u32 s67, s67, s21
  s_lshl_b32 s67, s67, 7
  s_add_u32 s67, s67, 983040
  s_cmp_eq_u32 s20, 0
  s_cselect_b32 s67, s67, 1073741824
  s_cmp_lt_u32 s22, 12
  s_mov_b32 s83, 3216550459
  s_cselect_b32 s83, 1069066811, s83
  s_mul_i32 s76, s21, 3
  s_add_u32 s76, s76, s51
  s_add_u32 s77, s76, 1
  s_and_b32 s28, s76, 15
  s_lshr_b32 s28, s28, 1
  s_add_u32 s28, s28, 1
  s_lshr_b32 s29, s76, 4
  s_xor_b32 s29, s29, s28
  s_and_b32 s29, s29, 1
  s_lshl_b32 s29, s29, 13
  s_lshl_b32 s28, s28, 21
  s_add_u32 s28, s28, s29
  s_and_b32 s29, s76, 1
  buffer_load_dwordx4 v238, s[8:11], s42 offen offset:2048 lds
  s_mul_i32 s29, s29, 442368
  s_add_u32 s28, s28, s29
  s_add_u32 s80, s28, 1212416
  s_and_b32 s28, s77, 15
  s_lshr_b32 s28, s28, 1
  s_add_u32 s28, s28, 1
  s_lshr_b32 s29, s77, 4
  s_xor_b32 s29, s29, s28
  s_and_b32 s29, s29, 1
  s_lshl_b32 s29, s29, 13
  s_lshl_b32 s28, s28, 21
  s_add_u32 s28, s28, s29
  s_and_b32 s29, s77, 1
  s_mul_i32 s29, s29, 442368
  s_add_u32 s28, s28, s29
  s_add_u32 s81, s28, 1212416
  s_and_b32 s28, s76, 15
  s_lshr_b32 s28, s28, 2
  s_add_u32 s28, s28, 9
  buffer_load_dwordx4 v239, s[8:11], s42 offen offset:3072 lds
  s_lshr_b32 s29, s76, 4
  s_xor_b32 s29, s29, s28
  s_and_b32 s29, s29, 1
  s_lshl_b32 s29, s29, 13
  s_lshl_b32 s28, s28, 21
  s_add_u32 s28, s28, s29
  s_and_b32 s29, s76, 3
  s_mul_i32 s29, s29, 327680
  s_add_u32 s28, s28, s29
  s_add_u32 s78, s28, 0
  s_and_b32 s28, s77, 15
  s_lshr_b32 s28, s28, 2
  s_add_u32 s28, s28, 9
  s_lshr_b32 s29, s77, 4
  s_xor_b32 s29, s29, s28
  s_and_b32 s29, s29, 1
  s_lshl_b32 s29, s29, 13
  s_lshl_b32 s28, s28, 21
  s_add_u32 s28, s28, s29
  s_add_u32 m0, s40, 49152
  s_nop 0
  buffer_load_dwordx4 v240, s[8:11], s42 offen offset:0 lds
  s_and_b32 s29, s77, 3
  s_mul_i32 s29, s29, 327680
  s_add_u32 s28, s28, s29
  s_add_u32 s79, s28, 0
  s_cmp_lt_u32 s22, 12
  s_cselect_b32 s80, s78, s80
  s_cselect_b32 s81, s79, s81
  s_cmp_ge_u32 s76, 32
  s_cselect_b32 s80, 1073741824, s80
  s_cmp_ge_u32 s77, 32
  s_cselect_b32 s81, 1073741824, s81
  s_lshl_b32 s28, s51, 11
  s_add_u32 s82, s81, s28
  s_add_u32 s29, s80, 2048
  s_add_u32 s80, s80, s28
  s_cmp_eq_u32 s51, 0
  s_cselect_b32 s81, s29, s81
  s_mul_i32 s61, s23, 5
  s_mul_i32 s28, s52, 3
  s_add_u32 s62, s61, s28
  s_add_u32 s63, s62, 1
  s_add_u32 s61, s61, 2
  s_lshl_b32 s28, s23, 1
  s_add_u32 s28, s28, s52
  buffer_load_dwordx4 v241, s[8:11], s42 offen offset:1024 lds
  s_add_u32 s29, s28, 22
  s_add_u32 s30, s23, 43
  s_cmp_lt_u32 s22, 12
  s_cselect_b32 s62, s62, s28
  s_cselect_b32 s63, s63, s29
  s_cselect_b32 s61, s61, s30
  s_mov_b32 s75, 18432
  s_cselect_b32 s75, 1073741824, s75
  s_cmp_eq_u32 s63, 43
  s_cselect_b32 s63, 131072, s63
  s_lshr_b32 s28, s62, 1
  s_lshl_b32 s28, s28, 14
  s_and_b32 s62, s62, 1
  s_lshl_b32 s62, s62, 12
  s_add_u32 s62, s62, s28
  s_lshr_b32 s28, s63, 1
  s_lshl_b32 s28, s28, 14
  s_and_b32 s63, s63, 1
  s_lshl_b32 s63, s63, 12
  s_add_u32 s63, s63, s28
  s_lshr_b32 s28, s61, 1
  s_lshl_b32 s28, s28, 14
  s_and_b32 s61, s61, 1
  s_lshl_b32 s61, s61, 12
  s_add_u32 s61, s61, s28
  s_add_u32 m0, s41, 45056
  s_nop 0
  buffer_load_dwordx4 v242, s[12:15], s43 offen offset:0 lds
  s_lshl_b32 s28, s52, 9
  s_add_u32 s61, s61, s28
  s_add_u32 s75, s75, s67
  v_lshlrev_b32 v20, 16, v8
  v_and_b32 v21, 0xffff0000, v8
  v_lshlrev_b32 v22, 16, v9
  v_and_b32 v23, 0xffff0000, v9
  v_lshlrev_b32 v24, 16, v10
  v_and_b32 v25, 0xffff0000, v10
  v_lshlrev_b32 v26, 16, v11
  v_and_b32 v27, 0xffff0000, v11
  v_lshlrev_b32 v28, 16, v12
  v_and_b32 v29, 0xffff0000, v12
  v_lshlrev_b32 v30, 16, v13
  v_and_b32 v31, 0xffff0000, v13
  v_lshlrev_b32 v32, 16, v14
  v_and_b32 v33, 0xffff0000, v14
  v_lshlrev_b32 v34, 16, v15
  v_and_b32 v35, 0xffff0000, v15
  buffer_load_dwordx4 v243, s[12:15], s43 offen offset:1024 lds
  v_lshlrev_b32 v36, 16, v16
  v_and_b32 v37, 0xffff0000, v16
  v_lshlrev_b32 v38, 16, v17
  v_and_b32 v39, 0xffff0000, v17
  v_lshlrev_b32 v40, 16, v18
  v_and_b32 v41, 0xffff0000, v18
  v_lshlrev_b32 v42, 16, v19
  v_and_b32 v43, 0xffff0000, v19
  v_pk_add_f32 v[44:45], v[20:21], v[22:23]
  v_pk_add_f32 v[44:45], v[44:45], v[24:25]
  v_pk_add_f32 v[44:45], v[44:45], v[26:27]
  v_pk_add_f32 v[44:45], v[44:45], v[28:29]
  v_pk_add_f32 v[44:45], v[44:45], v[30:31]
  v_pk_add_f32 v[44:45], v[44:45], v[32:33]
  v_pk_add_f32 v[44:45], v[44:45], v[34:35]
  v_pk_add_f32 v[44:45], v[44:45], v[36:37]
  v_pk_add_f32 v[44:45], v[44:45], v[38:39]
  v_pk_add_f32 v[44:45], v[44:45], v[40:41]
  v_pk_add_f32 v[44:45], v[44:45], v[42:43]
  buffer_load_dwordx4 v244, s[12:15], s43 offen offset:2048 lds
  v_add_f32 v44, v44, v45
  s_nop 1
  v_add_f32_dpp v44, v44, v44 row_ror:8 row_mask:0xf bank_mask:0xf
  s_nop 1
  v_add_f32_dpp v44, v44, v44 row_ror:4 row_mask:0xf bank_mask:0xf
  s_nop 1
  v_add_f32_dpp v44, v44, v44 row_ror:2 row_mask:0xf bank_mask:0xf
  s_nop 1
  v_add_f32_dpp v44, v44, v44 row_ror:1 row_mask:0xf bank_mask:0xf
  v_mov_b32 v45, v44
  s_nop 1
  v_permlane16_swap_b32 v44, v45
  v_add_f32 v44, v44, v45
  v_mul_f32 v46, 0xbacccccd, v44
  v_cndmask_b32 v47, 0, v46, s[32:33]
  v_pk_add_f32 v[20:21], v[20:21], v[46:47] op_sel_hi:[1,0]
  v_pk_add_f32 v[22:23], v[22:23], v[46:47] op_sel_hi:[1,0]
  v_pk_add_f32 v[24:25], v[24:25], v[46:47] op_sel_hi:[1,0]
  v_pk_add_f32 v[26:27], v[26:27], v[46:47] op_sel_hi:[1,0]
  v_pk_add_f32 v[28:29], v[28:29], v[46:47] op_sel_hi:[1,0]
  v_pk_add_f32 v[30:31], v[30:31], v[46:47] op_sel_hi:[1,0]
  v_pk_add_f32 v[32:33], v[32:33], v[46:47] op_sel_hi:[1,0]
  v_pk_add_f32 v[34:35], v[34:35], v[46:47] op_sel_hi:[1,0]
  v_pk_add_f32 v[36:37], v[36:37], v[46:47] op_sel:[0,1] op_sel_hi:[1,1]
  buffer_load_dwordx4 v245, s[12:15], s43 offen offset:3072 lds
  v_pk_add_f32 v[38:39], v[38:39], v[46:47] op_sel:[0,1] op_sel_hi:[1,1]
  v_pk_add_f32 v[40:41], v[40:41], v[46:47] op_sel:[0,1] op_sel_hi:[1,1]
  v_pk_add_f32 v[42:43], v[42:43], v[46:47] op_sel:[0,1] op_sel_hi:[1,1]
  v_pk_mul_f32 v[44:45], v[20:21], v[20:21]
  v_pk_fma_f32 v[44:45], v[22:23], v[22:23], v[44:45]
  v_pk_fma_f32 v[44:45], v[24:25], v[24:25], v[44:45]
  v_pk_fma_f32 v[44:45], v[26:27], v[26:27], v[44:45]
  v_pk_fma_f32 v[44:45], v[28:29], v[28:29], v[44:45]
  v_pk_fma_f32 v[44:45], v[30:31], v[30:31], v[44:45]
  v_pk_fma_f32 v[44:45], v[32:33], v[32:33], v[44:45]
  v_pk_fma_f32 v[44:45], v[34:35], v[34:35], v[44:45]
  v_pk_fma_f32 v[44:45], v[36:37], v[36:37], v[44:45]
  v_pk_fma_f32 v[44:45], v[38:39], v[38:39], v[44:45]
  v_pk_fma_f32 v[44:45], v[40:41], v[40:41], v[44:45]
  v_pk_fma_f32 v[44:45], v[42:43], v[42:43], v[44:45]
  v_add_f32 v44, v44, v45
  s_nop 1
  v_add_f32_dpp v44, v44, v44 row_ror:8 row_mask:0xf bank_mask:0xf
  s_nop 1
  v_add_f32_dpp v44, v44, v44 row_ror:4 row_mask:0xf bank_mask:0xf
  s_nop 1
  v_add_f32_dpp v44, v44, v44 row_ror:2 row_mask:0xf bank_mask:0xf
  s_add_u32 m0, s41, 49152
  s_nop 0
  buffer_load_dwordx4 v246, s[12:15], s43 offen offset:0 lds
  v_add_f32_dpp v44, v44, v44 row_ror:1 row_mask:0xf bank_mask:0xf
  v_mov_b32 v45, v44
  s_nop 1
  v_permlane16_swap_b32 v44, v45
  v_add_f32 v44, v44, v45
  v_mov_b32 v45, 0x3727c5ac
  v_fmac_f32 v45, 0x3acccccd, v44
  v_rsq_f32 v45, v45
  v_and_b32 v48, 31, v7
  v_cmp_eq_u32 vcc, 0, v48
  v_lshrrev_b32 v49, 5, v7
  v_lshlrev_b32 v49, 2, v49
  v_cndmask_b32 v46, v45, v46, vcc
  v_lshl_add_u32 v49, v48, 13, v49
  v_cmp_gt_u32 vcc, 2, v48
  v_mov_b32 v50, 1073741824
  s_lshl_b32 s28, s48, 3
  s_add_u32 s28, s28, 65536
  v_cndmask_b32 v49, v50, v49, vcc
  buffer_store_dword v46, v49, s[16:19], s28 offen sc1
  s_cmp_le_u32 s54, 1
  s_cselect_b32 s44, 2, 1
  s_lshl_b32 s42, s44, 7
  s_mul_i32 s43, s44, s45
  s_waitcnt lgkmcnt(0)
  s_mul_i32 s39, s39, 1664525
  s_add_u32 s39, s39, 1013904223
  s_cmp_lt_u32 s22, 8
  s_cbranch_scc1 k_kv
  s_cmp_eq_u32 s21, 11
  s_cbranch_scc1 k_race
  s_waitcnt vmcnt(12)
  s_barrier
  ds_read_b64_tr_b16 v[196:197], v249 offset:0
  ds_read_b64_tr_b16 v[198:199], v249 offset:1280
  ds_read_b64_tr_b16 v[216:217], v249 offset:10240
  ds_read_b64_tr_b16 v[218:219], v249 offset:11520
  ds_read_b64_tr_b16 v[200:201], v250 offset:0
  ds_read_b64_tr_b16 v[202:203], v250 offset:1280
  ds_read_b64_tr_b16 v[220:221], v250 offset:10240
  ds_read_b64_tr_b16 v[222:223], v250 offset:11520
  ds_read_b64_tr_b16 v[204:205], v249 offset:64
  ds_read_b64_tr_b16 v[206:207], v249 offset:1344
  ds_read_b64_tr_b16 v[224:225], v249 offset:10304
  ds_read_b64_tr_b16 v[226:227], v249 offset:11584
  ds_read_b64_tr_b16 v[208:209], v250 offset:64
  ds_read_b64_tr_b16 v[210:211], v250 offset:1344
  ds_read_b64_tr_b16 v[228:229], v250 offset:10304
  ds_read_b64_tr_b16 v[230:231], v250 offset:11584
  ds_read_b64_tr_b16 v[212:213], v251 offset:0
  ds_read_b64_tr_b16 v[214:215], v251 offset:1280
  ds_read_b64_tr_b16 v[232:233], v251 offset:10240
  ds_read_b64_tr_b16 v[234:235], v251 offset:11520
  ds_read_b128 v[148:151], v247 offset:0
  ds_read_b128 v[172:175], v248 offset:0
  s_waitcnt lgkmcnt(2)
  v_mfma_f32_16x16x32_bf16 v[128:131], a[240:243], v[196:199], 0
  ds_read_b128 v[152:155], v247 offset:2048
  s_add_u32 m0, s40, 90112
  v_mfma_f32_16x16x32_bf16 v[128:131], a[240:243], v[216:219], v[128:131]
  buffer_load_dwordx4 v236, s[8:11], s42 offen offset:0 lds
  v_mfma_f32_16x16x32_bf16 v[132:135], a[240:243], v[200:203], 0
  ds_read_b128 v[176:179], v248 offset:2048
  v_mfma_f32_16x16x32_bf16 v[132:135], a[240:243], v[220:223], v[132:135]
  buffer_load_dwordx4 v237, s[8:11], s42 offen offset:1024 lds
  v_mfma_f32_16x16x32_bf16 v[136:139], a[240:243], v[204:207], 0
  ds_read_b128 v[156:159], v247 offset:4096
  buffer_load_dwordx4 v238, s[8:11], s42 offen offset:2048 lds
  v_mfma_f32_16x16x32_bf16 v[136:139], a[240:243], v[224:227], v[136:139]
  v_mfma_f32_16x16x32_bf16 v[140:143], a[240:243], v[208:211], 0
  buffer_load_dwordx4 v239, s[8:11], s42 offen offset:3072 lds
  v_mfma_f32_16x16x32_bf16 v[140:143], a[240:243], v[228:231], v[140:143]
  ds_read_b128 v[180:183], v248 offset:4096
  s_add_u32 m0, s40, 94208
  v_mfma_f32_16x16x32_bf16 v[144:147], a[240:243], v[212:215], 0
  v_mfma_f32_16x16x32_bf16 v[144:147], a[240:243], v[232:235], v[144:147]
  ds_read_b128 v[160:163], v247 offset:6144
  s_waitcnt lgkmcnt(5)
  buffer_load_dwordx4 v240, s[8:11], s42 offen offset:0 lds
  v_mfma_f32_16x16x32_bf16 v[8:11], v[196:199], v[148:151], 0
  buffer_load_dwordx4 v241, s[8:11], s42 offen offset:1024 lds
  v_mfma_f32_16x16x32_bf16 v[8:11], v[216:219], v[172:175], v[8:11]
  v_mfma_f32_16x16x32_bf16 v[12:15], v[220:223], v[172:175], 0
  ds_read_b128 v[184:187], v248 offset:6144
  s_add_u32 m0, s41, 90112
  v_mfma_f32_16x16x32_bf16 v[12:15], v[200:203], v[148:151], v[12:15]
  v_mfma_f32_16x16x32_bf16 v[16:19], v[204:207], v[148:151], 0
  ds_read_b128 v[164:167], v247 offset:8192
  buffer_load_dwordx4 v242, s[12:15], s43 offen offset:0 lds
  v_mfma_f32_16x16x32_bf16 v[16:19], v[224:227], v[172:175], v[16:19]
  buffer_load_dwordx4 v243, s[12:15], s43 offen offset:1024 lds
  v_mfma_f32_16x16x32_bf16 v[20:23], v[228:231], v[172:175], 0
  ds_read_b128 v[188:191], v248 offset:8192
  v_mfma_f32_16x16x32_bf16 v[20:23], v[208:211], v[148:151], v[20:23]
  buffer_load_dwordx4 v244, s[12:15], s43 offen offset:2048 lds
  v_mfma_f32_16x16x32_bf16 v[24:27], v[212:215], v[148:151], 0
  buffer_load_dwordx4 v245, s[12:15], s43 offen offset:3072 lds
  v_mfma_f32_16x16x32_bf16 v[24:27], v[232:235], v[172:175], v[24:27]
  ds_read_b128 v[168:171], v247 offset:10240
  s_waitcnt lgkmcnt(7)
  v_mfma_f32_16x16x32_bf16 v[44:47], v[232:235], v[176:179], 0
  s_add_u32 m0, s41, 94208
  v_mfma_f32_16x16x32_bf16 v[44:47], v[212:215], v[152:155], v[44:47]
  ds_read_b128 v[192:195], v248 offset:10240
  buffer_load_dwordx4 v246, s[12:15], s43 offen offset:0 lds
  v_mfma_f32_16x16x32_bf16 v[40:43], v[208:211], v[152:155], 0
  v_mfma_f32_16x16x32_bf16 v[40:43], v[228:231], v[176:179], v[40:43]
  s_add_u32 m0, s53, 0
  v_mfma_f32_16x16x32_bf16 v[36:39], v[224:227], v[176:179], 0
  buffer_load_dwordx4 v252, s[56:59], s55 offen offset:0 nt lds
  v_cmp_le_u32 vcc, 16, v7
  v_mfma_f32_16x16x32_bf16 v[36:39], v[204:207], v[152:155], v[36:39]
  v_cmp_le_u32 s[28:29], 32, v7
  v_mfma_f32_16x16x32_bf16 v[32:35], v[200:203], v[152:155], 0
  s_add_u32 m0, s53, 896
  v_cmp_le_u32 s[30:31], 48, v7
  v_mfma_f32_16x16x32_bf16 v[32:35], v[220:223], v[176:179], v[32:35]
  v_cndmask_b32 v145, v128, v132, vcc
  v_mfma_f32_16x16x32_bf16 v[28:31], v[216:219], v[176:179], 0
  buffer_load_dwordx4 v252, s[56:59], s55 offen offset:128 nt lds
  v_cndmask_b32 v145, v145, v136, s[28:29]
  v_mfma_f32_16x16x32_bf16 v[28:31], v[196:199], v[152:155], v[28:31]
  s_waitcnt lgkmcnt(6)
  s_add_u32 m0, s53, 1792
  v_cndmask_b32 v145, v145, v140, s[30:31]
  v_mfma_f32_16x16x32_bf16 v[48:51], v[196:199], v[156:159], 0
  buffer_store_dword v145, v253, s[16:19], s64 offen sc1
  v_mfma_f32_16x16x32_bf16 v[48:51], v[216:219], v[180:183], v[48:51]
  buffer_load_dwordx4 v252, s[56:59], s55 offen offset:256 nt lds
  v_mfma_f32_16x16x32_bf16 v[52:55], v[220:223], v[180:183], 0
  s_add_u32 m0, s53, 2688
  buffer_store_dword v144, v254, s[16:19], s64 offen sc1
  v_mfma_f32_16x16x32_bf16 v[52:55], v[200:203], v[156:159], v[52:55]
  v_add_u32 v128, 90112, v247
  v_mfma_f32_16x16x32_bf16 v[56:59], v[204:207], v[156:159], 0
  buffer_load_dwordx4 v252, s[56:59], s55 offen offset:384 nt lds
  v_add_u32 v129, 90112, v248
  v_mfma_f32_16x16x32_bf16 v[56:59], v[224:227], v[180:183], v[56:59]
  s_add_u32 m0, s53, 3584
  v_add_u32 v130, 90112, v249
  v_mfma_f32_16x16x32_bf16 v[60:63], v[228:231], v[180:183], 0
  v_add_u32 v131, 90112, v250
  v_mfma_f32_16x16x32_bf16 v[60:63], v[208:211], v[156:159], v[60:63]
  buffer_load_dwordx4 v252, s[56:59], s55 offen offset:512 nt lds
  v_add_u32 v132, 90112, v251
  v_mfma_f32_16x16x32_bf16 v[64:67], v[212:215], v[156:159], 0
  v_mfma_f32_16x16x32_bf16 v[64:67], v[232:235], v[180:183], v[64:67]
  s_cmp_le_u32 s54, 2
  s_cselect_b32 s44, 3, 2
  s_lshl_b32 s42, s44, 7
  s_mul_i32 s43, s44, s45
  s_waitcnt lgkmcnt(0)
  v_mfma_f32_16x16x32_bf16 v[84:87], v[212:215], v[160:163], 0
  v_mfma_f32_16x16x32_bf16 v[84:87], v[232:235], v[184:187], v[84:87]
  s_waitcnt vmcnt(19)
  s_barrier
  v_mfma_f32_16x16x32_bf16 v[80:83], v[228:231], v[184:187], 0
  ds_read_b128 v[148:151], v247 offset:45056
  v_mfma_f32_16x16x32_bf16 v[80:83], v[208:211], v[160:163], v[80:83]
  ds_read_b128 v[172:175], v248 offset:45056
  v_mfma_f32_16x16x32_bf16 v[76:79], v[204:207], v[160:163], 0
  ds_read_b64_tr_b16 a[140:141], v249 offset:45056
  v_mfma_f32_16x16x32_bf16 v[76:79], v[224:227], v[184:187], v[76:79]
  ds_read_b64_tr_b16 a[142:143], v249 offset:46336
  s_add_u32 m0, s40, 0
  v_mfma_f32_16x16x32_bf16 v[72:75], v[220:223], v[184:187], 0
  ds_read_b64_tr_b16 a[160:161], v249 offset:55296
  buffer_load_dwordx4 v236, s[8:11], s42 offen offset:0 lds
  v_mfma_f32_16x16x32_bf16 v[72:75], v[200:203], v[160:163], v[72:75]
  ds_read_b64_tr_b16 a[162:163], v249 offset:56576
  v_mfma_f32_16x16x32_bf16 v[68:71], v[196:199], v[160:163], 0
  ds_read_b64_tr_b16 a[144:145], v250 offset:45056
  v_mfma_f32_16x16x32_bf16 v[68:71], v[216:219], v[184:187], v[68:71]
  ds_read_b64_tr_b16 a[146:147], v250 offset:46336
  v_mfma_f32_16x16x32_bf16 v[88:91], v[216:219], v[188:191], 0
  ds_read_b64_tr_b16 a[164:165], v250 offset:55296
  v_mfma_f32_16x16x32_bf16 v[88:91], v[196:199], v[164:167], v[88:91]
  ds_read_b64_tr_b16 a[166:167], v250 offset:56576
  buffer_load_dwordx4 v237, s[8:11], s42 offen offset:1024 lds
  v_mfma_f32_16x16x32_bf16 v[92:95], v[200:203], v[164:167], 0
  ds_read_b64_tr_b16 a[148:149], v249 offset:45120
  v_mfma_f32_16x16x32_bf16 v[92:95], v[220:223], v[188:191], v[92:95]
  ds_read_b64_tr_b16 a[150:151], v249 offset:46400
  v_mfma_f32_16x16x32_bf16 v[96:99], v[224:227], v[188:191], 0
  ds_read_b64_tr_b16 a[168:169], v249 offset:55360
  v_mfma_f32_16x16x32_bf16 v[96:99], v[204:207], v[164:167], v[96:99]
  ds_read_b64_tr_b16 a[170:171], v249 offset:56640
  v_mfma_f32_16x16x32_bf16 v[100:103], v[208:211], v[164:167], 0
  ds_read_b64_tr_b16 a[152:153], v250 offset:45120
  buffer_load_dwordx4 v238, s[8:11], s42 offen offset:2048 lds
  v_mfma_f32_16x16x32_bf16 v[100:103], v[228:231], v[188:191], v[100:103]
  ds_read_b64_tr_b16 a[154:155], v250 offset:46400
  v_mfma_f32_16x16x32_bf16 v[104:107], v[232:235], v[188:191], 0
  ds_read_b64_tr_b16 a[172:173], v250 offset:55360
  v_mfma_f32_16x16x32_bf16 v[104:107], v[212:215], v[164:167], v[104:107]
  ds_read_b64_tr_b16 a[174:175], v250 offset:56640
  v_mfma_f32_16x16x32_bf16 v[124:127], v[212:215], v[168:171], 0
  ds_read_b64_tr_b16 a[156:157], v251 offset:45056
  v_mfma_f32_16x16x32_bf16 v[124:127], v[232:235], v[192:195], v[124:127]
  ds_read_b64_tr_b16 a[158:159], v251 offset:46336
  buffer_load_dwordx4 v239, s[8:11], s42 offen offset:3072 lds
  v_mfma_f32_16x16x32_bf16 v[120:123], v[228:231], v[192:195], 0
  ds_read_b64_tr_b16 a[176:177], v251 offset:55296
  v_mfma_f32_16x16x32_bf16 v[120:123], v[208:211], v[168:171], v[120:123]
  ds_read_b64_tr_b16 a[178:179], v251 offset:56576
  v_mfma_f32_16x16x32_bf16 v[116:119], v[204:207], v[168:171], 0
  v_mfma_f32_16x16x32_bf16 v[116:119], v[224:227], v[192:195], v[116:119]
  s_add_u32 m0, s40, 4096
  v_mfma_f32_16x16x32_bf16 v[112:115], v[220:223], v[192:195], 0
  buffer_load_dwordx4 v240, s[8:11], s42 offen offset:0 lds
  v_mfma_f32_16x16x32_bf16 v[112:115], v[200:203], v[168:171], v[112:115]
  v_mfma_f32_16x16x32_bf16 v[108:111], v[196:199], v[168:171], 0
  v_mfma_f32_16x16x32_bf16 v[108:111], v[216:219], v[192:195], v[108:111]
  s_waitcnt lgkmcnt(0)
  v_mfma_f32_16x16x32_bf16 v[8:11], a[140:143], v[148:151], v[8:11]
  ds_read_b128 v[152:155], v247 offset:47104
  v_mfma_f32_16x16x32_bf16 v[8:11], a[160:163], v[172:175], v[8:11]
  ds_read_b128 v[176:179], v248 offset:47104
  buffer_load_dwordx4 v241, s[8:11], s42 offen offset:1024 lds
  v_mfma_f32_16x16x32_bf16 v[12:15], a[164:167], v[172:175], v[12:15]
  ds_read_b128 v[156:159], v247 offset:49152
  v_mfma_f32_16x16x32_bf16 v[12:15], a[144:147], v[148:151], v[12:15]
  v_mfma_f32_16x16x32_bf16 v[16:19], a[148:151], v[148:151], v[16:19]
  ds_read_b128 v[180:183], v248 offset:49152
  v_mfma_f32_16x16x32_bf16 v[16:19], a[168:171], v[172:175], v[16:19]
  ds_read_b128 v[160:163], v247 offset:51200
  s_add_u32 m0, s41, 0
  v_mfma_f32_16x16x32_bf16 v[20:23], a[172:175], v[172:175], v[20:23]
  buffer_load_dwordx4 v242, s[12:15], s43 offen offset:0 lds
  v_mfma_f32_16x16x32_bf16 v[20:23], a[152:155], v[148:151], v[20:23]
  ds_read_b128 v[184:187], v248 offset:51200
  v_mfma_f32_16x16x32_bf16 v[24:27], a[156:159], v[148:151], v[24:27]
  ds_read_b128 v[164:167], v247 offset:53248
  v_mfma_f32_16x16x32_bf16 v[24:27], a[176:179], v[172:175], v[24:27]
  ds_read_b128 v[188:191], v248 offset:53248
  s_waitcnt lgkmcnt(6)
  v_mfma_f32_16x16x32_bf16 v[44:47], a[176:179], v[176:179], v[44:47]
  v_mfma_f32_16x16x32_bf16 v[44:47], a[156:159], v[152:155], v[44:47]
  ds_read_b128 v[168:171], v247 offset:55296
  buffer_load_dwordx4 v243, s[12:15], s43 offen offset:1024 lds
  v_mfma_f32_16x16x32_bf16 v[40:43], a[152:155], v[152:155], v[40:43]
  ds_read_b128 v[192:195], v248 offset:55296
  v_mfma_f32_16x16x32_bf16 v[40:43], a[172:175], v[176:179], v[40:43]
  v_mfma_f32_16x16x32_bf16 v[36:39], a[168:171], v[176:179], v[36:39]
  v_mfma_f32_16x16x32_bf16 v[36:39], a[148:151], v[152:155], v[36:39]
  v_mfma_f32_16x16x32_bf16 v[32:35], a[144:147], v[152:155], v[32:35]
  buffer_load_dwordx4 v244, s[12:15], s43 offen offset:2048 lds
  v_mfma_f32_16x16x32_bf16 v[32:35], a[164:167], v[176:179], v[32:35]
  v_mfma_f32_16x16x32_bf16 v[28:31], a[160:163], v[176:179], v[28:31]
  v_mfma_f32_16x16x32_bf16 v[28:31], a[140:143], v[152:155], v[28:31]
  s_waitcnt lgkmcnt(6)
  v_mfma_f32_16x16x32_bf16 v[48:51], a[140:143], v[156:159], v[48:51]
  v_mfma_f32_16x16x32_bf16 v[48:51], a[160:163], v[180:183], v[48:51]
  buffer_load_dwordx4 v245, s[12:15], s43 offen offset:3072 lds
  v_mfma_f32_16x16x32_bf16 v[52:55], a[164:167], v[180:183], v[52:55]
  v_mfma_f32_16x16x32_bf16 v[52:55], a[144:147], v[156:159], v[52:55]
  v_mfma_f32_16x16x32_bf16 v[56:59], a[148:151], v[156:159], v[56:59]
  v_mfma_f32_16x16x32_bf16 v[56:59], a[168:171], v[180:183], v[56:59]
  s_add_u32 m0, s41, 4096
  v_mfma_f32_16x16x32_bf16 v[60:63], a[172:175], v[180:183], v[60:63]
  buffer_load_dwordx4 v246, s[12:15], s43 offen offset:0 lds
  v_mfma_f32_16x16x32_bf16 v[60:63], a[152:155], v[156:159], v[60:63]
  s_cmp_le_u32 s54, 3
  s_cselect_b32 s44, 4, 3
  v_mfma_f32_16x16x32_bf16 v[64:67], a[156:159], v[156:159], v[64:67]
  s_lshl_b32 s42, s44, 7
  v_mfma_f32_16x16x32_bf16 v[64:67], a[176:179], v[180:183], v[64:67]
  s_mul_i32 s43, s44, s45
  s_waitcnt lgkmcnt(0)
  v_mfma_f32_16x16x32_bf16 v[84:87], a[156:159], v[160:163], v[84:87]
  v_mfma_f32_16x16x32_bf16 v[84:87], a[176:179], v[184:187], v[84:87]
  s_waitcnt vmcnt(11)
  s_barrier
  v_mfma_f32_16x16x32_bf16 v[80:83], a[172:175], v[184:187], v[80:83]
  ds_read_b128 v[148:151], v128 offset:0
  v_mfma_f32_16x16x32_bf16 v[80:83], a[152:155], v[160:163], v[80:83]
  ds_read_b128 v[172:175], v129 offset:0
  v_mfma_f32_16x16x32_bf16 v[76:79], a[148:151], v[160:163], v[76:79]
  ds_read_b64_tr_b16 v[196:197], v130 offset:0
  v_mfma_f32_16x16x32_bf16 v[76:79], a[168:171], v[184:187], v[76:79]
  ds_read_b64_tr_b16 v[198:199], v130 offset:1280
  s_add_u32 m0, s40, 45056
  v_mfma_f32_16x16x32_bf16 v[72:75], a[164:167], v[184:187], v[72:75]
  ds_read_b64_tr_b16 v[216:217], v130 offset:10240
  buffer_load_dwordx4 v236, s[8:11], s42 offen offset:0 lds
  v_mfma_f32_16x16x32_bf16 v[72:75], a[144:147], v[160:163], v[72:75]
  ds_read_b64_tr_b16 v[218:219], v130 offset:11520
  v_mfma_f32_16x16x32_bf16 v[68:71], a[140:143], v[160:163], v[68:71]
  ds_read_b64_tr_b16 v[200:201], v131 offset:0
  v_mfma_f32_16x16x32_bf16 v[68:71], a[160:163], v[184:187], v[68:71]
  ds_read_b64_tr_b16 v[202:203], v131 offset:1280
  v_mfma_f32_16x16x32_bf16 v[88:91], a[160:163], v[188:191], v[88:91]
  ds_read_b64_tr_b16 v[220:221], v131 offset:10240
  v_mfma_f32_16x16x32_bf16 v[88:91], a[140:143], v[164:167], v[88:91]
  ds_read_b64_tr_b16 v[222:223], v131 offset:11520
  buffer_load_dwordx4 v237, s[8:11], s42 offen offset:1024 lds
  v_mfma_f32_16x16x32_bf16 v[92:95], a[144:147], v[164:167], v[92:95]
  ds_read_b64_tr_b16 v[204:205], v130 offset:64
  v_mfma_f32_16x16x32_bf16 v[92:95], a[164:167], v[188:191], v[92:95]
  ds_read_b64_tr_b16 v[206:207], v130 offset:1344
  v_mfma_f32_16x16x32_bf16 v[96:99], a[168:171], v[188:191], v[96:99]
  ds_read_b64_tr_b16 v[224:225], v130 offset:10304
  v_mfma_f32_16x16x32_bf16 v[96:99], a[148:151], v[164:167], v[96:99]
  ds_read_b64_tr_b16 v[226:227], v130 offset:11584
  v_mfma_f32_16x16x32_bf16 v[100:103], a[152:155], v[164:167], v[100:103]
  ds_read_b64_tr_b16 v[208:209], v131 offset:64
  buffer_load_dwordx4 v238, s[8:11], s42 offen offset:2048 lds
  v_mfma_f32_16x16x32_bf16 v[100:103], a[172:175], v[188:191], v[100:103]
  ds_read_b64_tr_b16 v[210:211], v131 offset:1344
  v_mfma_f32_16x16x32_bf16 v[104:107], a[176:179], v[188:191], v[104:107]
  ds_read_b64_tr_b16 v[228:229], v131 offset:10304
  v_mfma_f32_16x16x32_bf16 v[104:107], a[156:159], v[164:167], v[104:107]
  ds_read_b64_tr_b16 v[230:231], v131 offset:11584
  v_mfma_f32_16x16x32_bf16 v[124:127], a[156:159], v[168:171], v[124:127]
  ds_read_b64_tr_b16 v[212:213], v132 offset:0
  v_mfma_f32_16x16x32_bf16 v[124:127], a[176:179], v[192:195], v[124:127]
  ds_read_b64_tr_b16 v[214:215], v132 offset:1280
  buffer_load_dwordx4 v239, s[8:11], s42 offen offset:3072 lds
  v_mfma_f32_16x16x32_bf16 v[120:123], a[172:175], v[192:195], v[120:123]
  ds_read_b64_tr_b16 v[232:233], v132 offset:10240
  v_mfma_f32_16x16x32_bf16 v[120:123], a[152:155], v[168:171], v[120:123]
  ds_read_b64_tr_b16 v[234:235], v132 offset:11520
  v_mfma_f32_16x16x32_bf16 v[116:119], a[148:151], v[168:171], v[116:119]
  v_mfma_f32_16x16x32_bf16 v[116:119], a[168:171], v[192:195], v[116:119]
  s_add_u32 m0, s40, 49152
  v_mfma_f32_16x16x32_bf16 v[112:115], a[164:167], v[192:195], v[112:115]
  buffer_load_dwordx4 v240, s[8:11], s42 offen offset:0 lds
  v_mfma_f32_16x16x32_bf16 v[112:115], a[144:147], v[168:171], v[112:115]
  v_mfma_f32_16x16x32_bf16 v[108:111], a[140:143], v[168:171], v[108:111]
  v_mfma_f32_16x16x32_bf16 v[108:111], a[160:163], v[192:195], v[108:111]
  s_waitcnt lgkmcnt(0)
  v_mfma_f32_16x16x32_bf16 v[8:11], v[196:199], v[148:151], v[8:11]
  ds_read_b128 v[152:155], v128 offset:2048
  v_mfma_f32_16x16x32_bf16 v[8:11], v[216:219], v[172:175], v[8:11]
  ds_read_b128 v[176:179], v129 offset:2048
  buffer_load_dwordx4 v241, s[8:11], s42 offen offset:1024 lds
  v_mfma_f32_16x16x32_bf16 v[12:15], v[220:223], v[172:175], v[12:15]
  ds_read_b128 v[156:159], v128 offset:4096
  ds_read_b64_tr_b16 a[16:17], v1 offset:0
  ds_read_b64_tr_b16 a[18:19], v2 offset:0
  v_mfma_f32_16x16x32_bf16 v[12:15], v[200:203], v[148:151], v[12:15]
  s_cmp_eq_u32 s20, 3
  s_cselect_b32 s28, 896, 0
  v_add_u32 v1, s28, v1
  v_mfma_f32_16x16x32_bf16 v[16:19], v[204:207], v[148:151], v[16:19]
  ds_read_b128 v[180:183], v129 offset:4096
  v_add_u32 v2, s28, v2
  ds_read_b64_tr_b16 a[20:21], v1 offset:32
  v_mfma_f32_16x16x32_bf16 v[16:19], v[224:227], v[172:175], v[16:19]
  ds_read_b128 v[160:163], v128 offset:6144
  s_add_u32 m0, s41, 45056
  ds_read_b64_tr_b16 a[22:23], v2 offset:32
  s_cmp_eq_u32 s20, 2
  s_cselect_b32 s28, 896, 0
  v_mfma_f32_16x16x32_bf16 v[20:23], v[228:231], v[172:175], v[20:23]
  buffer_load_dwordx4 v242, s[12:15], s43 offen offset:0 lds
  v_add_u32 v1, s28, v1
  v_mfma_f32_16x16x32_bf16 v[20:23], v[208:211], v[148:151], v[20:23]
  ds_read_b128 v[184:187], v129 offset:6144
  v_add_u32 v2, s28, v2
  ds_read_b64_tr_b16 a[24:25], v1 offset:64
  v_mfma_f32_16x16x32_bf16 v[24:27], v[212:215], v[148:151], v[24:27]
  ds_read_b128 v[164:167], v128 offset:8192
  ds_read_b64_tr_b16 a[26:27], v2 offset:64
  s_cmp_eq_u32 s20, 1
  s_cselect_b32 s28, 896, 0
  v_mfma_f32_16x16x32_bf16 v[24:27], v[232:235], v[172:175], v[24:27]
  ds_read_b128 v[188:191], v129 offset:8192
  s_waitcnt lgkmcnt(12)
  v_add_u32 v1, s28, v1
  v_add_u32 v2, s28, v2
  v_mfma_f32_16x16x32_bf16 v[44:47], v[232:235], v[176:179], v[44:47]
  ds_read_b64_tr_b16 a[28:29], v1 offset:96
  v_mfma_f32_16x16x32_bf16 v[44:47], v[212:215], v[152:155], v[44:47]
  ds_read_b128 v[168:171], v128 offset:10240
  buffer_load_dwordx4 v243, s[12:15], s43 offen offset:1024 lds
  ds_read_b64_tr_b16 a[30:31], v2 offset:96
  s_cmp_eq_u32 s20, 0
  s_cselect_b32 s28, 896, 0
  v_mfma_f32_16x16x32_bf16 v[40:43], v[208:211], v[152:155], v[40:43]
  ds_read_b128 v[192:195], v129 offset:10240
  v_add_u32 v1, s28, v1
  v_add_u32 v2, s28, v2
  v_mfma_f32_16x16x32_bf16 v[40:43], v[228:231], v[176:179], v[40:43]
  ds_read_b64_tr_b16 a[32:33], v1 offset:128
  ds_read_b64_tr_b16 a[34:35], v2 offset:128
  v_mfma_f32_16x16x32_bf16 v[36:39], v[224:227], v[176:179], v[36:39]
  s_add_u32 s53, s60, 8192
  v_mfma_f32_16x16x32_bf16 v[36:39], v[204:207], v[152:155], v[36:39]
  v_mfma_f32_16x16x32_bf16 v[32:35], v[200:203], v[152:155], v[32:35]
  buffer_load_dwordx4 v244, s[12:15], s43 offen offset:2048 lds
  v_mfma_f32_16x16x32_bf16 v[32:35], v[220:223], v[176:179], v[32:35]
  v_mfma_f32_16x16x32_bf16 v[28:31], v[216:219], v[176:179], v[28:31]
  s_waitcnt lgkmcnt(0)
  v_mfma_f32_16x16x32_bf16 v[28:31], v[196:199], v[152:155], v[28:31]
  s_waitcnt lgkmcnt(14)
  v_mfma_f32_16x16x32_bf16 v[48:51], v[196:199], v[156:159], v[48:51]
  v_mfma_f32_16x16x32_bf16 v[48:51], v[216:219], v[180:183], v[48:51]
  buffer_load_dwordx4 v245, s[12:15], s43 offen offset:3072 lds
  buffer_store_dwordx4 a[16:19], v4, s[16:19], s60 offen offset:0 sc1
  v_mfma_f32_16x16x32_bf16 v[52:55], v[220:223], v[180:183], v[52:55]
  v_mfma_f32_16x16x32_bf16 v[52:55], v[200:203], v[156:159], v[52:55]
  v_mfma_f32_16x16x32_bf16 v[56:59], v[204:207], v[156:159], v[56:59]
  buffer_store_dwordx4 a[20:23], v4, s[16:19], s60 offen offset:1024 sc1
  v_mfma_f32_16x16x32_bf16 v[56:59], v[224:227], v[180:183], v[56:59]
  s_add_u32 m0, s41, 49152
  v_mfma_f32_16x16x32_bf16 v[60:63], v[228:231], v[180:183], v[60:63]
  buffer_load_dwordx4 v246, s[12:15], s43 offen offset:0 lds
  v_mfma_f32_16x16x32_bf16 v[60:63], v[208:211], v[156:159], v[60:63]
  s_cmp_le_u32 s54, 4
  s_cselect_b32 s44, 5, 4
  buffer_store_dwordx4 a[24:27], v4, s[16:19], s60 offen offset:2048 sc1
  v_mfma_f32_16x16x32_bf16 v[64:67], v[212:215], v[156:159], v[64:67]
  s_lshl_b32 s42, s44, 7
  v_mfma_f32_16x16x32_bf16 v[64:67], v[232:235], v[180:183], v[64:67]
  s_mul_i32 s43, s44, s45
  s_waitcnt lgkmcnt(0)
  v_mfma_f32_16x16x32_bf16 v[84:87], v[212:215], v[160:163], v[84:87]
  v_mfma_f32_16x16x32_bf16 v[84:87], v[232:235], v[184:187], v[84:87]
  s_waitcnt vmcnt(14)
  s_barrier
  v_mfma_f32_16x16x32_bf16 v[80:83], v[228:231], v[184:187], v[80:83]
  ds_read_b128 v[148:151], v247 offset:0
  v_mfma_f32_16x16x32_bf16 v[80:83], v[208:211], v[160:163], v[80:83]
  ds_read_b128 v[172:175], v248 offset:0
  v_mfma_f32_16x16x32_bf16 v[76:79], v[204:207], v[160:163], v[76:79]
  ds_read_b64_tr_b16 a[140:141], v249 offset:0
  buffer_store_dwordx4 a[28:31], v4, s[16:19], s60 offen offset:3072 sc1
  v_mfma_f32_16x16x32_bf16 v[76:79], v[224:227], v[184:187], v[76:79]
  ds_read_b64_tr_b16 a[142:143], v249 offset:1280
  s_add_u32 m0, s40, 90112
  v_mfma_f32_16x16x32_bf16 v[72:75], v[220:223], v[184:187], v[72:75]
  ds_read_b64_tr_b16 a[160:161], v249 offset:10240
  buffer_load_dwordx4 v236, s[8:11], s42 offen offset:0 lds
  v_mfma_f32_16x16x32_bf16 v[72:75], v[200:203], v[160:163], v[72:75]
  ds_read_b64_tr_b16 a[162:163], v249 offset:11520
  v_mfma_f32_16x16x32_bf16 v[68:71], v[196:199], v[160:163], v[68:71]
  ds_read_b64_tr_b16 a[144:145], v250 offset:0
  v_mfma_f32_16x16x32_bf16 v[68:71], v[216:219], v[184:187], v[68:71]
  ds_read_b64_tr_b16 a[146:147], v250 offset:1280
  v_mfma_f32_16x16x32_bf16 v[88:91], v[216:219], v[188:191], v[88:91]
  ds_read_b64_tr_b16 a[164:165], v250 offset:10240
  v_mfma_f32_16x16x32_bf16 v[88:91], v[196:199], v[164:167], v[88:91]
  ds_read_b64_tr_b16 a[166:167], v250 offset:11520
  buffer_load_dwordx4 v237, s[8:11], s42 offen offset:1024 lds
  v_mfma_f32_16x16x32_bf16 v[92:95], v[200:203], v[164:167], v[92:95]
  ds_read_b64_tr_b16 a[148:149], v249 offset:64
  buffer_store_dwordx4 a[32:35], v5, s[16:19], s60 offen offset:0 sc1
  v_mfma_f32_16x16x32_bf16 v[92:95], v[220:223], v[188:191], v[92:95]
  ds_read_b64_tr_b16 a[150:151], v249 offset:1344
  v_mfma_f32_16x16x32_bf16 v[96:99], v[224:227], v[188:191], v[96:99]
  ds_read_b64_tr_b16 a[168:169], v249 offset:10304
  v_mfma_f32_16x16x32_bf16 v[96:99], v[204:207], v[164:167], v[96:99]
  ds_read_b64_tr_b16 a[170:171], v249 offset:11584
  v_mfma_f32_16x16x32_bf16 v[100:103], v[208:211], v[164:167], v[100:103]
  ds_read_b64_tr_b16 a[152:153], v250 offset:64
  buffer_load_dwordx4 v238, s[8:11], s42 offen offset:2048 lds
  v_mfma_f32_16x16x32_bf16 v[100:103], v[228:231], v[188:191], v[100:103]
  ds_read_b64_tr_b16 a[154:155], v250 offset:1344
  v_mfma_f32_16x16x32_bf16 v[104:107], v[232:235], v[188:191], v[104:107]
  ds_read_b64_tr_b16 a[172:173], v250 offset:10304
  v_mfma_f32_16x16x32_bf16 v[104:107], v[212:215], v[164:167], v[104:107]
  ds_read_b64_tr_b16 a[174:175], v250 offset:11584
  v_mfma_f32_16x16x32_bf16 v[124:127], v[212:215], v[168:171], v[124:127]
  ds_read_b64_tr_b16 a[156:157], v251 offset:0
  v_mfma_f32_16x16x32_bf16 v[124:127], v[232:235], v[192:195], v[124:127]
  ds_read_b64_tr_b16 a[158:159], v251 offset:1280
  buffer_load_dwordx4 v239, s[8:11], s42 offen offset:3072 lds
  v_mfma_f32_16x16x32_bf16 v[120:123], v[228:231], v[192:195], v[120:123]
  ds_read_b64_tr_b16 a[176:177], v251 offset:10240
  v_mfma_f32_16x16x32_bf16 v[120:123], v[208:211], v[168:171], v[120:123]
  ds_read_b64_tr_b16 a[178:179], v251 offset:11520
  v_mfma_f32_16x16x32_bf16 v[116:119], v[204:207], v[168:171], v[116:119]
  v_mfma_f32_16x16x32_bf16 v[116:119], v[224:227], v[192:195], v[116:119]
  s_add_u32 m0, s40, 94208
  v_mfma_f32_16x16x32_bf16 v[112:115], v[220:223], v[192:195], v[112:115]
  buffer_load_dwordx4 v240, s[8:11], s42 offen offset:0 lds
  v_mfma_f32_16x16x32_bf16 v[112:115], v[200:203], v[168:171], v[112:115]
  v_mfma_f32_16x16x32_bf16 v[108:111], v[196:199], v[168:171], v[108:111]
  v_mfma_f32_16x16x32_bf16 v[108:111], v[216:219], v[192:195], v[108:111]
  s_waitcnt lgkmcnt(0)
  v_mfma_f32_16x16x32_bf16 v[8:11], a[140:143], v[148:151], v[8:11]
  ds_read_b128 v[152:155], v247 offset:2048
  v_mfma_f32_16x16x32_bf16 v[8:11], a[160:163], v[172:175], v[8:11]
  ds_read_b128 v[176:179], v248 offset:2048
  buffer_load_dwordx4 v241, s[8:11], s42 offen offset:1024 lds
  v_mfma_f32_16x16x32_bf16 v[12:15], a[164:167], v[172:175], v[12:15]
  ds_read_b128 v[156:159], v247 offset:4096
  v_mfma_f32_16x16x32_bf16 v[12:15], a[144:147], v[148:151], v[12:15]
  v_mfma_f32_16x16x32_bf16 v[16:19], a[148:151], v[148:151], v[16:19]
  ds_read_b128 v[180:183], v248 offset:4096
  v_mfma_f32_16x16x32_bf16 v[16:19], a[168:171], v[172:175], v[16:19]
  ds_read_b128 v[160:163], v247 offset:6144
  s_add_u32 m0, s41, 90112
  v_mfma_f32_16x16x32_bf16 v[20:23], a[172:175], v[172:175], v[20:23]
  buffer_load_dwordx4 v242, s[12:15], s43 offen offset:0 lds
  v_mfma_f32_16x16x32_bf16 v[20:23], a[152:155], v[148:151], v[20:23]
  ds_read_b128 v[184:187], v248 offset:6144
  v_mfma_f32_16x16x32_bf16 v[24:27], a[156:159], v[148:151], v[24:27]
  ds_read_b128 v[164:167], v247 offset:8192
  v_mfma_f32_16x16x32_bf16 v[24:27], a[176:179], v[172:175], v[24:27]
  ds_read_b128 v[188:191], v248 offset:8192
  s_waitcnt lgkmcnt(6)
  v_mfma_f32_16x16x32_bf16 v[44:47], a[176:179], v[176:179], v[44:47]
  v_mfma_f32_16x16x32_bf16 v[44:47], a[156:159], v[152:155], v[44:47]
  ds_read_b128 v[168:171], v247 offset:10240
  buffer_load_dwordx4 v243, s[12:15], s43 offen offset:1024 lds
  v_mfma_f32_16x16x32_bf16 v[40:43], a[152:155], v[152:155], v[40:43]
  ds_read_b128 v[192:195], v248 offset:10240
  v_mfma_f32_16x16x32_bf16 v[40:43], a[172:175], v[176:179], v[40:43]
  v_mfma_f32_16x16x32_bf16 v[36:39], a[168:171], v[176:179], v[36:39]
  v_mfma_f32_16x16x32_bf16 v[36:39], a[148:151], v[152:155], v[36:39]
  v_mfma_f32_16x16x32_bf16 v[32:35], a[144:147], v[152:155], v[32:35]
  buffer_load_dwordx4 v244, s[12:15], s43 offen offset:2048 lds
  v_mfma_f32_16x16x32_bf16 v[32:35], a[164:167], v[176:179], v[32:35]
  v_mfma_f32_16x16x32_bf16 v[28:31], a[160:163], v[176:179], v[28:31]
  v_mfma_f32_16x16x32_bf16 v[28:31], a[140:143], v[152:155], v[28:31]
  s_waitcnt lgkmcnt(6)
  v_mfma_f32_16x16x32_bf16 v[48:51], a[140:143], v[156:159], v[48:51]
  v_mfma_f32_16x16x32_bf16 v[48:51], a[160:163], v[180:183], v[48:51]
  buffer_load_dwordx4 v245, s[12:15], s43 offen offset:3072 lds
  v_mfma_f32_16x16x32_bf16 v[52:55], a[164:167], v[180:183], v[52:55]
  v_mfma_f32_16x16x32_bf16 v[52:55], a[144:147], v[156:159], v[52:55]
  v_mfma_f32_16x16x32_bf16 v[56:59], a[148:151], v[156:159], v[56:59]
  v_mfma_f32_16x16x32_bf16 v[56:59], a[168:171], v[180:183], v[56:59]
  s_add_u32 m0, s41, 94208
  v_mfma_f32_16x16x32_bf16 v[60:63], a[172:175], v[180:183], v[60:63]
  buffer_load_dwordx4 v246, s[12:15], s43 offen offset:0 lds
  v_mfma_f32_16x16x32_bf16 v[60:63], a[152:155], v[156:159], v[60:63]
  s_cmp_le_u32 s54, 5
  s_cselect_b32 s44, 6, 5
  v_mfma_f32_16x16x32_bf16 v[64:67], a[156:159], v[156:159], v[64:67]
  s_lshl_b32 s42, s44, 7
  v_mfma_f32_16x16x32_bf16 v[64:67], a[176:179], v[180:183], v[64:67]
  s_mul_i32 s43, s44, s45
  s_waitcnt lgkmcnt(0)
  v_mfma_f32_16x16x32_bf16 v[84:87], a[156:159], v[160:163], v[84:87]
  v_mfma_f32_16x16x32_bf16 v[84:87], a[176:179], v[184:187], v[84:87]
  s_waitcnt vmcnt(9)
  s_barrier
  v_mfma_f32_16x16x32_bf16 v[80:83], a[172:175], v[184:187], v[80:83]
  ds_read_b128 v[148:151], v247 offset:45056
  v_mov_b32 v3, s39
  v_mfma_f32_16x16x32_bf16 v[80:83], a[152:155], v[160:163], v[80:83]
  ds_read_b128 v[172:175], v248 offset:45056
  v_lshlrev_b32 v6, 25, v7
  v_mfma_f32_16x16x32_bf16 v[76:79], a[148:151], v[160:163], v[76:79]
  ds_read_b64_tr_b16 v[196:197], v249 offset:45056
  buffer_store_dword v3, v6, s[16:19], s49 offen sc1
  v_mfma_f32_16x16x32_bf16 v[76:79], a[168:171], v[184:187], v[76:79]
  ds_read_b64_tr_b16 v[198:199], v249 offset:46336
  s_add_u32 m0, s40, 0
  v_mfma_f32_16x16x32_bf16 v[72:75], a[164:167], v[184:187], v[72:75]
  ds_read_b64_tr_b16 v[216:217], v249 offset:55296
  buffer_load_dwordx4 v236, s[8:11], s42 offen offset:0 lds
  v_mfma_f32_16x16x32_bf16 v[72:75], a[144:147], v[160:163], v[72:75]
  ds_read_b64_tr_b16 v[218:219], v249 offset:56576
  v_mfma_f32_16x16x32_bf16 v[68:71], a[140:143], v[160:163], v[68:71]
  ds_read_b64_tr_b16 v[200:201], v250 offset:45056
  v_mfma_f32_16x16x32_bf16 v[68:71], a[160:163], v[184:187], v[68:71]
  ds_read_b64_tr_b16 v[202:203], v250 offset:46336
  v_mfma_f32_16x16x32_bf16 v[88:91], a[160:163], v[188:191], v[88:91]
  ds_read_b64_tr_b16 v[220:221], v250 offset:55296
  v_mfma_f32_16x16x32_bf16 v[88:91], a[140:143], v[164:167], v[88:91]
  ds_read_b64_tr_b16 v[222:223], v250 offset:56576
  buffer_load_dwordx4 v237, s[8:11], s42 offen offset:1024 lds
  v_mfma_f32_16x16x32_bf16 v[92:95], a[144:147], v[164:167], v[92:95]
  ds_read_b64_tr_b16 v[204:205], v249 offset:45120
  v_mfma_f32_16x16x32_bf16 v[92:95], a[164:167], v[188:191], v[92:95]
  ds_read_b64_tr_b16 v[206:207], v249 offset:46400
  v_mfma_f32_16x16x32_bf16 v[96:99], a[168:171], v[188:191], v[96:99]
  ds_read_b64_tr_b16 v[224:225], v249 offset:55360
  v_mfma_f32_16x16x32_bf16 v[96:99], a[148:151], v[164:167], v[96:99]
  ds_read_b64_tr_b16 v[226:227], v249 offset:56640
  v_mfma_f32_16x16x32_bf16 v[100:103], a[152:155], v[164:167], v[100:103]
  ds_read_b64_tr_b16 v[208:209], v250 offset:45120
  buffer_load_dwordx4 v238, s[8:11], s42 offen offset:2048 lds
  v_mfma_f32_16x16x32_bf16 v[100:103], a[172:175], v[188:191], v[100:103]
  ds_read_b64_tr_b16 v[210:211], v250 offset:46400
  v_mfma_f32_16x16x32_bf16 v[104:107], a[176:179], v[188:191], v[104:107]
  ds_read_b64_tr_b16 v[228:229], v250 offset:55360
  v_mfma_f32_16x16x32_bf16 v[104:107], a[156:159], v[164:167], v[104:107]
  ds_read_b64_tr_b16 v[230:231], v250 offset:56640
  v_mfma_f32_16x16x32_bf16 v[124:127], a[156:159], v[168:171], v[124:127]
  ds_read_b64_tr_b16 v[212:213], v251 offset:45056
  v_mfma_f32_16x16x32_bf16 v[124:127], a[176:179], v[192:195], v[124:127]
  ds_read_b64_tr_b16 v[214:215], v251 offset:46336
  buffer_load_dwordx4 v239, s[8:11], s42 offen offset:3072 lds
  v_mfma_f32_16x16x32_bf16 v[120:123], a[172:175], v[192:195], v[120:123]
  ds_read_b64_tr_b16 v[232:233], v251 offset:55296
  v_mfma_f32_16x16x32_bf16 v[120:123], a[152:155], v[168:171], v[120:123]
  ds_read_b64_tr_b16 v[234:235], v251 offset:56576
  v_mfma_f32_16x16x32_bf16 v[116:119], a[148:151], v[168:171], v[116:119]
  v_mfma_f32_16x16x32_bf16 v[116:119], a[168:171], v[192:195], v[116:119]
  s_add_u32 m0, s40, 4096
  v_mfma_f32_16x16x32_bf16 v[112:115], a[164:167], v[192:195], v[112:115]
  buffer_load_dwordx4 v240, s[8:11], s42 offen offset:0 lds
  v_mfma_f32_16x16x32_bf16 v[112:115], a[144:147], v[168:171], v[112:115]
  v_mfma_f32_16x16x32_bf16 v[108:111], a[140:143], v[168:171], v[108:111]
  v_mfma_f32_16x16x32_bf16 v[108:111], a[160:163], v[192:195], v[108:111]
  s_waitcnt lgkmcnt(0)
  v_mfma_f32_16x16x32_bf16 v[8:11], v[196:199], v[148:151], v[8:11]
  ds_read_b128 v[152:155], v247 offset:47104
  v_mfma_f32_16x16x32_bf16 v[8:11], v[216:219], v[172:175], v[8:11]
  ds_read_b128 v[176:179], v248 offset:47104
  buffer_load_dwordx4 v241, s[8:11], s42 offen offset:1024 lds
  v_mfma_f32_16x16x32_bf16 v[12:15], v[220:223], v[172:175], v[12:15]
  ds_read_b128 v[156:159], v247 offset:49152
  v_mfma_f32_16x16x32_bf16 v[12:15], v[200:203], v[148:151], v[12:15]
  v_mfma_f32_16x16x32_bf16 v[16:19], v[204:207], v[148:151], v[16:19]
  ds_read_b128 v[180:183], v248 offset:49152
  v_mfma_f32_16x16x32_bf16 v[16:19], v[224:227], v[172:175], v[16:19]
  ds_read_b128 v[160:163], v247 offset:51200
  s_add_u32 m0, s41, 0
  v_mfma_f32_16x16x32_bf16 v[20:23], v[228:231], v[172:175], v[20:23]
  buffer_load_dwordx4 v242, s[12:15], s43 offen offset:0 lds
  v_mfma_f32_16x16x32_bf16 v[20:23], v[208:211], v[148:151], v[20:23]
  ds_read_b128 v[184:187], v248 offset:51200
  v_mfma_f32_16x16x32_bf16 v[24:27], v[212:215], v[148:151], v[24:27]
  ds_read_b128 v[164:167], v247 offset:53248
  v_mfma_f32_16x16x32_bf16 v[24:27], v[232:235], v[172:175], v[24:27]
  ds_read_b128 v[188:191], v248 offset:53248
  s_waitcnt lgkmcnt(6)
  v_mfma_f32_16x16x32_bf16 v[44:47], v[232:235], v[176:179], v[44:47]
  v_mfma_f32_16x16x32_bf16 v[44:47], v[212:215], v[152:155], v[44:47]
  ds_read_b128 v[168:171], v247 offset:55296
  buffer_load_dwordx4 v243, s[12:15], s43 offen offset:1024 lds
  v_mfma_f32_16x16x32_bf16 v[40:43], v[208:211], v[152:155], v[40:43]
  ds_read_b128 v[192:195], v248 offset:55296
  v_mfma_f32_16x16x32_bf16 v[40:43], v[228:231], v[176:179], v[40:43]
  v_mfma_f32_16x16x32_bf16 v[36:39], v[224:227], v[176:179], v[36:39]
  v_mfma_f32_16x16x32_bf16 v[36:39], v[204:207], v[152:155], v[36:39]
  v_mfma_f32_16x16x32_bf16 v[32:35], v[200:203], v[152:155], v[32:35]
  buffer_load_dwordx4 v244, s[12:15], s43 offen offset:2048 lds
  v_mfma_f32_16x16x32_bf16 v[32:35], v[220:223], v[176:179], v[32:35]
  v_mfma_f32_16x16x32_bf16 v[28:31], v[216:219], v[176:179], v[28:31]
  v_mfma_f32_16x16x32_bf16 v[28:31], v[196:199], v[152:155], v[28:31]
  s_waitcnt lgkmcnt(6)
  v_mfma_f32_16x16x32_bf16 v[48:51], v[196:199], v[156:159], v[48:51]
  v_mfma_f32_16x16x32_bf16 v[48:51], v[216:219], v[180:183], v[48:51]
  buffer_load_dwordx4 v245, s[12:15], s43 offen offset:3072 lds
  v_mfma_f32_16x16x32_bf16 v[52:55], v[220:223], v[180:183], v[52:55]
  v_mfma_f32_16x16x32_bf16 v[52:55], v[200:203], v[156:159], v[52:55]
  v_mfma_f32_16x16x32_bf16 v[56:59], v[204:207], v[156:159], v[56:59]
  v_mfma_f32_16x16x32_bf16 v[56:59], v[224:227], v[180:183], v[56:59]
  s_add_u32 m0, s41, 4096
  v_mfma_f32_16x16x32_bf16 v[60:63], v[228:231], v[180:183], v[60:63]
  buffer_load_dwordx4 v246, s[12:15], s43 offen offset:0 lds
  v_mfma_f32_16x16x32_bf16 v[60:63], v[208:211], v[156:159], v[60:63]
  s_cmp_le_u32 s54, 6
  s_cselect_b32 s44, 7, 6
  v_mfma_f32_16x16x32_bf16 v[64:67], v[212:215], v[156:159], v[64:67]
  s_lshl_b32 s42, s44, 7
  v_mfma_f32_16x16x32_bf16 v[64:67], v[232:235], v[180:183], v[64:67]
  s_mul_i32 s43, s44, s45
  s_waitcnt lgkmcnt(0)
  v_mfma_f32_16x16x32_bf16 v[84:87], v[212:215], v[160:163], v[84:87]
  v_mfma_f32_16x16x32_bf16 v[84:87], v[232:235], v[184:187], v[84:87]
  s_waitcnt vmcnt(12)
  s_barrier
  v_mfma_f32_16x16x32_bf16 v[80:83], v[228:231], v[184:187], v[80:83]
  ds_read_b128 v[148:151], v128 offset:0
  v_mfma_f32_16x16x32_bf16 v[80:83], v[208:211], v[160:163], v[80:83]
  ds_read_b128 v[172:175], v129 offset:0
  v_mfma_f32_16x16x32_bf16 v[76:79], v[204:207], v[160:163], v[76:79]
  ds_read_b64_tr_b16 a[140:141], v130 offset:0
  v_mfma_f32_16x16x32_bf16 v[76:79], v[224:227], v[184:187], v[76:79]
  ds_read_b64_tr_b16 a[142:143], v130 offset:1280
  s_add_u32 m0, s40, 45056
  v_mfma_f32_16x16x32_bf16 v[72:75], v[220:223], v[184:187], v[72:75]
  ds_read_b64_tr_b16 a[160:161], v130 offset:10240
  buffer_load_dwordx4 v236, s[8:11], s42 offen offset:0 lds
  v_mfma_f32_16x16x32_bf16 v[72:75], v[200:203], v[160:163], v[72:75]
  ds_read_b64_tr_b16 a[162:163], v130 offset:11520
  v_mfma_f32_16x16x32_bf16 v[68:71], v[196:199], v[160:163], v[68:71]
  ds_read_b64_tr_b16 a[144:145], v131 offset:0
  v_mfma_f32_16x16x32_bf16 v[68:71], v[216:219], v[184:187], v[68:71]
  ds_read_b64_tr_b16 a[146:147], v131 offset:1280
  v_mfma_f32_16x16x32_bf16 v[88:91], v[216:219], v[188:191], v[88:91]
  ds_read_b64_tr_b16 a[164:165], v131 offset:10240
  v_mfma_f32_16x16x32_bf16 v[88:91], v[196:199], v[164:167], v[88:91]
  ds_read_b64_tr_b16 a[166:167], v131 offset:11520
  buffer_load_dwordx4 v237, s[8:11], s42 offen offset:1024 lds
  v_mfma_f32_16x16x32_bf16 v[92:95], v[200:203], v[164:167], v[92:95]
  ds_read_b64_tr_b16 a[148:149], v130 offset:64
  v_mfma_f32_16x16x32_bf16 v[92:95], v[220:223], v[188:191], v[92:95]
  ds_read_b64_tr_b16 a[150:151], v130 offset:1344
  v_mfma_f32_16x16x32_bf16 v[96:99], v[224:227], v[188:191], v[96:99]
  ds_read_b64_tr_b16 a[168:169], v130 offset:10304
  v_mfma_f32_16x16x32_bf16 v[96:99], v[204:207], v[164:167], v[96:99]
  ds_read_b64_tr_b16 a[170:171], v130 offset:11584
  v_mfma_f32_16x16x32_bf16 v[100:103], v[208:211], v[164:167], v[100:103]
  ds_read_b64_tr_b16 a[152:153], v131 offset:64
  buffer_load_dwordx4 v238, s[8:11], s42 offen offset:2048 lds
  v_mfma_f32_16x16x32_bf16 v[100:103], v[228:231], v[188:191], v[100:103]
  ds_read_b64_tr_b16 a[154:155], v131 offset:1344
  v_mfma_f32_16x16x32_bf16 v[104:107], v[232:235], v[188:191], v[104:107]
  ds_read_b64_tr_b16 a[172:173], v131 offset:10304
  v_mfma_f32_16x16x32_bf16 v[104:107], v[212:215], v[164:167], v[104:107]
  ds_read_b64_tr_b16 a[174:175], v131 offset:11584
  v_mfma_f32_16x16x32_bf16 v[124:127], v[212:215], v[168:171], v[124:127]
  ds_read_b64_tr_b16 a[156:157], v132 offset:0
  v_mfma_f32_16x16x32_bf16 v[124:127], v[232:235], v[192:195], v[124:127]
  ds_read_b64_tr_b16 a[158:159], v132 offset:1280
  buffer_load_dwordx4 v239, s[8:11], s42 offen offset:3072 lds
  v_mfma_f32_16x16x32_bf16 v[120:123], v[228:231], v[192:195], v[120:123]
  ds_read_b64_tr_b16 a[176:177], v132 offset:10240
  v_mfma_f32_16x16x32_bf16 v[120:123], v[208:211], v[168:171], v[120:123]
  ds_read_b64_tr_b16 a[178:179], v132 offset:11520
  v_mfma_f32_16x16x32_bf16 v[116:119], v[204:207], v[168:171], v[116:119]
  v_mfma_f32_16x16x32_bf16 v[116:119], v[224:227], v[192:195], v[116:119]
  s_add_u32 m0, s40, 49152
  v_mfma_f32_16x16x32_bf16 v[112:115], v[220:223], v[192:195], v[112:115]
  buffer_load_dwordx4 v240, s[8:11], s42 offen offset:0 lds
  v_mfma_f32_16x16x32_bf16 v[112:115], v[200:203], v[168:171], v[112:115]
  v_mfma_f32_16x16x32_bf16 v[108:111], v[196:199], v[168:171], v[108:111]
  v_mfma_f32_16x16x32_bf16 v[108:111], v[216:219], v[192:195], v[108:111]
  s_waitcnt lgkmcnt(0)
  v_mfma_f32_16x16x32_bf16 v[8:11], a[140:143], v[148:151], v[8:11]
  ds_read_b128 v[152:155], v128 offset:2048
  v_mfma_f32_16x16x32_bf16 v[8:11], a[160:163], v[172:175], v[8:11]
  ds_read_b128 v[176:179], v129 offset:2048
  buffer_load_dwordx4 v241, s[8:11], s42 offen offset:1024 lds
  v_mfma_f32_16x16x32_bf16 v[12:15], a[164:167], v[172:175], v[12:15]
  ds_read_b128 v[156:159], v128 offset:4096
  v_mfma_f32_16x16x32_bf16 v[12:15], a[144:147], v[148:151], v[12:15]
  v_mfma_f32_16x16x32_bf16 v[16:19], a[148:151], v[148:151], v[16:19]
  ds_read_b128 v[180:183], v129 offset:4096
  v_mfma_f32_16x16x32_bf16 v[16:19], a[168:171], v[172:175], v[16:19]
  ds_read_b128 v[160:163], v128 offset:6144
  s_add_u32 m0, s41, 45056
  v_mfma_f32_16x16x32_bf16 v[20:23], a[172:175], v[172:175], v[20:23]
  buffer_load_dwordx4 v242, s[12:15], s43 offen offset:0 lds
  v_mfma_f32_16x16x32_bf16 v[20:23], a[152:155], v[148:151], v[20:23]
  ds_read_b128 v[184:187], v129 offset:6144
  v_mfma_f32_16x16x32_bf16 v[24:27], a[156:159], v[148:151], v[24:27]
  ds_read_b128 v[164:167], v128 offset:8192
  v_mfma_f32_16x16x32_bf16 v[24:27], a[176:179], v[172:175], v[24:27]
  ds_read_b128 v[188:191], v129 offset:8192
  s_waitcnt lgkmcnt(6)
  v_mfma_f32_16x16x32_bf16 v[44:47], a[176:179], v[176:179], v[44:47]
  v_mfma_f32_16x16x32_bf16 v[44:47], a[156:159], v[152:155], v[44:47]
  ds_read_b128 v[168:171], v128 offset:10240
  buffer_load_dwordx4 v243, s[12:15], s43 offen offset:1024 lds
  v_mfma_f32_16x16x32_bf16 v[40:43], a[152:155], v[152:155], v[40:43]
  ds_read_b128 v[192:195], v129 offset:10240
  v_mfma_f32_16x16x32_bf16 v[40:43], a[172:175], v[176:179], v[40:43]
  v_mfma_f32_16x16x32_bf16 v[36:39], a[168:171], v[176:179], v[36:39]
  v_mfma_f32_16x16x32_bf16 v[36:39], a[148:151], v[152:155], v[36:39]
  v_mfma_f32_16x16x32_bf16 v[32:35], a[144:147], v[152:155], v[32:35]
  buffer_load_dwordx4 v244, s[12:15], s43 offen offset:2048 lds
  v_mfma_f32_16x16x32_bf16 v[32:35], a[164:167], v[176:179], v[32:35]
  v_mfma_f32_16x16x32_bf16 v[28:31], a[160:163], v[176:179], v[28:31]
  v_mfma_f32_16x16x32_bf16 v[28:31], a[140:143], v[152:155], v[28:31]
  s_waitcnt lgkmcnt(6)
  v_mfma_f32_16x16x32_bf16 v[48:51], a[140:143], v[156:159], v[48:51]
  v_mfma_f32_16x16x32_bf16 v[48:51], a[160:163], v[180:183], v[48:51]
  buffer_load_dwordx4 v245, s[12:15], s43 offen offset:3072 lds
  v_mfma_f32_16x16x32_bf16 v[52:55], a[164:167], v[180:183], v[52:55]
  v_mfma_f32_16x16x32_bf16 v[52:55], a[144:147], v[156:159], v[52:55]
  v_mfma_f32_16x16x32_bf16 v[56:59], a[148:151], v[156:159], v[56:59]
  v_mfma_f32_16x16x32_bf16 v[56:59], a[168:171], v[180:183], v[56:59]
  s_add_u32 m0, s41, 49152
  v_mfma_f32_16x16x32_bf16 v[60:63], a[172:175], v[180:183], v[60:63]
  buffer_load_dwordx4 v246, s[12:15], s43 offen offset:0 lds
  v_mfma_f32_16x16x32_bf16 v[60:63], a[152:155], v[156:159], v[60:63]
  s_cmp_le_u32 s54, 7
  s_cselect_b32 s44, 8, 7
  v_mfma_f32_16x16x32_bf16 v[64:67], a[156:159], v[156:159], v[64:67]
  s_lshl_b32 s42, s44, 7
  v_mfma_f32_16x16x32_bf16 v[64:67], a[176:179], v[180:183], v[64:67]
  s_mul_i32 s43, s44, s45
  s_waitcnt lgkmcnt(0)
  v_mfma_f32_16x16x32_bf16 v[84:87], a[156:159], v[160:163], v[84:87]
  v_mfma_f32_16x16x32_bf16 v[84:87], a[176:179], v[184:187], v[84:87]
  s_waitcnt vmcnt(11)
  s_barrier
  v_mfma_f32_16x16x32_bf16 v[80:83], a[172:175], v[184:187], v[80:83]
  ds_read_b128 v[148:151], v247 offset:0
  v_mfma_f32_16x16x32_bf16 v[80:83], a[152:155], v[160:163], v[80:83]
  ds_read_b128 v[172:175], v248 offset:0
  v_mfma_f32_16x16x32_bf16 v[76:79], a[148:151], v[160:163], v[76:79]
  ds_read_b64_tr_b16 v[196:197], v249 offset:0
  v_mfma_f32_16x16x32_bf16 v[76:79], a[168:171], v[184:187], v[76:79]
  ds_read_b64_tr_b16 v[198:199], v249 offset:1280
  s_add_u32 m0, s40, 90112
  v_mfma_f32_16x16x32_bf16 v[72:75], a[164:167], v[184:187], v[72:75]
  ds_read_b64_tr_b16 v[216:217], v249 offset:10240
  buffer_load_dwordx4 v236, s[8:11], s42 offen offset:0 lds
  v_mfma_f32_16x16x32_bf16 v[72:75], a[144:147], v[160:163], v[72:75]
  ds_read_b64_tr_b16 v[218:219], v249 offset:11520
  v_mfma_f32_16x16x32_bf16 v[68:71], a[140:143], v[160:163], v[68:71]
  ds_read_b64_tr_b16 v[200:201], v250 offset:0
  v_mfma_f32_16x16x32_bf16 v[68:71], a[160:163], v[184:187], v[68:71]
  ds_read_b64_tr_b16 v[202:203], v250 offset:1280
  v_mfma_f32_16x16x32_bf16 v[88:91], a[160:163], v[188:191], v[88:91]
  ds_read_b64_tr_b16 v[220:221], v250 offset:10240
  v_mfma_f32_16x16x32_bf16 v[88:91], a[140:143], v[164:167], v[88:91]
  ds_read_b64_tr_b16 v[222:223], v250 offset:11520
  buffer_load_dwordx4 v237, s[8:11], s42 offen offset:1024 lds
  v_mfma_f32_16x16x32_bf16 v[92:95], a[144:147], v[164:167], v[92:95]
  ds_read_b64_tr_b16 v[204:205], v249 offset:64
  v_mfma_f32_16x16x32_bf16 v[92:95], a[164:167], v[188:191], v[92:95]
  ds_read_b64_tr_b16 v[206:207], v249 offset:1344
  v_mfma_f32_16x16x32_bf16 v[96:99], a[168:171], v[188:191], v[96:99]
  ds_read_b64_tr_b16 v[224:225], v249 offset:10304
  v_mfma_f32_16x16x32_bf16 v[96:99], a[148:151], v[164:167], v[96:99]
  ds_read_b64_tr_b16 v[226:227], v249 offset:11584
  v_mfma_f32_16x16x32_bf16 v[100:103], a[152:155], v[164:167], v[100:103]
  ds_read_b64_tr_b16 v[208:209], v250 offset:64
  buffer_load_dwordx4 v238, s[8:11], s42 offen offset:2048 lds
  v_mfma_f32_16x16x32_bf16 v[100:103], a[172:175], v[188:191], v[100:103]
  ds_read_b64_tr_b16 v[210:211], v250 offset:1344
  v_mfma_f32_16x16x32_bf16 v[104:107], a[176:179], v[188:191], v[104:107]
  ds_read_b64_tr_b16 v[228:229], v250 offset:10304
  v_mfma_f32_16x16x32_bf16 v[104:107], a[156:159], v[164:167], v[104:107]
  ds_read_b64_tr_b16 v[230:231], v250 offset:11584
  v_mfma_f32_16x16x32_bf16 v[124:127], a[156:159], v[168:171], v[124:127]
  ds_read_b64_tr_b16 v[212:213], v251 offset:0
  v_mfma_f32_16x16x32_bf16 v[124:127], a[176:179], v[192:195], v[124:127]
  ds_read_b64_tr_b16 v[214:215], v251 offset:1280
  buffer_load_dwordx4 v239, s[8:11], s42 offen offset:3072 lds
  v_mfma_f32_16x16x32_bf16 v[120:123], a[172:175], v[192:195], v[120:123]
  ds_read_b64_tr_b16 v[232:233], v251 offset:10240
  v_mfma_f32_16x16x32_bf16 v[120:123], a[152:155], v[168:171], v[120:123]
  ds_read_b64_tr_b16 v[234:235], v251 offset:11520
  v_mfma_f32_16x16x32_bf16 v[116:119], a[148:151], v[168:171], v[116:119]
  v_mfma_f32_16x16x32_bf16 v[116:119], a[168:171], v[192:195], v[116:119]
  s_add_u32 m0, s40, 94208
  v_mfma_f32_16x16x32_bf16 v[112:115], a[164:167], v[192:195], v[112:115]
  buffer_load_dwordx4 v240, s[8:11], s42 offen offset:0 lds
  v_mfma_f32_16x16x32_bf16 v[112:115], a[144:147], v[168:171], v[112:115]
  v_mfma_f32_16x16x32_bf16 v[108:111], a[140:143], v[168:171], v[108:111]
  v_mfma_f32_16x16x32_bf16 v[108:111], a[160:163], v[192:195], v[108:111]
  s_waitcnt lgkmcnt(0)
  v_mfma_f32_16x16x32_bf16 v[8:11], v[196:199], v[148:151], v[8:11]
  ds_read_b128 v[152:155], v247 offset:2048
  v_mfma_f32_16x16x32_bf16 v[8:11], v[216:219], v[172:175], v[8:11]
  ds_read_b128 v[176:179], v248 offset:2048
  buffer_load_dwordx4 v241, s[8:11], s42 offen offset:1024 lds
  v_mfma_f32_16x16x32_bf16 v[12:15], v[220:223], v[172:175], v[12:15]
  ds_read_b128 v[156:159], v247 offset:4096
  v_mfma_f32_16x16x32_bf16 v[12:15], v[200:203], v[148:151], v[12:15]
  v_mfma_f32_16x16x32_bf16 v[16:19], v[204:207], v[148:151], v[16:19]
  ds_read_b128 v[180:183], v248 offset:4096
  v_mfma_f32_16x16x32_bf16 v[16:19], v[224:227], v[172:175], v[16:19]
  ds_read_b128 v[160:163], v247 offset:6144
  s_add_u32 m0, s41, 90112
  v_mfma_f32_16x16x32_bf16 v[20:23], v[228:231], v[172:175], v[20:23]
  buffer_load_dwordx4 v242, s[12:15], s43 offen offset:0 lds
  v_mfma_f32_16x16x32_bf16 v[20:23], v[208:211], v[148:151], v[20:23]
  ds_read_b128 v[184:187], v248 offset:6144
  v_mfma_f32_16x16x32_bf16 v[24:27], v[212:215], v[148:151], v[24:27]
  ds_read_b128 v[164:167], v247 offset:8192
  v_mfma_f32_16x16x32_bf16 v[24:27], v[232:235], v[172:175], v[24:27]
  ds_read_b128 v[188:191], v248 offset:8192
  s_waitcnt lgkmcnt(6)
  v_mfma_f32_16x16x32_bf16 v[44:47], v[232:235], v[176:179], v[44:47]
  v_mfma_f32_16x16x32_bf16 v[44:47], v[212:215], v[152:155], v[44:47]
  ds_read_b128 v[168:171], v247 offset:10240
  buffer_load_dwordx4 v243, s[12:15], s43 offen offset:1024 lds
  v_mfma_f32_16x16x32_bf16 v[40:43], v[208:211], v[152:155], v[40:43]
  ds_read_b128 v[192:195], v248 offset:10240
  v_mfma_f32_16x16x32_bf16 v[40:43], v[228:231], v[176:179], v[40:43]
  v_mfma_f32_16x16x32_bf16 v[36:39], v[224:227], v[176:179], v[36:39]
  v_mfma_f32_16x16x32_bf16 v[36:39], v[204:207], v[152:155], v[36:39]
  v_mfma_f32_16x16x32_bf16 v[32:35], v[200:203], v[152:155], v[32:35]
  buffer_load_dwordx4 v244, s[12:15], s43 offen offset:2048 lds
  v_mfma_f32_16x16x32_bf16 v[32:35], v[220:223], v[176:179], v[32:35]
  v_mfma_f32_16x16x32_bf16 v[28:31], v[216:219], v[176:179], v[28:31]
  v_mfma_f32_16x16x32_bf16 v[28:31], v[196:199], v[152:155], v[28:31]
  s_waitcnt lgkmcnt(6)
  v_mfma_f32_16x16x32_bf16 v[48:51], v[196:199], v[156:159], v[48:51]
  v_mfma_f32_16x16x32_bf16 v[48:51], v[216:219], v[180:183], v[48:51]
  buffer_load_dwordx4 v245, s[12:15], s43 offen offset:3072 lds
  v_mfma_f32_16x16x32_bf16 v[52:55], v[220:223], v[180:183], v[52:55]
  v_mfma_f32_16x16x32_bf16 v[52:55], v[200:203], v[156:159], v[52:55]
  v_mfma_f32_16x16x32_bf16 v[56:59], v[204:207], v[156:159], v[56:59]
  v_mfma_f32_16x16x32_bf16 v[56:59], v[224:227], v[180:183], v[56:59]
  s_add_u32 m0, s41, 94208
  v_mfma_f32_16x16x32_bf16 v[60:63], v[228:231], v[180:183], v[60:63]
  buffer_load_dwordx4 v246, s[12:15], s43 offen offset:0 lds
  v_mfma_f32_16x16x32_bf16 v[60:63], v[208:211], v[156:159], v[60:63]
  s_cmp_le_u32 s54, 8
  s_cselect_b32 s44, 9, 8
  v_mfma_f32_16x16x32_bf16 v[64:67], v[212:215], v[156:159], v[64:67]
  s_lshl_b32 s42, s44, 7
  v_mfma_f32_16x16x32_bf16 v[64:67], v[232:235], v[180:183], v[64:67]
  s_mul_i32 s43, s44, s45
  v_add_u32 v136, s50, v4
  v_min_u32 v136, 48336, v136
  s_cmp_gt_u32 s50, 48336
  s_cbranch_scc1 k_t_c2
  global_load_dwordx4 v[140:143], v136, s[0:1]
k_t_c2:
k_t_join:
  s_waitcnt lgkmcnt(0)
  v_mfma_f32_16x16x32_bf16 v[84:87], v[212:215], v[160:163], v[84:87]
  v_mfma_f32_16x16x32_bf16 v[84:87], v[232:235], v[184:187], v[84:87]
  s_waitcnt vmcnt(11)
  s_barrier
  v_mfma_f32_16x16x32_bf16 v[80:83], v[228:231], v[184:187], v[80:83]
  ds_read_b128 v[148:151], v247 offset:45056
  v_lshlrev_b32 v6, 4, v0
  v_mfma_f32_16x16x32_bf16 v[80:83], v[208:211], v[160:163], v[80:83]
  ds_read_b128 v[172:175], v248 offset:45056
  v_add_u32 v6, 32768, v6
  v_mfma_f32_16x16x32_bf16 v[76:79], v[204:207], v[160:163], v[76:79]
  ds_read_b64_tr_b16 a[140:141], v249 offset:45056
  buffer_load_dword v255, v6, s[16:19], 0 offen sc1
  v_mfma_f32_16x16x32_bf16 v[76:79], v[224:227], v[184:187], v[76:79]
  ds_read_b64_tr_b16 a[142:143], v249 offset:46336
  s_add_u32 m0, s40, 0
  v_mfma_f32_16x16x32_bf16 v[72:75], v[220:223], v[184:187], v[72:75]
  ds_read_b64_tr_b16 a[160:161], v249 offset:55296
  buffer_load_dwordx4 v236, s[8:11], s42 offen offset:0 lds
  v_mfma_f32_16x16x32_bf16 v[72:75], v[200:203], v[160:163], v[72:75]
  ds_read_b64_tr_b16 a[162:163], v249 offset:56576
  v_mfma_f32_16x16x32_bf16 v[68:71], v[196:199], v[160:163], v[68:71]
  ds_read_b64_tr_b16 a[144:145], v250 offset:45056
  v_mfma_f32_16x16x32_bf16 v[68:71], v[216:219], v[184:187], v[68:71]
  ds_read_b64_tr_b16 a[146:147], v250 offset:46336
  v_mfma_f32_16x16x32_bf16 v[88:91], v[216:219], v[188:191], v[88:91]
  ds_read_b64_tr_b16 a[164:165], v250 offset:55296
  v_mfma_f32_16x16x32_bf16 v[88:91], v[196:199], v[164:167], v[88:91]
  ds_read_b64_tr_b16 a[166:167], v250 offset:56576
  buffer_load_dwordx4 v237, s[8:11], s42 offen offset:1024 lds
  v_mfma_f32_16x16x32_bf16 v[92:95], v[200:203], v[164:167], v[92:95]
  ds_read_b64_tr_b16 a[148:149], v249 offset:45120
  v_mfma_f32_16x16x32_bf16 v[92:95], v[220:223], v[188:191], v[92:95]
  ds_read_b64_tr_b16 a[150:151], v249 offset:46400
  v_mfma_f32_16x16x32_bf16 v[96:99], v[224:227], v[188:191], v[96:99]
  ds_read_b64_tr_b16 a[168:169], v249 offset:55360
  v_mfma_f32_16x16x32_bf16 v[96:99], v[204:207], v[164:167], v[96:99]
  ds_read_b64_tr_b16 a[170:171], v249 offset:56640
  v_mfma_f32_16x16x32_bf16 v[100:103], v[208:211], v[164:167], v[100:103]
  ds_read_b64_tr_b16 a[152:153], v250 offset:45120
  buffer_load_dwordx4 v238, s[8:11], s42 offen offset:2048 lds
  v_mfma_f32_16x16x32_bf16 v[100:103], v[228:231], v[188:191], v[100:103]
  ds_read_b64_tr_b16 a[154:155], v250 offset:46400
  v_mfma_f32_16x16x32_bf16 v[104:107], v[232:235], v[188:191], v[104:107]
  ds_read_b64_tr_b16 a[172:173], v250 offset:55360
  v_mfma_f32_16x16x32_bf16 v[104:107], v[212:215], v[164:167], v[104:107]
  ds_read_b64_tr_b16 a[174:175], v250 offset:56640
  v_mfma_f32_16x16x32_bf16 v[124:127], v[212:215], v[168:171], v[124:127]
  ds_read_b64_tr_b16 a[156:157], v251 offset:45056
  v_mfma_f32_16x16x32_bf16 v[124:127], v[232:235], v[192:195], v[124:127]
  ds_read_b64_tr_b16 a[158:159], v251 offset:46336
  buffer_load_dwordx4 v239, s[8:11], s42 offen offset:3072 lds
  v_mfma_f32_16x16x32_bf16 v[120:123], v[228:231], v[192:195], v[120:123]
  ds_read_b64_tr_b16 a[176:177], v251 offset:55296
  v_mfma_f32_16x16x32_bf16 v[120:123], v[208:211], v[168:171], v[120:123]
  ds_read_b64_tr_b16 a[178:179], v251 offset:56576
  v_mfma_f32_16x16x32_bf16 v[116:119], v[204:207], v[168:171], v[116:119]
  v_mfma_f32_16x16x32_bf16 v[116:119], v[224:227], v[192:195], v[116:119]
  s_add_u32 m0, s40, 4096
  v_mfma_f32_16x16x32_bf16 v[112:115], v[220:223], v[192:195], v[112:115]
  buffer_load_dwordx4 v240, s[8:11], s42 offen offset:0 lds
  v_mfma_f32_16x16x32_bf16 v[112:115], v[200:203], v[168:171], v[112:115]
  v_mfma_f32_16x16x32_bf16 v[108:111], v[196:199], v[168:171], v[108:111]
  v_mfma_f32_16x16x32_bf16 v[108:111], v[216:219], v[192:195], v[108:111]
  s_waitcnt lgkmcnt(0)
  v_mfma_f32_16x16x32_bf16 v[8:11], a[140:143], v[148:151], v[8:11]
  ds_read_b128 v[152:155], v247 offset:47104
  v_mfma_f32_16x16x32_bf16 v[8:11], a[160:163], v[172:175], v[8:11]
  ds_read_b128 v[176:179], v248 offset:47104
  buffer_load_dwordx4 v241, s[8:11], s42 offen offset:1024 lds
  v_mfma_f32_16x16x32_bf16 v[12:15], a[164:167], v[172:175], v[12:15]
  ds_read_b128 v[156:159], v247 offset:49152
  v_mfma_f32_16x16x32_bf16 v[12:15], a[144:147], v[148:151], v[12:15]
  v_mfma_f32_16x16x32_bf16 v[16:19], a[148:151], v[148:151], v[16:19]
  ds_read_b128 v[180:183], v248 offset:49152
  v_mfma_f32_16x16x32_bf16 v[16:19], a[168:171], v[172:175], v[16:19]
  ds_read_b128 v[160:163], v247 offset:51200
  s_add_u32 m0, s41, 0
  v_mfma_f32_16x16x32_bf16 v[20:23], a[172:175], v[172:175], v[20:23]
  buffer_load_dwordx4 v242, s[12:15], s43 offen offset:0 lds
  v_mfma_f32_16x16x32_bf16 v[20:23], a[152:155], v[148:151], v[20:23]
  ds_read_b128 v[184:187], v248 offset:51200
  v_mfma_f32_16x16x32_bf16 v[24:27], a[156:159], v[148:151], v[24:27]
  ds_read_b128 v[164:167], v247 offset:53248
  v_mfma_f32_16x16x32_bf16 v[24:27], a[176:179], v[172:175], v[24:27]
  ds_read_b128 v[188:191], v248 offset:53248
  s_waitcnt lgkmcnt(6)
  v_mfma_f32_16x16x32_bf16 v[44:47], a[176:179], v[176:179], v[44:47]
  v_mfma_f32_16x16x32_bf16 v[44:47], a[156:159], v[152:155], v[44:47]
  ds_read_b128 v[168:171], v247 offset:55296
  buffer_load_dwordx4 v243, s[12:15], s43 offen offset:1024 lds
  v_mfma_f32_16x16x32_bf16 v[40:43], a[152:155], v[152:155], v[40:43]
  ds_read_b128 v[192:195], v248 offset:55296
  v_mfma_f32_16x16x32_bf16 v[40:43], a[172:175], v[176:179], v[40:43]
  v_mfma_f32_16x16x32_bf16 v[36:39], a[168:171], v[176:179], v[36:39]
  v_mfma_f32_16x16x32_bf16 v[36:39], a[148:151], v[152:155], v[36:39]
  v_lshlrev_b32 v3, 4, v0
  v_mfma_f32_16x16x32_bf16 v[32:35], a[144:147], v[152:155], v[32:35]
  buffer_load_dwordx4 v244, s[12:15], s43 offen offset:2048 lds
  v_add_u32 v252, s74, v3
  v_mfma_f32_16x16x32_bf16 v[32:35], a[164:167], v[176:179], v[32:35]
  v_add_u32 v253, 4096, v252
  v_mfma_f32_16x16x32_bf16 v[28:31], a[160:163], v[176:179], v[28:31]
  v_cmp_le_u32 vcc, 144, v0
  v_mfma_f32_16x16x32_bf16 v[28:31], a[140:143], v[152:155], v[28:31]
  s_waitcnt lgkmcnt(6)
  v_add_u32 v3, s65, v3
  v_mfma_f32_16x16x32_bf16 v[48:51], a[140:143], v[156:159], v[48:51]
  v_cmp_le_u32 s[28:29], s66, v0
  v_mfma_f32_16x16x32_bf16 v[48:51], a[160:163], v[180:183], v[48:51]
  buffer_load_dwordx4 v245, s[12:15], s43 offen offset:3072 lds
  v_cndmask_b32 v253, v253, v3, vcc
  v_mfma_f32_16x16x32_bf16 v[52:55], a[164:167], v[180:183], v[52:55]
  v_add_u32 v3, 7424, v3
  v_mfma_f32_16x16x32_bf16 v[52:55], a[144:147], v[156:159], v[52:55]
  v_cmp_le_u32 vcc, 240, v0
  v_mfma_f32_16x16x32_bf16 v[56:59], a[148:151], v[156:159], v[56:59]
  v_cndmask_b32 v253, v253, v3, s[28:29]
  v_mfma_f32_16x16x32_bf16 v[56:59], a[168:171], v[180:183], v[56:59]
  s_add_u32 m0, s41, 4096
  v_mov_b32 v3, 1073741824
  v_mfma_f32_16x16x32_bf16 v[60:63], a[172:175], v[180:183], v[60:63]
  buffer_load_dwordx4 v246, s[12:15], s43 offen offset:0 lds
  v_cndmask_b32 v253, v253, v3, vcc
  v_mfma_f32_16x16x32_bf16 v[60:63], a[152:155], v[156:159], v[60:63]
  v_and_b32 v1, 15, v7
  v_mfma_f32_16x16x32_bf16 v[64:67], a[156:159], v[156:159], v[64:67]
  v_lshrrev_b32 v2, 4, v7
  v_mfma_f32_16x16x32_bf16 v[64:67], a[176:179], v[180:183], v[64:67]
  s_waitcnt lgkmcnt(0)
  v_mfma_f32_16x16x32_bf16 v[84:87], a[156:159], v[160:163], v[84:87]
  v_mfma_f32_16x16x32_bf16 v[84:87], a[176:179], v[184:187], v[84:87]
  s_waitcnt vmcnt(11)
  v_cmp_ne_u32 vcc, s39, v255
  s_nop 1
  s_cmp_lg_u64 vcc, 0
  s_cbranch_scc1 k_t_sa_slow
k_t_sa_ok:
  s_barrier
  v_mfma_f32_16x16x32_bf16 v[80:83], a[172:175], v[184:187], v[80:83]
  ds_read_b128 v[148:151], v128 offset:0
  v_mov_b32 v146, 819200
  s_mov_b32 m0, s72
  s_nop 0
  buffer_load_dwordx4 v252, s[16:19], 0 offen sc1 lds
  v_mfma_f32_16x16x32_bf16 v[80:83], a[152:155], v[160:163], v[80:83]
  ds_read_b128 v[172:175], v129 offset:0
  buffer_load_dword v147, v146, s[16:19], 0 offen sc1
  s_add_u32 m0, s72, 4096
  s_nop 0
  buffer_load_dwordx4 v253, s[16:19], 0 offen sc1 lds
  v_mfma_f32_16x16x32_bf16 v[76:79], a[148:151], v[160:163], v[76:79]
  ds_read_b64_tr_b16 v[196:197], v130 offset:0
  v_mov_b32 v3, s39
  v_lshlrev_b32 v6, 25, v7
  buffer_store_dword v3, v6, s[16:19], s73 offen sc1
  v_mfma_f32_16x16x32_bf16 v[76:79], a[168:171], v[184:187], v[76:79]
  ds_read_b64_tr_b16 v[198:199], v130 offset:1280
  s_add_u32 s68, s46, 0
  v_mfma_f32_16x16x32_bf16 v[72:75], a[164:167], v[184:187], v[72:75]
  ds_read_b64_tr_b16 v[216:217], v130 offset:10240
  v_mfma_f32_16x16x32_bf16 v[72:75], a[144:147], v[160:163], v[72:75]
  ds_read_b64_tr_b16 v[218:219], v130 offset:11520
  v_mfma_f32_16x16x32_bf16 v[68:71], a[140:143], v[160:163], v[68:71]
  ds_read_b64_tr_b16 v[200:201], v131 offset:0
  v_mfma_f32_16x16x32_bf16 v[68:71], a[160:163], v[184:187], v[68:71]
  ds_read_b64_tr_b16 v[202:203], v131 offset:1280
  buffer_load_dwordx4 a[0:3], v4, s[16:19], s68 offen offset:0 sc1
  v_mfma_f32_16x16x32_bf16 v[88:91], a[160:163], v[188:191], v[88:91]
  ds_read_b64_tr_b16 v[220:221], v131 offset:10240
  v_mfma_f32_16x16x32_bf16 v[88:91], a[140:143], v[164:167], v[88:91]
  ds_read_b64_tr_b16 v[222:223], v131 offset:11520
  v_mfma_f32_16x16x32_bf16 v[92:95], a[144:147], v[164:167], v[92:95]
  ds_read_b64_tr_b16 v[204:205], v130 offset:64
  v_mfma_f32_16x16x32_bf16 v[92:95], a[164:167], v[188:191], v[92:95]
  ds_read_b64_tr_b16 v[206:207], v130 offset:1344
  buffer_load_dwordx4 a[4:7], v4, s[16:19], s68 offen offset:1024 sc1
  v_mfma_f32_16x16x32_bf16 v[96:99], a[168:171], v[188:191], v[96:99]
  ds_read_b64_tr_b16 v[224:225], v130 offset:10304
  v_mfma_f32_16x16x32_bf16 v[96:99], a[148:151], v[164:167], v[96:99]
  ds_read_b64_tr_b16 v[226:227], v130 offset:11584
  v_mfma_f32_16x16x32_bf16 v[100:103], a[152:155], v[164:167], v[100:103]
  ds_read_b64_tr_b16 v[208:209], v131 offset:64
  v_mfma_f32_16x16x32_bf16 v[100:103], a[172:175], v[188:191], v[100:103]
  ds_read_b64_tr_b16 v[210:211], v131 offset:1344
  buffer_load_dwordx4 a[8:11], v4, s[16:19], s68 offen offset:2048 sc1
  v_mfma_f32_16x16x32_bf16 v[104:107], a[176:179], v[188:191], v[104:107]
  ds_read_b64_tr_b16 v[228:229], v131 offset:10304
  v_mfma_f32_16x16x32_bf16 v[104:107], a[156:159], v[164:167], v[104:107]
  ds_read_b64_tr_b16 v[230:231], v131 offset:11584
  v_mfma_f32_16x16x32_bf16 v[124:127], a[156:159], v[168:171], v[124:127]
  ds_read_b64_tr_b16 v[212:213], v132 offset:0
  v_mfma_f32_16x16x32_bf16 v[124:127], a[176:179], v[192:195], v[124:127]
  ds_read_b64_tr_b16 v[214:215], v132 offset:1280
  buffer_load_dwordx4 a[12:15], v4, s[16:19], s68 offen offset:3072 sc1
  v_mfma_f32_16x16x32_bf16 v[120:123], a[172:175], v[192:195], v[120:123]
  ds_read_b64_tr_b16 v[232:233], v132 offset:10240
  v_mfma_f32_16x16x32_bf16 v[120:123], a[152:155], v[168:171], v[120:123]
  ds_read_b64_tr_b16 v[234:235], v132 offset:11520
  v_mfma_f32_16x16x32_bf16 v[116:119], a[148:151], v[168:171], v[116:119]
  v_mfma_f32_16x16x32_bf16 v[116:119], a[168:171], v[192:195], v[116:119]
  buffer_load_dwordx4 a[16:19], v5, s[16:19], s68 offen sc1
  v_mfma_f32_16x16x32_bf16 v[112:115], a[164:167], v[192:195], v[112:115]
  v_mfma_f32_16x16x32_bf16 v[112:115], a[144:147], v[168:171], v[112:115]
  v_mfma_f32_16x16x32_bf16 v[108:111], a[140:143], v[168:171], v[108:111]
  v_mfma_f32_16x16x32_bf16 v[108:111], a[160:163], v[192:195], v[108:111]
  s_waitcnt lgkmcnt(0)
  v_mfma_f32_16x16x32_bf16 v[8:11], v[196:199], v[148:151], v[8:11]
  ds_read_b128 v[152:155], v128 offset:2048
  v_mfma_f32_16x16x32_bf16 v[8:11], v[216:219], v[172:175], v[8:11]
  ds_read_b128 v[176:179], v129 offset:2048
  v_mfma_f32_16x16x32_bf16 v[12:15], v[220:223], v[172:175], v[12:15]
  ds_read_b128 v[156:159], v128 offset:4096
  v_mfma_f32_16x16x32_bf16 v[12:15], v[200:203], v[148:151], v[12:15]
  s_add_u32 s68, s46, 131072
  v_mfma_f32_16x16x32_bf16 v[16:19], v[204:207], v[148:151], v[16:19]
  ds_read_b128 v[180:183], v129 offset:4096
  v_mfma_f32_16x16x32_bf16 v[16:19], v[224:227], v[172:175], v[16:19]
  ds_read_b128 v[160:163], v128 offset:6144
  buffer_load_dwordx4 a[20:23], v4, s[16:19], s68 offen offset:0 sc1
  v_mfma_f32_16x16x32_bf16 v[20:23], v[228:231], v[172:175], v[20:23]
  v_mfma_f32_16x16x32_bf16 v[20:23], v[208:211], v[148:151], v[20:23]
  ds_read_b128 v[184:187], v129 offset:6144
  v_mfma_f32_16x16x32_bf16 v[24:27], v[212:215], v[148:151], v[24:27]
  ds_read_b128 v[164:167], v128 offset:8192
  buffer_load_dwordx4 a[24:27], v4, s[16:19], s68 offen offset:1024 sc1
  v_mfma_f32_16x16x32_bf16 v[24:27], v[232:235], v[172:175], v[24:27]
  ds_read_b128 v[188:191], v129 offset:8192
  s_waitcnt lgkmcnt(6)
  v_mfma_f32_16x16x32_bf16 v[44:47], v[232:235], v[176:179], v[44:47]
  v_mfma_f32_16x16x32_bf16 v[44:47], v[212:215], v[152:155], v[44:47]
  ds_read_b128 v[168:171], v128 offset:10240
  buffer_load_dwordx4 a[28:31], v4, s[16:19], s68 offen offset:2048 sc1
  v_mfma_f32_16x16x32_bf16 v[40:43], v[208:211], v[152:155], v[40:43]
  ds_read_b128 v[192:195], v129 offset:10240
  v_mfma_f32_16x16x32_bf16 v[40:43], v[228:231], v[176:179], v[40:43]
  v_mfma_f32_16x16x32_bf16 v[36:39], v[224:227], v[176:179], v[36:39]
  buffer_load_dwordx4 a[32:35], v4, s[16:19], s68 offen offset:3072 sc1
  v_mfma_f32_16x16x32_bf16 v[36:39], v[204:207], v[152:155], v[36:39]
  v_mfma_f32_16x16x32_bf16 v[32:35], v[200:203], v[152:155], v[32:35]
  buffer_load_dwordx4 a[36:39], v5, s[16:19], s68 offen sc1
  v_mfma_f32_16x16x32_bf16 v[32:35], v[220:223], v[176:179], v[32:35]
  v_mfma_f32_16x16x32_bf16 v[28:31], v[216:219], v[176:179], v[28:31]
  v_add_u32 v236, s62, v4
  v_mfma_f32_16x16x32_bf16 v[28:31], v[196:199], v[152:155], v[28:31]
  s_waitcnt lgkmcnt(6)
  v_add_u32 v237, s63, v4
  s_add_u32 s68, s46, 262144
  v_mfma_f32_16x16x32_bf16 v[48:51], v[196:199], v[156:159], v[48:51]
  v_and_b32 v3, 1, v2
  v_mfma_f32_16x16x32_bf16 v[48:51], v[216:219], v[180:183], v[48:51]
  v_lshlrev_b32 v3, 10, v3
  v_mfma_f32_16x16x32_bf16 v[52:55], v[220:223], v[180:183], v[52:55]
  v_lshrrev_b32 v254, 1, v2
  buffer_load_dwordx4 a[40:43], v4, s[16:19], s68 offen offset:0 sc1
  v_mfma_f32_16x16x32_bf16 v[52:55], v[200:203], v[156:159], v[52:55]
  v_lshl_add_u32 v3, v254, 8, v3
  v_mfma_f32_16x16x32_bf16 v[56:59], v[204:207], v[156:159], v[56:59]
  v_lshl_add_u32 v3, v1, 4, v3
  v_mfma_f32_16x16x32_bf16 v[56:59], v[224:227], v[180:183], v[56:59]
  v_add_u32 v238, s61, v3
  buffer_load_dwordx4 a[44:47], v4, s[16:19], s68 offen offset:1024 sc1
  v_mfma_f32_16x16x32_bf16 v[60:63], v[228:231], v[180:183], v[60:63]
  v_mov_b32 v240, 0x358637bd
  v_mfma_f32_16x16x32_bf16 v[60:63], v[208:211], v[156:159], v[60:63]
  v_mov_b32 v241, 0x358637bd
  v_mfma_f32_16x16x32_bf16 v[64:67], v[212:215], v[156:159], v[64:67]
  v_mfma_f32_16x16x32_bf16 v[64:67], v[232:235], v[180:183], v[64:67]
  s_waitcnt lgkmcnt(0)
  v_mfma_f32_16x16x32_bf16 v[84:87], v[212:215], v[160:163], v[84:87]
  v_mfma_f32_16x16x32_bf16 v[84:87], v[232:235], v[184:187], v[84:87]
  s_waitcnt vmcnt(13)
  s_barrier
  v_mfma_f32_16x16x32_bf16 v[80:83], v[228:231], v[184:187], v[80:83]
  ds_read_b128 v[148:151], v247 offset:0
  v_mfma_f32_16x16x32_bf16 v[80:83], v[208:211], v[160:163], v[80:83]
  ds_read_b128 v[172:175], v248 offset:0
  v_mfma_f32_16x16x32_bf16 v[76:79], v[204:207], v[160:163], v[76:79]
  ds_read_b64_tr_b16 a[140:141], v249 offset:0
  v_mfma_f32_16x16x32_bf16 v[76:79], v[224:227], v[184:187], v[76:79]
  ds_read_b64_tr_b16 a[142:143], v249 offset:1280
  s_add_u32 s68, s46, 262144
  v_mfma_f32_16x16x32_bf16 v[72:75], v[220:223], v[184:187], v[72:75]
  ds_read_b64_tr_b16 a[160:161], v249 offset:10240
  v_mfma_f32_16x16x32_bf16 v[72:75], v[200:203], v[160:163], v[72:75]
  ds_read_b64_tr_b16 a[162:163], v249 offset:11520
  v_mfma_f32_16x16x32_bf16 v[68:71], v[196:199], v[160:163], v[68:71]
  ds_read_b64_tr_b16 a[144:145], v250 offset:0
  buffer_load_dwordx4 a[48:51], v4, s[16:19], s68 offen offset:2048 sc1
  v_mfma_f32_16x16x32_bf16 v[68:71], v[216:219], v[184:187], v[68:71]
  ds_read_b64_tr_b16 a[146:147], v250 offset:1280
  v_mfma_f32_16x16x32_bf16 v[88:91], v[216:219], v[188:191], v[88:91]
  ds_read_b64_tr_b16 a[164:165], v250 offset:10240
  v_mfma_f32_16x16x32_bf16 v[88:91], v[196:199], v[164:167], v[88:91]
  ds_read_b64_tr_b16 a[166:167], v250 offset:11520
  v_mfma_f32_16x16x32_bf16 v[92:95], v[200:203], v[164:167], v[92:95]
  ds_read_b64_tr_b16 a[148:149], v249 offset:64
  buffer_load_dwordx4 a[52:55], v4, s[16:19], s68 offen offset:3072 sc1
  v_mfma_f32_16x16x32_bf16 v[92:95], v[220:223], v[188:191], v[92:95]
  ds_read_b64_tr_b16 a[150:151], v249 offset:1344
  v_mfma_f32_16x16x32_bf16 v[96:99], v[224:227], v[188:191], v[96:99]
  ds_read_b64_tr_b16 a[168:169], v249 offset:10304
  v_mfma_f32_16x16x32_bf16 v[96:99], v[204:207], v[164:167], v[96:99]
  ds_read_b64_tr_b16 a[170:171], v249 offset:11584
  buffer_load_dwordx4 a[56:59], v5, s[16:19], s68 offen sc1
  v_mfma_f32_16x16x32_bf16 v[100:103], v[208:211], v[164:167], v[100:103]
  ds_read_b64_tr_b16 a[152:153], v250 offset:64
  v_mfma_f32_16x16x32_bf16 v[100:103], v[228:231], v[188:191], v[100:103]
  ds_read_b64_tr_b16 a[154:155], v250 offset:1344
  v_mfma_f32_16x16x32_bf16 v[104:107], v[232:235], v[188:191], v[104:107]
  ds_read_b64_tr_b16 a[172:173], v250 offset:10304
  v_mfma_f32_16x16x32_bf16 v[104:107], v[212:215], v[164:167], v[104:107]
  ds_read_b64_tr_b16 a[174:175], v250 offset:11584
  s_add_u32 s68, s46, 393216
  v_mfma_f32_16x16x32_bf16 v[124:127], v[212:215], v[168:171], v[124:127]
  ds_read_b64_tr_b16 a[156:157], v251 offset:0
  v_mfma_f32_16x16x32_bf16 v[124:127], v[232:235], v[192:195], v[124:127]
  ds_read_b64_tr_b16 a[158:159], v251 offset:1280
  v_mfma_f32_16x16x32_bf16 v[120:123], v[228:231], v[192:195], v[120:123]
  ds_read_b64_tr_b16 a[176:177], v251 offset:10240
  buffer_load_dwordx4 a[60:63], v4, s[16:19], s68 offen offset:0 sc1
  v_mfma_f32_16x16x32_bf16 v[120:123], v[208:211], v[168:171], v[120:123]
  ds_read_b64_tr_b16 a[178:179], v251 offset:11520
  v_mfma_f32_16x16x32_bf16 v[116:119], v[204:207], v[168:171], v[116:119]
  v_readfirstlane_b32 s3, v147
  v_mfma_f32_16x16x32_bf16 v[116:119], v[224:227], v[192:195], v[116:119]
  s_xor_b32 s3, s3, s39
  v_mfma_f32_16x16x32_bf16 v[112:115], v[220:223], v[192:195], v[112:115]
  s_and_b32 s38, s3, 4294959103
  s_cbranch_scc1 k_t_pw
k_t_pwr:
  buffer_load_dwordx4 a[64:67], v4, s[16:19], s68 offen offset:1024 sc1
  v_mfma_f32_16x16x32_bf16 v[112:115], v[200:203], v[168:171], v[112:115]
  s_xor_b32 s80, s80, s3
  v_mfma_f32_16x16x32_bf16 v[108:111], v[196:199], v[168:171], v[108:111]
  s_xor_b32 s81, s81, s3
  v_mfma_f32_16x16x32_bf16 v[108:111], v[216:219], v[192:195], v[108:111]
  s_xor_b32 s82, s82, s3
  s_waitcnt lgkmcnt(0)
  v_mfma_f32_16x16x32_bf16 v[8:11], a[140:143], v[148:151], v[8:11]
  ds_read_b128 v[152:155], v247 offset:2048
  v_lshlrev_b32 v252, 2, v0
  v_add_u32 v252, 135168, v252
  v_mfma_f32_16x16x32_bf16 v[8:11], a[160:163], v[172:175], v[8:11]
  ds_read_b128 v[176:179], v248 offset:2048
  ds_read_b32 v128, v252 offset:0
  v_mfma_f32_16x16x32_bf16 v[12:15], a[164:167], v[172:175], v[12:15]
  ds_read_b128 v[156:159], v247 offset:4096
  ds_read_b32 v129, v252 offset:640
  v_mfma_f32_16x16x32_bf16 v[12:15], a[144:147], v[148:151], v[12:15]
  ds_read_b32 v130, v252 offset:1280
  s_add_u32 s68, s46, 393216
  v_mfma_f32_16x16x32_bf16 v[16:19], a[148:151], v[148:151], v[16:19]
  ds_read_b128 v[180:183], v248 offset:4096
  ds_read_b32 v131, v252 offset:1920
  v_mfma_f32_16x16x32_bf16 v[16:19], a[168:171], v[172:175], v[16:19]
  ds_read_b128 v[160:163], v247 offset:6144
  ds_read_b32 v132, v252 offset:2560
  ds_read_b32 v133, v252 offset:3200
  buffer_load_dwordx4 a[68:71], v4, s[16:19], s68 offen offset:2048 sc1
  v_mfma_f32_16x16x32_bf16 v[20:23], a[172:175], v[172:175], v[20:23]
  ds_read_b32 v134, v252 offset:3840
  v_mfma_f32_16x16x32_bf16 v[20:23], a[152:155], v[148:151], v[20:23]
  ds_read_b128 v[184:187], v248 offset:6144
  ds_read_b32 v135, v252 offset:4480
  v_mfma_f32_16x16x32_bf16 v[24:27], a[156:159], v[148:151], v[24:27]
  ds_read_b128 v[164:167], v247 offset:8192
  ds_read_b32 v136, v252 offset:5120
  buffer_load_dwordx4 a[72:75], v4, s[16:19], s68 offen offset:3072 sc1
  v_mfma_f32_16x16x32_bf16 v[24:27], a[176:179], v[172:175], v[24:27]
  ds_read_b128 v[188:191], v248 offset:8192
  s_waitcnt lgkmcnt(15)
  ds_read_b32 v137, v252 offset:5760
  v_mfma_f32_16x16x32_bf16 v[44:47], a[176:179], v[176:179], v[44:47]
  v_mfma_f32_16x16x32_bf16 v[44:47], a[156:159], v[152:155], v[44:47]
  ds_read_b128 v[168:171], v247 offset:10240
  buffer_load_dwordx4 a[76:79], v5, s[16:19], s68 offen sc1
  v_mfma_f32_16x16x32_bf16 v[40:43], a[152:155], v[152:155], v[40:43]
  ds_read_b128 v[192:195], v248 offset:10240
  v_mfma_f32_16x16x32_bf16 v[40:43], a[172:175], v[176:179], v[40:43]
  v_mfma_f32_16x16x32_bf16 v[36:39], a[168:171], v[176:179], v[36:39]
  s_add_u32 s68, s46, 524288
  v_mfma_f32_16x16x32_bf16 v[36:39], a[148:151], v[152:155], v[36:39]
  s_waitcnt lgkmcnt(2)
  v_mfma_f32_16x16x32_bf16 v[32:35], a[144:147], v[152:155], v[32:35]
  v_add_f32 v128, v128, v129
  buffer_load_dwordx4 a[80:83], v4, s[16:19], s68 offen offset:0 sc1
  v_mfma_f32_16x16x32_bf16 v[32:35], a[164:167], v[176:179], v[32:35]
  v_add_f32 v128, v128, v130
  v_mfma_f32_16x16x32_bf16 v[28:31], a[160:163], v[176:179], v[28:31]
  v_add_f32 v128, v128, v131
  v_mfma_f32_16x16x32_bf16 v[28:31], a[140:143], v[152:155], v[28:31]
  s_waitcnt lgkmcnt(13)
  v_add_f32 v128, v128, v132
  buffer_load_dwordx4 a[84:87], v4, s[16:19], s68 offen offset:1024 sc1
  v_mfma_f32_16x16x32_bf16 v[48:51], a[140:143], v[156:159], v[48:51]
  v_add_f32 v128, v128, v133
  v_mfma_f32_16x16x32_bf16 v[48:51], a[160:163], v[180:183], v[48:51]
  v_add_f32 v128, v128, v134
  v_mfma_f32_16x16x32_bf16 v[52:55], a[164:167], v[180:183], v[52:55]
  v_add_f32 v128, v128, v135
  buffer_load_dwordx4 a[88:91], v4, s[16:19], s68 offen offset:2048 sc1
  v_mfma_f32_16x16x32_bf16 v[52:55], a[144:147], v[156:159], v[52:55]
  v_add_f32 v128, v128, v136
  v_mfma_f32_16x16x32_bf16 v[56:59], a[148:151], v[156:159], v[56:59]
  v_add_f32 v128, v128, v137
  v_mfma_f32_16x16x32_bf16 v[56:59], a[168:171], v[180:183], v[56:59]
  ds_write_b32 v252, v128 offset:8192
  buffer_load_dwordx4 a[92:95], v4, s[16:19], s68 offen offset:3072 sc1
  v_mfma_f32_16x16x32_bf16 v[60:63], a[172:175], v[180:183], v[60:63]
  v_mfma_f32_16x16x32_bf16 v[60:63], a[152:155], v[156:159], v[60:63]
  v_mfma_f32_16x16x32_bf16 v[64:67], a[156:159], v[156:159], v[64:67]
  v_mfma_f32_16x16x32_bf16 v[64:67], a[176:179], v[180:183], v[64:67]
  s_waitcnt lgkmcnt(0)
  v_mfma_f32_16x16x32_bf16 v[84:87], a[156:159], v[160:163], v[84:87]
  v_mfma_f32_16x16x32_bf16 v[84:87], a[176:179], v[184:187], v[84:87]
  s_barrier
  v_mfma_f32_16x16x32_bf16 v[80:83], a[172:175], v[184:187], v[80:83]
  s_mul_i32 s28, s51, 384
  v_mfma_f32_16x16x32_bf16 v[80:83], a[152:155], v[160:163], v[80:83]
  s_add_u32 s28, s28, 141568
  v_mfma_f32_16x16x32_bf16 v[76:79], a[148:151], v[160:163], v[76:79]
  v_lshlrev_b32 v6, 4, v2
  v_mfma_f32_16x16x32_bf16 v[76:79], a[168:171], v[184:187], v[76:79]
  v_add_u32 v252, s34, v6
  s_add_u32 s68, s46, 524288
  v_mfma_f32_16x16x32_bf16 v[72:75], a[164:167], v[184:187], v[72:75]
  v_add_u32 v253, s35, v6
  v_mfma_f32_16x16x32_bf16 v[72:75], a[144:147], v[160:163], v[72:75]
  v_lshl_add_u32 v3, v1, 2, s28
  buffer_load_dwordx4 a[96:99], v5, s[16:19], s68 offen sc1
  v_mfma_f32_16x16x32_bf16 v[68:71], a[140:143], v[160:163], v[68:71]
  ds_read_b128 v[128:131], v252 offset:0
  v_mfma_f32_16x16x32_bf16 v[68:71], a[160:163], v[184:187], v[68:71]
  ds_read_b128 v[132:135], v252 offset:64
  s_add_u32 s68, s46, 655360
  v_mfma_f32_16x16x32_bf16 v[88:91], a[160:163], v[188:191], v[88:91]
  ds_read_b128 v[136:139], v252 offset:128
  v_mfma_f32_16x16x32_bf16 v[88:91], a[140:143], v[164:167], v[88:91]
  ds_read_b128 v[140:143], v252 offset:192
  buffer_load_dwordx4 a[100:103], v4, s[16:19], s68 offen offset:0 sc1
  v_mfma_f32_16x16x32_bf16 v[92:95], a[144:147], v[164:167], v[92:95]
  ds_read_b128 v[144:147], v253
  v_mfma_f32_16x16x32_bf16 v[92:95], a[164:167], v[188:191], v[92:95]
  ds_read_b32 v212, v3 offset:0
  v_mfma_f32_16x16x32_bf16 v[96:99], a[168:171], v[188:191], v[96:99]
  ds_read_b32 v213, v3 offset:768
  buffer_load_dwordx4 a[104:107], v4, s[16:19], s68 offen offset:1024 sc1
  v_mfma_f32_16x16x32_bf16 v[96:99], a[148:151], v[164:167], v[96:99]
  ds_read_b32 v216, v3 offset:64
  v_mfma_f32_16x16x32_bf16 v[100:103], a[152:155], v[164:167], v[100:103]
  ds_read_b32 v217, v3 offset:832
  buffer_load_dwordx4 a[108:111], v4, s[16:19], s68 offen offset:2048 sc1
  v_mfma_f32_16x16x32_bf16 v[100:103], a[172:175], v[188:191], v[100:103]
  ds_read_b32 v220, v3 offset:128
  v_mfma_f32_16x16x32_bf16 v[104:107], a[176:179], v[188:191], v[104:107]
  ds_read_b32 v221, v3 offset:896
  buffer_load_dwordx4 a[112:115], v4, s[16:19], s68 offen offset:3072 sc1
  v_mfma_f32_16x16x32_bf16 v[104:107], a[156:159], v[164:167], v[104:107]
  ds_read_b32 v224, v3 offset:192
  v_mfma_f32_16x16x32_bf16 v[124:127], a[156:159], v[168:171], v[124:127]
  ds_read_b32 v225, v3 offset:960
  buffer_load_dwordx4 a[116:119], v5, s[16:19], s68 offen sc1
  v_mfma_f32_16x16x32_bf16 v[124:127], a[176:179], v[192:195], v[124:127]
  ds_read_b32 v228, v3 offset:256
  v_mfma_f32_16x16x32_bf16 v[120:123], a[172:175], v[192:195], v[120:123]
  ds_read_b32 v229, v3 offset:1024
  v_mfma_f32_16x16x32_bf16 v[120:123], a[152:155], v[168:171], v[120:123]
  ds_read_b32 v232, v3 offset:320
  s_add_u32 s68, s46, 786432
  v_mfma_f32_16x16x32_bf16 v[116:119], a[148:151], v[168:171], v[116:119]
  ds_read_b32 v233, v3 offset:1088
  v_mfma_f32_16x16x32_bf16 v[116:119], a[168:171], v[192:195], v[116:119]
  s_cmp_lt_u32 s20, 3
  s_cselect_b32 s68, s68, 1073741824
  v_mfma_f32_16x16x32_bf16 v[112:115], a[164:167], v[192:195], v[112:115]
  v_mfma_f32_16x16x32_bf16 v[112:115], a[144:147], v[168:171], v[112:115]
  buffer_load_dwordx4 a[120:123], v4, s[16:19], s68 offen offset:0 sc1
  v_mfma_f32_16x16x32_bf16 v[108:111], a[140:143], v[168:171], v[108:111]
  v_mfma_f32_16x16x32_bf16 v[108:111], a[160:163], v[192:195], v[108:111]
  s_waitcnt lgkmcnt(0)
  s_cmp_lt_u32 s22, 12
  s_cbranch_scc1 k_q
  v_mul_f32 v214, s83, v213
  v_rcp_f32 v215, v213
  v_mul_f32 v218, s83, v217
  v_rcp_f32 v219, v217
  v_mul_f32 v222, s83, v221
  v_rcp_f32 v223, v221
  v_mul_f32 v226, s83, v225
  v_rcp_f32 v227, v225
  v_mul_f32 v230, s83, v229
  v_rcp_f32 v231, v229
  v_mul_f32 v234, s83, v233
  v_rcp_f32_e64 v235, v233
  v_pk_fma_f32 v[8:9], v[128:129], v[212:213], v[8:9] op_sel_hi:[1,0,1]
  v_pk_fma_f32 v[10:11], v[130:131], v[212:213], v[10:11] op_sel_hi:[1,0,1]
  v_pk_fma_f32 v[12:13], v[132:133], v[212:213], v[12:13] op_sel_hi:[1,0,1]
  v_pk_fma_f32 v[14:15], v[134:135], v[212:213], v[14:15] op_sel_hi:[1,0,1]
  v_pk_fma_f32 v[28:29], v[128:129], v[216:217], v[28:29] op_sel_hi:[1,0,1]
  v_pk_fma_f32 v[30:31], v[130:131], v[216:217], v[30:31] op_sel_hi:[1,0,1]
  s_add_u32 s68, s46, 786432
  s_cmp_lt_u32 s20, 3
  s_cselect_b32 s68, s68, 1073741824
  buffer_load_dwordx4 a[124:127], v4, s[16:19], s68 offen offset:1024 sc1
  v_pk_fma_f32 v[32:33], v[132:133], v[216:217], v[32:33] op_sel_hi:[1,0,1]
  v_pk_fma_f32 v[34:35], v[134:135], v[216:217], v[34:35] op_sel_hi:[1,0,1]
  v_pk_mul_f32 v[148:149], v[8:9], v[214:215] op_sel_hi:[1,0]
  v_pk_mul_f32 v[150:151], v[10:11], v[214:215] op_sel_hi:[1,0]
  v_pk_mul_f32 v[152:153], v[12:13], v[214:215] op_sel_hi:[1,0]
  v_pk_mul_f32 v[154:155], v[14:15], v[214:215] op_sel_hi:[1,0]
  v_pk_mul_f32 v[156:157], v[28:29], v[218:219] op_sel_hi:[1,0]
  v_pk_mul_f32 v[158:159], v[30:31], v[218:219] op_sel_hi:[1,0]
  v_pk_mul_f32 v[160:161], v[32:33], v[218:219] op_sel_hi:[1,0]
  v_pk_mul_f32 v[162:163], v[34:35], v[218:219] op_sel_hi:[1,0]
  buffer_load_dwordx4 a[128:131], v4, s[16:19], s68 offen offset:2048 sc1
  v_exp_f32 v148, v148
  v_exp_f32 v149, v149
  v_exp_f32 v150, v150
  v_exp_f32 v151, v151
  v_exp_f32 v152, v152
  v_exp_f32 v153, v153
  v_exp_f32 v154, v154
  v_exp_f32 v155, v155
  v_exp_f32 v156, v156
  v_exp_f32 v157, v157
  buffer_load_dwordx4 a[132:135], v4, s[16:19], s68 offen offset:3072 sc1
  v_exp_f32 v158, v158
  v_exp_f32 v159, v159
  v_exp_f32 v160, v160
  v_exp_f32 v161, v161
  v_exp_f32 v162, v162
  v_exp_f32 v163, v163
  v_pk_fma_f32 v[148:149], v[148:149], v[214:215], v[214:215] op_sel:[0,1,1] op_sel_hi:[1,1,1]
  v_pk_fma_f32 v[150:151], v[150:151], v[214:215], v[214:215] op_sel:[0,1,1] op_sel_hi:[1,1,1]
  v_pk_fma_f32 v[152:153], v[152:153], v[214:215], v[214:215] op_sel:[0,1,1] op_sel_hi:[1,1,1]
  v_pk_fma_f32 v[154:155], v[154:155], v[214:215], v[214:215] op_sel:[0,1,1] op_sel_hi:[1,1,1]
  buffer_load_dwordx4 a[136:139], v5, s[16:19], s68 offen sc1
  v_pk_fma_f32 v[156:157], v[156:157], v[218:219], v[218:219] op_sel:[0,1,1] op_sel_hi:[1,1,1]
  v_pk_fma_f32 v[158:159], v[158:159], v[218:219], v[218:219] op_sel:[0,1,1] op_sel_hi:[1,1,1]
  v_pk_fma_f32 v[160:161], v[160:161], v[218:219], v[218:219] op_sel:[0,1,1] op_sel_hi:[1,1,1]
  v_pk_fma_f32 v[162:163], v[162:163], v[218:219], v[218:219] op_sel:[0,1,1] op_sel_hi:[1,1,1]
  v_rcp_f32 v148, v148
  v_rcp_f32 v149, v149
  v_rcp_f32 v150, v150
  v_rcp_f32 v151, v151
  v_rcp_f32 v152, v152
  v_rcp_f32 v153, v153
  s_add_u32 m0, s69, 0
  s_add_u32 s71, s70, 0
  buffer_load_dwordx4 v4, s[16:19], s71 offen offset:0 sc1 lds
  v_rcp_f32 v154, v154
  v_rcp_f32 v155, v155
  v_rcp_f32 v156, v156
  v_rcp_f32 v157, v157
  v_rcp_f32 v158, v158
  v_rcp_f32 v159, v159
  v_rcp_f32 v160, v160
  v_rcp_f32 v161, v161
  v_rcp_f32 v162, v162
  v_rcp_f32 v163, v163
  v_pk_mul_f32 v[8:9], v[8:9], v[148:149]
  v_pk_mul_f32 v[10:11], v[10:11], v[150:151]
  v_pk_mul_f32 v[12:13], v[12:13], v[152:153]
  v_pk_mul_f32 v[14:15], v[14:15], v[154:155]
  v_cvt_pk_bf16_f32 v172, v8, v9
  v_cvt_pk_bf16_f32 v173, v10, v11
  v_cvt_pk_bf16_f32 v174, v12, v13
  v_cvt_pk_bf16_f32 v175, v14, v15
  buffer_store_dwordx4 v[172:175], v236, s[16:19], s80 offen offset:0 sc1
  v_pk_mul_f32 v[28:29], v[28:29], v[156:157]
  v_pk_mul_f32 v[30:31], v[30:31], v[158:159]
  v_pk_mul_f32 v[32:33], v[32:33], v[160:161]
  v_pk_mul_f32 v[34:35], v[34:35], v[162:163]
  v_cvt_pk_bf16_f32 v176, v28, v29
  v_cvt_pk_bf16_f32 v177, v30, v31
  v_cvt_pk_bf16_f32 v178, v32, v33
  v_cvt_pk_bf16_f32 v179, v34, v35
  v_pk_fma_f32 v[48:49], v[128:129], v[220:221], v[48:49] op_sel_hi:[1,0,1]
  v_pk_fma_f32 v[50:51], v[130:131], v[220:221], v[50:51] op_sel_hi:[1,0,1]
  v_pk_fma_f32 v[52:53], v[132:133], v[220:221], v[52:53] op_sel_hi:[1,0,1]
  v_pk_fma_f32 v[54:55], v[134:135], v[220:221], v[54:55] op_sel_hi:[1,0,1]
  v_pk_fma_f32 v[68:69], v[128:129], v[224:225], v[68:69] op_sel_hi:[1,0,1]
  v_pk_fma_f32 v[70:71], v[130:131], v[224:225], v[70:71] op_sel_hi:[1,0,1]
  buffer_store_dwordx4 v[176:179], v236, s[16:19], s80 offen offset:1024 sc1
  v_pk_fma_f32 v[72:73], v[132:133], v[224:225], v[72:73] op_sel_hi:[1,0,1]
  v_pk_fma_f32 v[74:75], v[134:135], v[224:225], v[74:75] op_sel_hi:[1,0,1]
  v_pk_mul_f32 v[148:149], v[48:49], v[222:223] op_sel_hi:[1,0]
  v_pk_mul_f32 v[150:151], v[50:51], v[222:223] op_sel_hi:[1,0]
  v_pk_mul_f32 v[152:153], v[52:53], v[222:223] op_sel_hi:[1,0]
  v_pk_mul_f32 v[154:155], v[54:55], v[222:223] op_sel_hi:[1,0]
  v_pk_mul_f32 v[156:157], v[68:69], v[226:227] op_sel_hi:[1,0]
  v_pk_mul_f32 v[158:159], v[70:71], v[226:227] op_sel_hi:[1,0]
  v_pk_mul_f32 v[160:161], v[72:73], v[226:227] op_sel_hi:[1,0]
  v_pk_mul_f32 v[162:163], v[74:75], v[226:227] op_sel_hi:[1,0]
  v_exp_f32 v148, v148
  v_exp_f32 v149, v149
  buffer_load_dwordx4 v4, s[16:19], s71 offen offset:1024 sc1 lds
  v_exp_f32 v150, v150
  v_exp_f32 v151, v151
  v_exp_f32 v152, v152
  v_exp_f32 v153, v153
  v_exp_f32 v154, v154
  v_exp_f32 v155, v155
  v_exp_f32 v156, v156
  v_exp_f32 v157, v157
  v_exp_f32 v158, v158
  v_exp_f32 v159, v159
  v_exp_f32 v160, v160
  v_exp_f32 v161, v161
  buffer_load_dwordx4 v4, s[16:19], s71 offen offset:2048 sc1 lds
  v_exp_f32 v162, v162
  v_exp_f32 v163, v163
  v_pk_fma_f32 v[148:149], v[148:149], v[222:223], v[222:223] op_sel:[0,1,1] op_sel_hi:[1,1,1]
  v_pk_fma_f32 v[150:151], v[150:151], v[222:223], v[222:223] op_sel:[0,1,1] op_sel_hi:[1,1,1]
  v_pk_fma_f32 v[152:153], v[152:153], v[222:223], v[222:223] op_sel:[0,1,1] op_sel_hi:[1,1,1]
  v_pk_fma_f32 v[154:155], v[154:155], v[222:223], v[222:223] op_sel:[0,1,1] op_sel_hi:[1,1,1]
  v_pk_fma_f32 v[156:157], v[156:157], v[226:227], v[226:227] op_sel:[0,1,1] op_sel_hi:[1,1,1]
  v_pk_fma_f32 v[158:159], v[158:159], v[226:227], v[226:227] op_sel:[0,1,1] op_sel_hi:[1,1,1]
  v_pk_fma_f32 v[160:161], v[160:161], v[226:227], v[226:227] op_sel:[0,1,1] op_sel_hi:[1,1,1]
  v_pk_fma_f32 v[162:163], v[162:163], v[226:227], v[226:227] op_sel:[0,1,1] op_sel_hi:[1,1,1]
  v_rcp_f32 v148, v148
  v_rcp_f32 v149, v149
  buffer_load_dwordx4 v4, s[16:19], s71 offen offset:3072 sc1 lds
  v_rcp_f32 v150, v150
  v_rcp_f32 v151, v151
  v_rcp_f32 v152, v152
  v_rcp_f32 v153, v153
  v_rcp_f32 v154, v154
  v_rcp_f32 v155, v155
  v_rcp_f32 v156, v156
  v_rcp_f32 v157, v157
  v_rcp_f32 v158, v158
  v_rcp_f32 v159, v159
  v_rcp_f32 v160, v160
  v_rcp_f32 v161, v161
  v_rcp_f32 v162, v162
  v_rcp_f32 v163, v163
  v_pk_mul_f32 v[48:49], v[48:49], v[148:149]
  v_pk_mul_f32 v[50:51], v[50:51], v[150:151]
  v_pk_mul_f32 v[52:53], v[52:53], v[152:153]
  v_pk_mul_f32 v[54:55], v[54:55], v[154:155]
  v_cvt_pk_bf16_f32 v184, v48, v49
  v_cvt_pk_bf16_f32 v185, v50, v51
  v_cvt_pk_bf16_f32 v186, v52, v53
  v_cvt_pk_bf16_f32 v187, v54, v55
  buffer_store_dwordx4 v[184:187], v236, s[16:19], s81 offen offset:0 sc1
  v_pk_mul_f32 v[68:69], v[68:69], v[156:157]
  v_pk_mul_f32 v[70:71], v[70:71], v[158:159]
  v_pk_mul_f32 v[72:73], v[72:73], v[160:161]
  v_pk_mul_f32 v[74:75], v[74:75], v[162:163]
  v_cvt_pk_bf16_f32 v188, v68, v69
  v_cvt_pk_bf16_f32 v189, v70, v71
  v_cvt_pk_bf16_f32 v190, v72, v73
  v_cvt_pk_bf16_f32 v191, v74, v75
  v_pk_fma_f32 v[88:89], v[128:129], v[228:229], v[88:89] op_sel_hi:[1,0,1]
  v_pk_fma_f32 v[90:91], v[130:131], v[228:229], v[90:91] op_sel_hi:[1,0,1]
  v_pk_fma_f32 v[92:93], v[132:133], v[228:229], v[92:93] op_sel_hi:[1,0,1]
  v_pk_fma_f32 v[94:95], v[134:135], v[228:229], v[94:95] op_sel_hi:[1,0,1]
  v_pk_fma_f32 v[108:109], v[128:129], v[232:233], v[108:109] op_sel_hi:[1,0,1]
  v_pk_fma_f32 v[110:111], v[130:131], v[232:233], v[110:111] op_sel_hi:[1,0,1]
  buffer_store_dwordx4 v[188:191], v236, s[16:19], s81 offen offset:1024 sc1
  v_pk_fma_f32 v[112:113], v[132:133], v[232:233], v[112:113] op_sel_hi:[1,0,1]
  v_pk_fma_f32 v[114:115], v[134:135], v[232:233], v[114:115] op_sel_hi:[1,0,1]
  v_pk_mul_f32 v[148:149], v[88:89], v[230:231] op_sel_hi:[1,0]
  v_pk_mul_f32 v[150:151], v[90:91], v[230:231] op_sel_hi:[1,0]
  v_pk_mul_f32 v[152:153], v[92:93], v[230:231] op_sel_hi:[1,0]
  v_pk_mul_f32 v[154:155], v[94:95], v[230:231] op_sel_hi:[1,0]
  v_pk_mul_f32 v[156:157], v[108:109], v[234:235] op_sel_hi:[1,0]
  v_pk_mul_f32 v[158:159], v[110:111], v[234:235] op_sel_hi:[1,0]
  v_pk_mul_f32 v[160:161], v[112:113], v[234:235] op_sel_hi:[1,0]
  v_pk_mul_f32 v[162:163], v[114:115], v[234:235] op_sel_hi:[1,0]
  v_exp_f32 v148, v148
  v_exp_f32 v149, v149
  s_add_u32 m0, s69, 4096
  s_add_u32 s71, s70, 0
  s_nop 0
  buffer_load_dwordx4 v5, s[16:19], s71 offen offset:0 sc1 lds
  v_exp_f32 v150, v150
  v_exp_f32 v151, v151
  v_exp_f32 v152, v152
  v_exp_f32 v153, v153
  v_exp_f32 v154, v154
  v_exp_f32 v155, v155
  v_exp_f32 v156, v156
  v_exp_f32 v157, v157
  v_exp_f32 v158, v158
  v_exp_f32 v159, v159
  v_exp_f32 v160, v160
  v_exp_f32 v161, v161
  s_add_u32 m0, s69, 20480
  s_add_u32 s71, s70, 65536
  buffer_load_dwordx4 v4, s[16:19], s71 offen offset:0 sc1 lds
  v_exp_f32 v162, v162
  v_exp_f32 v163, v163
  v_pk_fma_f32 v[148:149], v[148:149], v[230:231], v[230:231] op_sel:[0,1,1] op_sel_hi:[1,1,1]
  v_pk_fma_f32 v[150:151], v[150:151], v[230:231], v[230:231] op_sel:[0,1,1] op_sel_hi:[1,1,1]
  v_pk_fma_f32 v[152:153], v[152:153], v[230:231], v[230:231] op_sel:[0,1,1] op_sel_hi:[1,1,1]
  v_pk_fma_f32 v[154:155], v[154:155], v[230:231], v[230:231] op_sel:[0,1,1] op_sel_hi:[1,1,1]
  v_pk_fma_f32 v[156:157], v[156:157], v[234:235], v[234:235] op_sel:[0,1,1] op_sel_hi:[1,1,1]
  v_pk_fma_f32 v[158:159], v[158:159], v[234:235], v[234:235] op_sel:[0,1,1] op_sel_hi:[1,1,1]
  v_pk_fma_f32 v[160:161], v[160:161], v[234:235], v[234:235] op_sel:[0,1,1] op_sel_hi:[1,1,1]
  v_pk_fma_f32 v[162:163], v[162:163], v[234:235], v[234:235] op_sel:[0,1,1] op_sel_hi:[1,1,1]
  v_rcp_f32 v148, v148
  v_rcp_f32 v149, v149
  buffer_load_dwordx4 v4, s[16:19], s71 offen offset:1024 sc1 lds
  v_rcp_f32 v150, v150
  v_rcp_f32 v151, v151
  v_rcp_f32 v152, v152
  v_rcp_f32 v153, v153
  v_rcp_f32 v154, v154
  v_rcp_f32 v155, v155
  v_rcp_f32 v156, v156
  v_rcp_f32 v157, v157
  v_rcp_f32 v158, v158
  v_rcp_f32 v159, v159
  v_rcp_f32 v160, v160
  v_rcp_f32 v161, v161
  v_rcp_f32 v162, v162
  v_rcp_f32 v163, v163
  v_pk_mul_f32 v[88:89], v[88:89], v[148:149]
  v_pk_mul_f32 v[90:91], v[90:91], v[150:151]
  v_pk_mul_f32 v[92:93], v[92:93], v[152:153]
  v_pk_mul_f32 v[94:95], v[94:95], v[154:155]
  v_cvt_pk_bf16_f32 v172, v88, v89
  v_cvt_pk_bf16_f32 v173, v90, v91
  v_cvt_pk_bf16_f32 v174, v92, v93
  v_cvt_pk_bf16_f32 v175, v94, v95
  buffer_store_dwordx4 v[172:175], v236, s[16:19], s82 offen offset:0 sc1
  v_pk_mul_f32 v[108:109], v[108:109], v[156:157]
  v_pk_mul_f32 v[110:111], v[110:111], v[158:159]
  v_pk_mul_f32 v[112:113], v[112:113], v[160:161]
  v_pk_mul_f32 v[114:115], v[114:115], v[162:163]
  v_cvt_pk_bf16_f32 v176, v108, v109
  v_cvt_pk_bf16_f32 v177, v110, v111
  v_cvt_pk_bf16_f32 v178, v112, v113
  v_cvt_pk_bf16_f32 v179, v114, v115
  v_pk_fma_f32 v[16:17], v[136:137], v[212:213], v[16:17] op_sel_hi:[1,0,1]
  v_pk_fma_f32 v[18:19], v[138:139], v[212:213], v[18:19] op_sel_hi:[1,0,1]
  v_pk_fma_f32 v[20:21], v[140:141], v[212:213], v[20:21] op_sel_hi:[1,0,1]
  v_pk_fma_f32 v[22:23], v[142:143], v[212:213], v[22:23] op_sel_hi:[1,0,1]
  v_pk_fma_f32 v[36:37], v[136:137], v[216:217], v[36:37] op_sel_hi:[1,0,1]
  v_pk_fma_f32 v[38:39], v[138:139], v[216:217], v[38:39] op_sel_hi:[1,0,1]
  buffer_store_dwordx4 v[176:179], v236, s[16:19], s82 offen offset:1024 sc1
  v_pk_fma_f32 v[40:41], v[140:141], v[216:217], v[40:41] op_sel_hi:[1,0,1]
  v_pk_fma_f32 v[42:43], v[142:143], v[216:217], v[42:43] op_sel_hi:[1,0,1]
  v_pk_mul_f32 v[148:149], v[16:17], v[214:215] op_sel_hi:[1,0]
  v_pk_mul_f32 v[150:151], v[18:19], v[214:215] op_sel_hi:[1,0]
  v_pk_mul_f32 v[152:153], v[20:21], v[214:215] op_sel_hi:[1,0]
  v_pk_mul_f32 v[154:155], v[22:23], v[214:215] op_sel_hi:[1,0]
  v_pk_mul_f32 v[156:157], v[36:37], v[218:219] op_sel_hi:[1,0]
  v_pk_mul_f32 v[158:159], v[38:39], v[218:219] op_sel_hi:[1,0]
  v_pk_mul_f32 v[160:161], v[40:41], v[218:219] op_sel_hi:[1,0]
  v_pk_mul_f32 v[162:163], v[42:43], v[218:219] op_sel_hi:[1,0]
  v_exp_f32 v148, v148
  v_exp_f32 v149, v149
  buffer_load_dwordx4 v4, s[16:19], s71 offen offset:2048 sc1 lds
  v_exp_f32 v150, v150
  v_exp_f32 v151, v151
  v_exp_f32 v152, v152
  v_exp_f32 v153, v153
  v_exp_f32 v154, v154
  v_exp_f32 v155, v155
  v_exp_f32 v156, v156
  v_exp_f32 v157, v157
  v_exp_f32 v158, v158
  v_exp_f32 v159, v159
  v_exp_f32 v160, v160
  v_exp_f32 v161, v161
  buffer_load_dwordx4 v4, s[16:19], s71 offen offset:3072 sc1 lds
  v_exp_f32 v162, v162
  v_exp_f32 v163, v163
  v_pk_fma_f32 v[148:149], v[148:149], v[214:215], v[214:215] op_sel:[0,1,1] op_sel_hi:[1,1,1]
  v_pk_fma_f32 v[150:151], v[150:151], v[214:215], v[214:215] op_sel:[0,1,1] op_sel_hi:[1,1,1]
  v_pk_fma_f32 v[152:153], v[152:153], v[214:215], v[214:215] op_sel:[0,1,1] op_sel_hi:[1,1,1]
  v_pk_fma_f32 v[154:155], v[154:155], v[214:215], v[214:215] op_sel:[0,1,1] op_sel_hi:[1,1,1]
  v_pk_fma_f32 v[156:157], v[156:157], v[218:219], v[218:219] op_sel:[0,1,1] op_sel_hi:[1,1,1]
  v_pk_fma_f32 v[158:159], v[158:159], v[218:219], v[218:219] op_sel:[0,1,1] op_sel_hi:[1,1,1]
  v_pk_fma_f32 v[160:161], v[160:161], v[218:219], v[218:219] op_sel:[0,1,1] op_sel_hi:[1,1,1]
  v_pk_fma_f32 v[162:163], v[162:163], v[218:219], v[218:219] op_sel:[0,1,1] op_sel_hi:[1,1,1]
  v_rcp_f32 v148, v148
  v_rcp_f32 v149, v149
  s_add_u32 m0, s69, 24576
  s_add_u32 s71, s70, 65536
  buffer_load_dwordx4 v5, s[16:19], s71 offen offset:0 sc1 lds
  v_rcp_f32 v150, v150
  v_rcp_f32 v151, v151
  v_rcp_f32 v152, v152
  v_rcp_f32 v153, v153
  v_rcp_f32 v154, v154
  v_rcp_f32 v155, v155
  v_rcp_f32 v156, v156
  v_rcp_f32 v157, v157
  v_rcp_f32 v158, v158
  v_rcp_f32 v159, v159
  v_rcp_f32 v160, v160
  v_rcp_f32 v161, v161
  v_rcp_f32 v162, v162
  v_rcp_f32 v163, v163
  v_pk_mul_f32 v[16:17], v[16:17], v[148:149]
  v_pk_mul_f32 v[18:19], v[18:19], v[150:151]
  v_pk_mul_f32 v[20:21], v[20:21], v[152:153]
  v_pk_mul_f32 v[22:23], v[22:23], v[154:155]
  v_cvt_pk_bf16_f32 v184, v16, v17
  v_cvt_pk_bf16_f32 v185, v18, v19
  v_cvt_pk_bf16_f32 v186, v20, v21
  v_cvt_pk_bf16_f32 v187, v22, v23
  buffer_store_dwordx4 v[184:187], v237, s[16:19], s80 offen offset:0 sc1
  v_pk_mul_f32 v[36:37], v[36:37], v[156:157]
  v_pk_mul_f32 v[38:39], v[38:39], v[158:159]
  v_pk_mul_f32 v[40:41], v[40:41], v[160:161]
  v_pk_mul_f32 v[42:43], v[42:43], v[162:163]
  v_cvt_pk_bf16_f32 v188, v36, v37
  v_cvt_pk_bf16_f32 v189, v38, v39
  v_cvt_pk_bf16_f32 v190, v40, v41
  v_cvt_pk_bf16_f32 v191, v42, v43
  v_pk_fma_f32 v[56:57], v[136:137], v[220:221], v[56:57] op_sel_hi:[1,0,1]
  v_pk_fma_f32 v[58:59], v[138:139], v[220:221], v[58:59] op_sel_hi:[1,0,1]
  v_pk_fma_f32 v[60:61], v[140:141], v[220:221], v[60:61] op_sel_hi:[1,0,1]
  v_pk_fma_f32 v[62:63], v[142:143], v[220:221], v[62:63] op_sel_hi:[1,0,1]
  v_pk_fma_f32 v[76:77], v[136:137], v[224:225], v[76:77] op_sel_hi:[1,0,1]
  v_pk_fma_f32 v[78:79], v[138:139], v[224:225], v[78:79] op_sel_hi:[1,0,1]
  buffer_store_dwordx4 v[188:191], v237, s[16:19], s80 offen offset:1024 sc1
  v_pk_fma_f32 v[80:81], v[140:141], v[224:225], v[80:81] op_sel_hi:[1,0,1]
  v_pk_fma_f32 v[82:83], v[142:143], v[224:225], v[82:83] op_sel_hi:[1,0,1]
  v_pk_mul_f32 v[148:149], v[56:57], v[222:223] op_sel_hi:[1,0]
  v_pk_mul_f32 v[150:151], v[58:59], v[222:223] op_sel_hi:[1,0]
  v_pk_mul_f32 v[152:153], v[60:61], v[222:223] op_sel_hi:[1,0]
  v_pk_mul_f32 v[154:155], v[62:63], v[222:223] op_sel_hi:[1,0]
  v_pk_mul_f32 v[156:157], v[76:77], v[226:227] op_sel_hi:[1,0]
  v_pk_mul_f32 v[158:159], v[78:79], v[226:227] op_sel_hi:[1,0]
  v_pk_mul_f32 v[160:161], v[80:81], v[226:227] op_sel_hi:[1,0]
  v_pk_mul_f32 v[162:163], v[82:83], v[226:227] op_sel_hi:[1,0]
  v_exp_f32 v148, v148
  v_exp_f32 v149, v149
  s_add_u32 m0, s69, 40960
  s_add_u32 s71, s70, 131072
  buffer_load_dwordx4 v4, s[16:19], s71 offen offset:0 sc1 lds
  v_exp_f32 v150, v150
  v_exp_f32 v151, v151
  v_exp_f32 v152, v152
  v_exp_f32 v153, v153
  v_exp_f32 v154, v154
  v_exp_f32 v155, v155
  v_exp_f32 v156, v156
  v_exp_f32 v157, v157
  v_exp_f32 v158, v158
  v_exp_f32 v159, v159
  v_exp_f32 v160, v160
  v_exp_f32 v161, v161
  buffer_load_dwordx4 v4, s[16:19], s71 offen offset:1024 sc1 lds
  v_exp_f32 v162, v162
  v_exp_f32 v163, v163
  v_pk_fma_f32 v[148:149], v[148:149], v[222:223], v[222:223] op_sel:[0,1,1] op_sel_hi:[1,1,1]
  v_pk_fma_f32 v[150:151], v[150:151], v[222:223], v[222:223] op_sel:[0,1,1] op_sel_hi:[1,1,1]
  v_pk_fma_f32 v[152:153], v[152:153], v[222:223], v[222:223] op_sel:[0,1,1] op_sel_hi:[1,1,1]
  v_pk_fma_f32 v[154:155], v[154:155], v[222:223], v[222:223] op_sel:[0,1,1] op_sel_hi:[1,1,1]
  v_pk_fma_f32 v[156:157], v[156:157], v[226:227], v[226:227] op_sel:[0,1,1] op_sel_hi:[1,1,1]
  v_pk_fma_f32 v[158:159], v[158:159], v[226:227], v[226:227] op_sel:[0,1,1] op_sel_hi:[1,1,1]
  v_pk_fma_f32 v[160:161], v[160:161], v[226:227], v[226:227] op_sel:[0,1,1] op_sel_hi:[1,1,1]
  v_pk_fma_f32 v[162:163], v[162:163], v[226:227], v[226:227] op_sel:[0,1,1] op_sel_hi:[1,1,1]
  v_rcp_f32 v148, v148
  v_rcp_f32 v149, v149
  s_waitcnt vmcnt(7)
  s_barrier
  v_mov_b32 v3, s39
  v_lshlrev_b32 v6, 25, v7
  buffer_store_dword v3, v6, s[16:19], s75 offen sc1
  v_rcp_f32 v150, v150
  v_rcp_f32 v151, v151
  v_rcp_f32 v152, v152
  v_rcp_f32 v153, v153
  v_rcp_f32 v154, v154
  v_rcp_f32 v155, v155
  v_rcp_f32 v156, v156
  v_rcp_f32 v157, v157
  v_rcp_f32 v158, v158
  v_rcp_f32 v159, v159
  v_rcp_f32 v160, v160
  v_rcp_f32 v161, v161
  v_rcp_f32 v162, v162
  v_rcp_f32 v163, v163
  v_pk_mul_f32 v[56:57], v[56:57], v[148:149]
  v_pk_mul_f32 v[58:59], v[58:59], v[150:151]
  v_pk_mul_f32 v[60:61], v[60:61], v[152:153]
  v_pk_mul_f32 v[62:63], v[62:63], v[154:155]
  v_cvt_pk_bf16_f32 v172, v56, v57
  v_cvt_pk_bf16_f32 v173, v58, v59
  v_cvt_pk_bf16_f32 v174, v60, v61
  v_cvt_pk_bf16_f32 v175, v62, v63
  buffer_store_dwordx4 v[172:175], v237, s[16:19], s81 offen offset:0 sc1
  v_pk_mul_f32 v[76:77], v[76:77], v[156:157]
  v_pk_mul_f32 v[78:79], v[78:79], v[158:159]
  v_pk_mul_f32 v[80:81], v[80:81], v[160:161]
  v_pk_mul_f32 v[82:83], v[82:83], v[162:163]
  v_cvt_pk_bf16_f32 v176, v76, v77
  v_cvt_pk_bf16_f32 v177, v78, v79
  v_cvt_pk_bf16_f32 v178, v80, v81
  v_cvt_pk_bf16_f32 v179, v82, v83
  v_pk_fma_f32 v[96:97], v[136:137], v[228:229], v[96:97] op_sel_hi:[1,0,1]
  v_pk_fma_f32 v[98:99], v[138:139], v[228:229], v[98:99] op_sel_hi:[1,0,1]
  v_pk_fma_f32 v[100:101], v[140:141], v[228:229], v[100:101] op_sel_hi:[1,0,1]
  v_pk_fma_f32 v[102:103], v[142:143], v[228:229], v[102:103] op_sel_hi:[1,0,1]
  v_pk_fma_f32 v[116:117], v[136:137], v[232:233], v[116:117] op_sel_hi:[1,0,1]
  v_pk_fma_f32 v[118:119], v[138:139], v[232:233], v[118:119] op_sel_hi:[1,0,1]
  buffer_store_dwordx4 v[176:179], v237, s[16:19], s81 offen offset:1024 sc1
  v_pk_fma_f32 v[120:121], v[140:141], v[232:233], v[120:121] op_sel_hi:[1,0,1]
  v_pk_fma_f32 v[122:123], v[142:143], v[232:233], v[122:123] op_sel_hi:[1,0,1]
  v_pk_mul_f32 v[148:149], v[96:97], v[230:231] op_sel_hi:[1,0]
  v_pk_mul_f32 v[150:151], v[98:99], v[230:231] op_sel_hi:[1,0]
  v_pk_mul_f32 v[152:153], v[100:101], v[230:231] op_sel_hi:[1,0]
  v_pk_mul_f32 v[154:155], v[102:103], v[230:231] op_sel_hi:[1,0]
  v_pk_mul_f32 v[156:157], v[116:117], v[234:235] op_sel_hi:[1,0]
  v_pk_mul_f32 v[158:159], v[118:119], v[234:235] op_sel_hi:[1,0]
  v_pk_mul_f32 v[160:161], v[120:121], v[234:235] op_sel_hi:[1,0]
  v_pk_mul_f32 v[162:163], v[122:123], v[234:235] op_sel_hi:[1,0]
  v_exp_f32 v148, v148
  v_exp_f32 v149, v149
  buffer_load_dwordx4 v4, s[16:19], s71 offen offset:2048 sc1 lds
  v_exp_f32 v150, v150
  v_exp_f32 v151, v151
  v_exp_f32 v152, v152
  v_exp_f32 v153, v153
  v_exp_f32 v154, v154
  v_exp_f32 v155, v155
  v_exp_f32 v156, v156
  v_exp_f32 v157, v157
  v_exp_f32 v158, v158
  v_exp_f32 v159, v159
  v_exp_f32 v160, v160
  v_exp_f32 v161, v161
  buffer_load_dwordx4 v4, s[16:19], s71 offen offset:3072 sc1 lds
  v_exp_f32 v162, v162
  v_exp_f32 v163, v163
  v_pk_fma_f32 v[148:149], v[148:149], v[230:231], v[230:231] op_sel:[0,1,1] op_sel_hi:[1,1,1]
  v_pk_fma_f32 v[150:151], v[150:151], v[230:231], v[230:231] op_sel:[0,1,1] op_sel_hi:[1,1,1]
  v_pk_fma_f32 v[152:153], v[152:153], v[230:231], v[230:231] op_sel:[0,1,1] op_sel_hi:[1,1,1]
  v_pk_fma_f32 v[154:155], v[154:155], v[230:231], v[230:231] op_sel:[0,1,1] op_sel_hi:[1,1,1]
  v_pk_fma_f32 v[156:157], v[156:157], v[234:235], v[234:235] op_sel:[0,1,1] op_sel_hi:[1,1,1]
  v_pk_fma_f32 v[158:159], v[158:159], v[234:235], v[234:235] op_sel:[0,1,1] op_sel_hi:[1,1,1]
  v_pk_fma_f32 v[160:161], v[160:161], v[234:235], v[234:235] op_sel:[0,1,1] op_sel_hi:[1,1,1]
  v_pk_fma_f32 v[162:163], v[162:163], v[234:235], v[234:235] op_sel:[0,1,1] op_sel_hi:[1,1,1]
  v_rcp_f32 v148, v148
  v_rcp_f32 v149, v149
  s_add_u32 m0, s69, 45056
  s_add_u32 s71, s70, 131072
  buffer_load_dwordx4 v5, s[16:19], s71 offen offset:0 sc1 lds
  v_rcp_f32 v150, v150
  v_rcp_f32 v151, v151
  v_rcp_f32 v152, v152
  v_rcp_f32 v153, v153
  v_rcp_f32 v154, v154
  v_rcp_f32 v155, v155
  v_rcp_f32 v156, v156
  v_rcp_f32 v157, v157
  v_rcp_f32 v158, v158
  v_rcp_f32 v159, v159
  v_rcp_f32 v160, v160
  v_rcp_f32 v161, v161
  v_rcp_f32 v162, v162
  v_rcp_f32 v163, v163
  v_pk_mul_f32 v[96:97], v[96:97], v[148:149]
  v_pk_mul_f32 v[98:99], v[98:99], v[150:151]
  v_pk_mul_f32 v[100:101], v[100:101], v[152:153]
  v_pk_mul_f32 v[102:103], v[102:103], v[154:155]
  v_cvt_pk_bf16_f32 v184, v96, v97
  v_cvt_pk_bf16_f32 v185, v98, v99
  v_cvt_pk_bf16_f32 v186, v100, v101
  v_cvt_pk_bf16_f32 v187, v102, v103
  buffer_store_dwordx4 v[184:187], v237, s[16:19], s82 offen offset:0 sc1
  v_pk_mul_f32 v[116:117], v[116:117], v[156:157]
  v_pk_mul_f32 v[118:119], v[118:119], v[158:159]
  v_pk_mul_f32 v[120:121], v[120:121], v[160:161]
  v_pk_mul_f32 v[122:123], v[122:123], v[162:163]
  v_cvt_pk_bf16_f32 v188, v116, v117
  v_cvt_pk_bf16_f32 v189, v118, v119
  v_cvt_pk_bf16_f32 v190, v120, v121
  v_cvt_pk_bf16_f32 v191, v122, v123
  v_pk_fma_f32 v[24:25], v[144:145], v[212:213], v[24:25] op_sel_hi:[1,0,1]
  v_pk_fma_f32 v[26:27], v[146:147], v[212:213], v[26:27] op_sel_hi:[1,0,1]
  v_pk_fma_f32 v[44:45], v[144:145], v[216:217], v[44:45] op_sel_hi:[1,0,1]
  v_pk_fma_f32 v[46:47], v[146:147], v[216:217], v[46:47] op_sel_hi:[1,0,1]
  v_pk_fma_f32 v[64:65], v[144:145], v[220:221], v[64:65] op_sel_hi:[1,0,1]
  v_pk_fma_f32 v[66:67], v[146:147], v[220:221], v[66:67] op_sel_hi:[1,0,1]
  buffer_store_dwordx4 v[188:191], v237, s[16:19], s82 offen offset:1024 sc1
  v_pk_fma_f32 v[84:85], v[144:145], v[224:225], v[84:85] op_sel_hi:[1,0,1]
  v_pk_fma_f32 v[86:87], v[146:147], v[224:225], v[86:87] op_sel_hi:[1,0,1]
  v_pk_fma_f32 v[104:105], v[144:145], v[228:229], v[104:105] op_sel_hi:[1,0,1]
  v_pk_fma_f32 v[106:107], v[146:147], v[228:229], v[106:107] op_sel_hi:[1,0,1]
  v_pk_fma_f32 v[124:125], v[144:145], v[232:233], v[124:125] op_sel_hi:[1,0,1]
  v_pk_fma_f32 v[126:127], v[146:147], v[232:233], v[126:127] op_sel_hi:[1,0,1]
  v_pk_mul_f32 v[148:149], v[24:25], v[214:215] op_sel_hi:[1,0]
  v_pk_mul_f32 v[150:151], v[26:27], v[214:215] op_sel_hi:[1,0]
  v_pk_mul_f32 v[152:153], v[44:45], v[218:219] op_sel_hi:[1,0]
  v_pk_mul_f32 v[154:155], v[46:47], v[218:219] op_sel_hi:[1,0]
  v_pk_mul_f32 v[156:157], v[64:65], v[222:223] op_sel_hi:[1,0]
  v_pk_mul_f32 v[158:159], v[66:67], v[222:223] op_sel_hi:[1,0]
  v_pk_mul_f32 v[160:161], v[84:85], v[226:227] op_sel_hi:[1,0]
  v_pk_mul_f32 v[162:163], v[86:87], v[226:227] op_sel_hi:[1,0]
  v_pk_mul_f32 v[164:165], v[104:105], v[230:231] op_sel_hi:[1,0]
  v_pk_mul_f32 v[166:167], v[106:107], v[230:231] op_sel_hi:[1,0]
  v_pk_mul_f32 v[168:169], v[124:125], v[234:235] op_sel_hi:[1,0]
  v_pk_mul_f32 v[170:171], v[126:127], v[234:235] op_sel_hi:[1,0]
  v_exp_f32 v148, v148
  v_exp_f32 v149, v149
  v_exp_f32 v150, v150
  v_exp_f32 v151, v151
  v_exp_f32 v152, v152
  v_exp_f32 v153, v153
  v_exp_f32 v154, v154
  v_exp_f32 v155, v155
  s_add_u32 m0, s69, 61440
  s_add_u32 s71, s70, 196608
  buffer_load_dwordx4 v4, s[16:19], s71 offen offset:0 sc1 lds
  v_exp_f32 v156, v156
  v_exp_f32 v157, v157
  v_exp_f32 v158, v158
  v_exp_f32 v159, v159
  v_exp_f32 v160, v160
  v_exp_f32 v161, v161
  v_exp_f32 v162, v162
  v_exp_f32 v163, v163
  v_exp_f32 v164, v164
  v_exp_f32 v165, v165
  v_exp_f32 v166, v166
  v_exp_f32 v167, v167
  v_exp_f32 v168, v168
  v_exp_f32 v169, v169
  v_exp_f32 v170, v170
  v_exp_f32 v171, v171
  v_pk_fma_f32 v[148:149], v[148:149], v[214:215], v[214:215] op_sel:[0,1,1] op_sel_hi:[1,1,1]
  v_pk_fma_f32 v[150:151], v[150:151], v[214:215], v[214:215] op_sel:[0,1,1] op_sel_hi:[1,1,1]
  v_pk_fma_f32 v[152:153], v[152:153], v[218:219], v[218:219] op_sel:[0,1,1] op_sel_hi:[1,1,1]
  v_pk_fma_f32 v[154:155], v[154:155], v[218:219], v[218:219] op_sel:[0,1,1] op_sel_hi:[1,1,1]
  v_pk_fma_f32 v[156:157], v[156:157], v[222:223], v[222:223] op_sel:[0,1,1] op_sel_hi:[1,1,1]
  v_pk_fma_f32 v[158:159], v[158:159], v[222:223], v[222:223] op_sel:[0,1,1] op_sel_hi:[1,1,1]
  v_pk_fma_f32 v[160:161], v[160:161], v[226:227], v[226:227] op_sel:[0,1,1] op_sel_hi:[1,1,1]
  v_pk_fma_f32 v[162:163], v[162:163], v[226:227], v[226:227] op_sel:[0,1,1] op_sel_hi:[1,1,1]
  v_pk_fma_f32 v[164:165], v[164:165], v[230:231], v[230:231] op_sel:[0,1,1] op_sel_hi:[1,1,1]
  v_pk_fma_f32 v[166:167], v[166:167], v[230:231], v[230:231] op_sel:[0,1,1] op_sel_hi:[1,1,1]
  buffer_load_dwordx4 v4, s[16:19], s71 offen offset:1024 sc1 lds
  v_pk_fma_f32 v[168:169], v[168:169], v[234:235], v[234:235] op_sel:[0,1,1] op_sel_hi:[1,1,1]
  v_pk_fma_f32 v[170:171], v[170:171], v[234:235], v[234:235] op_sel:[0,1,1] op_sel_hi:[1,1,1]
  v_rcp_f32 v148, v148
  v_rcp_f32 v149, v149
  v_rcp_f32 v150, v150
  v_rcp_f32 v151, v151
  v_rcp_f32 v152, v152
  v_rcp_f32 v153, v153
  v_rcp_f32 v154, v154
  v_rcp_f32 v155, v155
  v_rcp_f32 v156, v156
  v_rcp_f32 v157, v157
  v_rcp_f32 v158, v158
  v_rcp_f32 v159, v159
  v_rcp_f32 v160, v160
  v_rcp_f32 v161, v161
  v_rcp_f32 v162, v162
  v_rcp_f32 v163, v163
  v_rcp_f32 v164, v164
  v_rcp_f32 v165, v165
  v_rcp_f32 v166, v166
  v_rcp_f32 v167, v167
  v_rcp_f32 v168, v168
  v_rcp_f32 v169, v169
  v_rcp_f32 v170, v170
  v_rcp_f32 v171, v171
  v_pk_mul_f32 v[24:25], v[24:25], v[148:149]
  v_pk_mul_f32 v[26:27], v[26:27], v[150:151]
  v_pk_mul_f32 v[44:45], v[44:45], v[152:153]
  v_pk_mul_f32 v[46:47], v[46:47], v[154:155]
  v_cvt_pk_bf16_f32 v172, v24, v25
  v_cvt_pk_bf16_f32 v173, v26, v27
  v_cvt_pk_bf16_f32 v174, v44, v45
  v_cvt_pk_bf16_f32 v175, v46, v47
  s_nop 0
  v_permlane16_swap_b32 v172, v174
  v_permlane16_swap_b32 v173, v175
  s_nop 0
  buffer_store_dwordx4 v[172:175], v238, s[16:19], s80 offen sc1
  v_pk_mul_f32 v[64:65], v[64:65], v[156:157]
  v_pk_mul_f32 v[66:67], v[66:67], v[158:159]
  v_pk_mul_f32 v[84:85], v[84:85], v[160:161]
  v_pk_mul_f32 v[86:87], v[86:87], v[162:163]
  v_cvt_pk_bf16_f32 v176, v64, v65
  v_cvt_pk_bf16_f32 v177, v66, v67
  v_cvt_pk_bf16_f32 v178, v84, v85
  v_cvt_pk_bf16_f32 v179, v86, v87
  s_nop 0
  v_permlane16_swap_b32 v176, v178
  v_permlane16_swap_b32 v177, v179
  s_nop 0
  buffer_store_dwordx4 v[176:179], v238, s[16:19], s81 offen sc1
  v_pk_mul_f32 v[104:105], v[104:105], v[164:165]
  v_pk_mul_f32 v[106:107], v[106:107], v[166:167]
  v_pk_mul_f32 v[124:125], v[124:125], v[168:169]
  v_pk_mul_f32 v[126:127], v[126:127], v[170:171]
  v_cvt_pk_bf16_f32 v180, v104, v105
  v_cvt_pk_bf16_f32 v181, v106, v107
  v_cvt_pk_bf16_f32 v182, v124, v125
  v_cvt_pk_bf16_f32 v183, v126, v127
  s_nop 0
  v_permlane16_swap_b32 v180, v182
  v_permlane16_swap_b32 v181, v183
  s_nop 0
  buffer_store_dwordx4 v[180:183], v238, s[16:19], s82 offen sc1
k_p2:
  s_cmp_eq_u32 s20, 0
  s_cselect_b32 s55, 0, 1073741824
  s_cselect_b64 s[56:57], -1, 0
  s_and_b32 s21, s2, 3
  s_lshl_b32 s21, s21, 2
  s_bfe_u32 s28, s2, 0x20003
  s_add_u32 s21, s21, s28
  s_and_b32 s23, s2, 4
  s_lshl_b32 s23, s23, 1
  s_lshr_b32 s28, s2, 5
  s_add_u32 s23, s23, s28
  v_accvgpr_read_b32 v239, a220
  s_add_u32 m0, s69, 61440
  s_add_u32 s71, s70, 196608
  buffer_load_dwordx4 v4, s[16:19], s71 offen offset:2048 sc1 lds
  buffer_load_dwordx4 v4, s[16:19], s71 offen offset:3072 sc1 lds
  v_accvgpr_read_b32 v238, a221
  s_mul_i32 s54, s21, 5
  s_lshr_b32 s54, s54, 2
  s_lshl_b32 s60, s21, 12
  s_add_u32 s60, s60, 262144
  v_lshlrev_b32 v3, 4, v0
  v_cmp_gt_u32 vcc, 210, v0
  v_mov_b32 v6, 1073741824
  s_nop 0
  v_cndmask_b32 v236, v6, v3, vcc
  s_lshl_b32 s76, s23, 1
  s_add_u32 s76, s76, s51
  s_and_b32 s28, s76, 15
  s_lshr_b32 s28, s28, 2
  s_add_u32 s28, s28, 9
  s_lshr_b32 s29, s76, 4
  s_xor_b32 s29, s29, s28
  s_and_b32 s29, s29, 1
  s_lshl_b32 s29, s29, 13
  s_lshl_b32 s28, s28, 21
  s_add_u32 s28, s28, s29
  s_and_b32 s29, s76, 3
  s_mul_i32 s29, s29, 327680
  s_add_u32 s28, s28, s29
  s_add_u32 s63, s28, 0
  s_xor_b32 s63, s63, s3
  s_lshl_b32 s30, s52, 11
  s_add_u32 s63, s63, s30
  s_add_u32 s62, s54, 1
  buffer_load_dword v255, v239, s[16:19], s55 offen sc1
  s_lshr_b32 s28, s54, 1
  s_lshl_b32 s28, s28, 14
  s_and_b32 s61, s54, 1
  s_lshl_b32 s61, s61, 12
  s_add_u32 s61, s61, s28
  s_lshr_b32 s28, s62, 1
  s_lshl_b32 s28, s28, 14
  s_and_b32 s62, s62, 1
  s_lshl_b32 s62, s62, 12
  s_add_u32 s62, s62, s28
  s_add_u32 s61, s61, s63
  s_add_u32 s62, s62, s63
  s_add_u32 s63, s63, 163840
  s_and_b32 s28, s24, 15
  s_lshr_b32 s28, s28, 1
  s_add_u32 s28, s28, 1
  s_lshr_b32 s29, s24, 4
  s_xor_b32 s29, s29, s28
  s_and_b32 s29, s29, 1
  s_lshl_b32 s29, s29, 13
  s_lshl_b32 s28, s28, 21
  s_add_u32 s28, s28, s29
  s_and_b32 s29, s24, 1
  s_mul_i32 s29, s29, 442368
  s_add_u32 s28, s28, s29
  s_add_u32 s40, s28, 1212416
  s_lshr_b32 s29, s47, 1
  s_lshl_b32 s29, s29, 14
  s_add_u32 m0, s69, 65536
  s_add_u32 s71, s70, 196608
  buffer_load_dwordx4 v5, s[16:19], s71 offen offset:0 sc1 lds
  s_add_u32 m0, s69, 81920
  s_add_u32 s71, s70, 262144
  buffer_load_dwordx4 v4, s[16:19], s71 offen offset:0 sc1 lds
  s_and_b32 s30, s47, 1
  s_lshl_b32 s30, s30, 12
  s_add_u32 s30, s30, s29
  s_xor_b32 s40, s40, s3
  s_add_u32 s44, s40, s30
  s_bitcmp1_b32 s24, 0
  s_mov_b32 s28, 442368
  s_cselect_b32 s28, 4294524928, s28
  s_add_u32 s45, s44, s28
  s_add_u32 s28, s20, 0
  s_and_b32 s28, s28, 3
  s_lshl_b32 s28, s28, 10
  v_add_u32 v244, s28, v4
  s_add_u32 s28, s20, 1
  s_and_b32 s28, s28, 3
  s_lshl_b32 s28, s28, 10
  v_add_u32 v245, s28, v4
  s_add_u32 s28, s20, 2
  s_and_b32 s28, s28, 3
  s_lshl_b32 s28, s28, 10
  v_add_u32 v246, s28, v4
  s_add_u32 s28, s20, 3
  s_and_b32 s28, s28, 3
  s_lshl_b32 s28, s28, 10
  v_add_u32 v247, s28, v4
  v_and_b32 v1, 15, v7
  v_lshrrev_b32 v2, 4, v7
  s_mov_b32 s37, 102400
  v_accvgpr_read_b32 v168, a204
  v_accvgpr_read_b32 v169, a205
  v_accvgpr_read_b32 v170, a206
  s_waitcnt vmcnt(5)
  s_barrier
  v_mov_b32 v224, s39
  v_lshlrev_b32 v225, 25, v7
  buffer_store_dword v224, v225, s[16:19], s67 offen sc1
  s_waitcnt vmcnt(3)
  s_mov_b64 s[58:59], vcc
  v_cmp_ne_u32 vcc, s39, v255
  s_nop 1
  s_and_b64 vcc, vcc, s[56:57]
  s_cbranch_scc1 k_s1_slow
k_s1_ok:
  s_barrier
  s_mov_b64 vcc, s[58:59]
  s_add_u32 s41, s45, 0
  buffer_load_dwordx4 a[140:143], v244, s[16:19], s41 offen sc1
  buffer_load_dwordx4 a[144:147], v245, s[16:19], s41 offen sc1
  s_add_u32 s41, s45, 65536
  buffer_load_dwordx4 a[148:151], v244, s[16:19], s41 offen sc1
  buffer_load_dwordx4 a[152:155], v245, s[16:19], s41 offen sc1
  s_add_u32 s41, s45, 0
  buffer_load_dwordx4 a[156:159], v246, s[16:19], s41 offen sc1
  buffer_load_dwordx4 a[160:163], v247, s[16:19], s41 offen sc1
  s_add_u32 s41, s45, 65536
  buffer_load_dwordx4 a[164:167], v246, s[16:19], s41 offen sc1
  buffer_load_dwordx4 a[168:171], v247, s[16:19], s41 offen sc1
  s_add_u32 s41, s44, 0
  buffer_load_dwordx4 a[172:175], v244, s[16:19], s41 offen sc1
  v_accvgpr_read_b32 v171, a207
  v_accvgpr_read_b32 v172, a208
  v_accvgpr_read_b32 v173, a209
  v_accvgpr_read_b32 v174, a210
  v_accvgpr_read_b32 v175, a211
  v_accvgpr_read_b32 v176, a212
  v_accvgpr_read_b32 v177, a213
  v_accvgpr_read_b32 v178, a214
  v_accvgpr_read_b32 v179, a215
  v_accvgpr_read_b32 v180, a216
  v_accvgpr_read_b32 v181, a217
  v_accvgpr_read_b32 v182, a218
  v_accvgpr_read_b32 v183, a219
  v_accvgpr_read_b32 v240, a222
  v_accvgpr_read_b32 v241, a223
  v_accvgpr_read_b32 v242, a224
  v_accvgpr_read_b32 v251, a225
  v_accvgpr_read_b32 v252, a226
  v_accvgpr_read_b32 v253, a227
  s_and_b32 s64, s23, 3
  s_lshl_b32 s64, s64, 11
  s_and_b32 s28, s23, 4
  s_lshl_b32 s28, s28, 12
  s_add_u32 s64, s64, s28
  s_and_b32 s28, s23, 8
  s_lshl_b32 s28, s28, 10
  buffer_load_dwordx4 a[176:179], v245, s[16:19], s41 offen sc1
  s_xor_b32 s28, s28, s3
  s_add_u32 s64, s64, s28
  s_lshl_b32 s28, s21, 7
  s_add_u32 s64, s64, s28
  s_add_u32 s64, s64, 229376
  s_add_u32 s64, s64, s55
  s_mul_i32 s28, s21, 5
  v_add_u32 v3, s28, v2
  v_lshrrev_b32 v6, 3, v3
  v_lshlrev_b32 v6, 14, v6
  v_bfe_u32 v212, v3, 2, 1
  v_lshl_add_u32 v6, v212, 12, v6
  v_and_b32 v3, 3, v3
  v_lshl_add_u32 v6, v3, 8, v6
  v_lshl_add_u32 v235, v1, 4, v6
  s_add_u32 s28, s28, 4
  s_lshr_b32 s30, s28, 2
  s_lshr_b32 s29, s30, 1
  s_lshl_b32 s29, s29, 14
  s_and_b32 s30, s30, 1
  s_lshl_b32 s30, s30, 12
  s_add_u32 s30, s30, s29
  s_and_b32 s28, s28, 3
  s_lshl_b32 s28, s28, 8
  s_add_u32 s28, s28, s30
  v_lshl_add_u32 v3, v1, 4, s28
  s_add_u32 s41, s44, 65536
  buffer_load_dwordx4 a[180:183], v244, s[16:19], s41 offen sc1
  v_lshl_add_u32 v3, v2, 3, v3
  v_cmp_gt_u32 vcc, 2, v2
  v_mov_b32 v6, 1073741824
  v_lshl_add_u32 v237, v0, 3, s37
  v_cndmask_b32 v0, v6, v3, vcc
  s_lshl_b32 s42, s24, 2
  s_add_u32 s42, s42, s20
  s_lshr_b32 s30, s24, 1
  s_and_b32 s28, s30, 3
  s_lshl_b32 s28, s28, 11
  s_and_b32 s29, s30, 4
  s_lshl_b32 s29, s29, 12
  s_add_u32 s28, s28, s29
  s_and_b32 s29, s30, 8
  s_lshl_b32 s29, s29, 10
  s_xor_b32 s29, s29, s3
  s_add_u32 s28, s28, s29
  s_add_u32 s28, s28, 229376
  v_min_u32 v6, 15, v7
  v_lshl_add_u32 v254, v6, 7, s28
  s_mul_i32 s48, s42, 20480
  s_mul_i32 s28, s25, 160
  s_add_u32 s48, s48, s28
  s_and_b32 s28, s24, 15
  s_lshr_b32 s28, s28, 2
  s_add_u32 s28, s28, 9
  buffer_load_dwordx4 a[184:187], v245, s[16:19], s41 offen sc1
  s_lshr_b32 s29, s24, 4
  s_xor_b32 s29, s29, s28
  s_and_b32 s29, s29, 1
  s_lshl_b32 s29, s29, 13
  s_lshl_b32 s28, s28, 21
  s_add_u32 s28, s28, s29
  s_and_b32 s29, s24, 3
  s_mul_i32 s29, s29, 327680
  s_add_u32 s28, s28, s29
  s_add_u32 s42, s28, 163840
  s_xor_b32 s42, s42, s3
  s_lshl_b32 s28, s20, 10
  s_add_u32 s42, s42, s28
  s_mul_i32 s49, s20, 15360
  s_add_u32 s49, s49, 102400
  v_mul_u32_u24 v243, 176, v1
  v_lshl_add_u32 v243, v2, 3, v243
  v_add_u32 v243, s49, v243
  s_add_u32 s28, s20, 1
  s_and_b32 s28, s28, 3
  s_mul_i32 s28, s28, 15360
  s_add_u32 s28, s28, 102400
  v_add_u32 v248, s28, v4
  s_add_u32 s28, s20, 2
  s_and_b32 s28, s28, 3
  s_mul_i32 s28, s28, 15360
  s_add_u32 s28, s28, 107520
  s_waitcnt vmcnt(8)
  v_mfma_f32_16x16x32_bf16 v[88:91], a[0:3], a[140:143], 0
  v_add_u32 v249, s28, v4
  buffer_load_dword v255, v238, s[16:19], s55 offen sc1
  v_mfma_f32_16x16x32_bf16 v[88:91], a[20:23], a[148:151], v[88:91]
  s_add_u32 s28, s20, 3
  s_add_u32 s41, s44, 0
  v_mfma_f32_16x16x32_bf16 v[92:95], a[24:27], a[148:151], 0
  s_and_b32 s28, s28, 3
  v_mfma_f32_16x16x32_bf16 v[92:95], a[4:7], a[140:143], v[92:95]
  buffer_load_dwordx4 a[188:191], v246, s[16:19], s41 offen sc1
  v_mfma_f32_16x16x32_bf16 v[96:99], a[8:11], a[140:143], 0
  s_mul_i32 s28, s28, 15360
  v_mfma_f32_16x16x32_bf16 v[96:99], a[28:31], a[148:151], v[96:99]
  s_add_u32 s28, s28, 112640
  buffer_load_dwordx4 a[192:195], v247, s[16:19], s41 offen sc1
  v_mfma_f32_16x16x32_bf16 v[100:103], a[32:35], a[148:151], 0
  s_add_u32 s41, s44, 65536
  v_mfma_f32_16x16x32_bf16 v[100:103], a[12:15], a[140:143], v[100:103]
  v_add_u32 v250, s28, v4
  v_mfma_f32_16x16x32_bf16 v[104:107], a[16:19], a[140:143], 0
  v_add_u32 v1, s49, v4
  buffer_load_dwordx4 a[196:199], v246, s[16:19], s41 offen sc1
  v_mfma_f32_16x16x32_bf16 v[104:107], a[36:39], a[148:151], v[104:107]
  v_mfma_f32_16x16x32_bf16 v[124:127], a[36:39], a[152:155], 0
  v_mov_b32 v2, v235
  buffer_load_dwordx4 a[200:203], v247, s[16:19], s41 offen sc1
  v_mfma_f32_16x16x32_bf16 v[124:127], a[16:19], a[144:147], v[124:127]
  s_and_b32 s28, s24, 15
  v_mfma_f32_16x16x32_bf16 v[120:123], a[12:15], a[144:147], 0
  s_lshl_b32 s28, s28, 3
  s_add_u32 m0, s69, 81920
  v_mfma_f32_16x16x32_bf16 v[120:123], a[32:35], a[152:155], v[120:123]
  s_add_u32 s71, s70, 262144
  v_mfma_f32_16x16x32_bf16 v[116:119], a[28:31], a[152:155], 0
  s_add_u32 s28, s28, s25
  v_mfma_f32_16x16x32_bf16 v[116:119], a[8:11], a[144:147], v[116:119]
  s_lshl_b32 s28, s28, 2
  buffer_load_dwordx4 v4, s[16:19], s71 offen offset:1024 sc1 lds
  v_mfma_f32_16x16x32_bf16 v[112:115], a[4:7], a[144:147], 0
  v_mfma_f32_16x16x32_bf16 v[112:115], a[24:27], a[152:155], v[112:115]
  s_add_u32 s28, s28, s20
  buffer_load_dwordx4 v4, s[16:19], s71 offen offset:2048 sc1 lds
  v_mfma_f32_16x16x32_bf16 v[108:111], a[20:23], a[152:155], 0
  s_lshr_b32 s29, s28, 1
  v_mfma_f32_16x16x32_bf16 v[108:111], a[0:3], a[144:147], v[108:111]
  s_waitcnt vmcnt(11)
  v_mfma_f32_16x16x32_bf16 v[128:131], a[0:3], a[156:159], 0
  s_lshl_b32 s29, s29, 14
  s_add_u32 m0, s49, 4096
  v_mfma_f32_16x16x32_bf16 v[128:131], a[20:23], a[164:167], v[128:131]
  s_and_b32 s65, s28, 1
  s_nop 0
  v_mfma_f32_16x16x32_bf16 v[132:135], a[24:27], a[164:167], 0
  s_lshl_b32 s65, s65, 12
  buffer_load_dwordx4 v251, s[8:11], s48 offen lds
  v_mfma_f32_16x16x32_bf16 v[132:135], a[4:7], a[156:159], v[132:135]
  s_add_u32 m0, s49, 5120
  v_mfma_f32_16x16x32_bf16 v[136:139], a[8:11], a[156:159], 0
  s_add_u32 s65, s65, s29
  v_mfma_f32_16x16x32_bf16 v[136:139], a[28:31], a[164:167], v[136:139]
  s_add_u32 s65, s65, 27262976
  s_nop 0
  v_mfma_f32_16x16x32_bf16 v[140:143], a[32:35], a[164:167], 0
  s_lshr_b32 s28, s65, 21
  buffer_load_dwordx4 v252, s[8:11], s48 offen lds
  v_mfma_f32_16x16x32_bf16 v[140:143], a[12:15], a[156:159], v[140:143]
  s_add_u32 m0, s49, 6144
  v_mfma_f32_16x16x32_bf16 v[144:147], a[16:19], a[156:159], 0
  s_lshr_b32 s29, s24, 4
  s_nop 0
  v_mfma_f32_16x16x32_bf16 v[144:147], a[36:39], a[164:167], v[144:147]
  s_xor_b32 s28, s28, s29
  v_mfma_f32_16x16x32_bf16 v[164:167], a[36:39], a[168:171], 0
  s_and_b32 s28, s28, 1
  buffer_load_dwordx4 v253, s[8:11], s48 offen lds
  v_mfma_f32_16x16x32_bf16 v[164:167], a[16:19], a[160:163], v[164:167]
  s_add_u32 m0, s69, 81920
  v_mfma_f32_16x16x32_bf16 v[160:163], a[12:15], a[160:163], 0
  s_lshl_b32 s28, s28, 13
  s_add_u32 s71, s70, 262144
  v_mfma_f32_16x16x32_bf16 v[160:163], a[32:35], a[168:171], v[160:163]
  s_xor_b32 s28, s28, s3
  buffer_load_dwordx4 v4, s[16:19], s71 offen offset:3072 sc1 lds
  v_mfma_f32_16x16x32_bf16 v[156:159], a[28:31], a[168:171], 0
  s_add_u32 s65, s65, s28
  v_mfma_f32_16x16x32_bf16 v[156:159], a[8:11], a[160:163], v[156:159]
  s_add_u32 m0, s69, 86016
  v_mfma_f32_16x16x32_bf16 v[152:155], a[4:7], a[160:163], 0
  s_xor_b32 s66, s65, 262144
  s_add_u32 s71, s70, 262144
  v_mfma_f32_16x16x32_bf16 v[152:155], a[24:27], a[168:171], v[152:155]
  s_add_u32 s72, s66, 3072
  buffer_load_dwordx4 v5, s[16:19], s71 offen offset:0 sc1 lds
  v_mfma_f32_16x16x32_bf16 v[148:151], a[20:23], a[168:171], 0
  s_add_u32 s73, s65, 3072
  v_mfma_f32_16x16x32_bf16 v[148:151], a[0:3], a[160:163], v[148:151]
  s_waitcnt vmcnt(11)
  v_cmp_ne_u32 vcc, s39, v255
  s_nop 1
  s_and_b64 vcc, vcc, s[56:57]
  s_cbranch_scc1 k_sw_slow
k_sw_ok:
  s_barrier
  v_mfma_f32_16x16x32_bf16 v[8:11], a[0:3], a[172:175], 0
  buffer_load_dwordx4 v[208:211], v236, s[16:19], s60 offen sc1
  v_mfma_f32_16x16x32_bf16 v[8:11], a[20:23], a[180:183], v[8:11]
  buffer_load_dwordx4 a[240:243], v4, s[16:19], s61 offen sc1
  v_mfma_f32_16x16x32_bf16 v[12:15], a[24:27], a[180:183], 0
  v_mfma_f32_16x16x32_bf16 v[12:15], a[4:7], a[172:175], v[12:15]
  buffer_load_dwordx4 a[244:247], v4, s[16:19], s62 offen sc1
  v_mfma_f32_16x16x32_bf16 v[16:19], a[8:11], a[172:175], 0
  v_mfma_f32_16x16x32_bf16 v[16:19], a[28:31], a[180:183], v[16:19]
  buffer_load_dwordx4 a[248:251], v4, s[16:19], s61 offen offset:1024 sc1
  v_mfma_f32_16x16x32_bf16 v[20:23], a[32:35], a[180:183], 0
  buffer_load_dwordx4 a[252:255], v4, s[16:19], s62 offen offset:1024 sc1
  v_mfma_f32_16x16x32_bf16 v[20:23], a[12:15], a[172:175], v[20:23]
  v_mfma_f32_16x16x32_bf16 v[24:27], a[16:19], a[172:175], 0
  s_add_u32 s41, s45, 131072
  v_mfma_f32_16x16x32_bf16 v[24:27], a[36:39], a[180:183], v[24:27]
  v_mfma_f32_16x16x32_bf16 v[44:47], a[36:39], a[184:187], 0
  buffer_load_dwordx4 a[140:143], v244, s[16:19], s41 offen sc1
  v_mfma_f32_16x16x32_bf16 v[44:47], a[16:19], a[176:179], v[44:47]
  v_mfma_f32_16x16x32_bf16 v[40:43], a[12:15], a[176:179], 0
  buffer_load_dwordx4 a[144:147], v245, s[16:19], s41 offen sc1
  v_mfma_f32_16x16x32_bf16 v[40:43], a[32:35], a[184:187], v[40:43]
  s_add_u32 s41, s45, 196608
  v_mfma_f32_16x16x32_bf16 v[36:39], a[28:31], a[184:187], 0
  v_mfma_f32_16x16x32_bf16 v[36:39], a[8:11], a[176:179], v[36:39]
  buffer_load_dwordx4 a[148:151], v244, s[16:19], s41 offen sc1
  v_mfma_f32_16x16x32_bf16 v[32:35], a[4:7], a[176:179], 0
  v_mfma_f32_16x16x32_bf16 v[32:35], a[24:27], a[184:187], v[32:35]
  buffer_load_dwordx4 a[152:155], v245, s[16:19], s41 offen sc1
  v_mfma_f32_16x16x32_bf16 v[28:31], a[20:23], a[184:187], 0
  v_mfma_f32_16x16x32_bf16 v[28:31], a[0:3], a[176:179], v[28:31]
  s_waitcnt vmcnt(16)
  v_mfma_f32_16x16x32_bf16 v[48:51], a[0:3], a[188:191], 0
  s_add_u32 s41, s45, 131072
  v_mfma_f32_16x16x32_bf16 v[48:51], a[20:23], a[196:199], v[48:51]
  buffer_load_dwordx4 a[156:159], v246, s[16:19], s41 offen sc1
  v_mfma_f32_16x16x32_bf16 v[52:55], a[24:27], a[196:199], 0
  v_mfma_f32_16x16x32_bf16 v[52:55], a[4:7], a[188:191], v[52:55]
  buffer_load_dwordx4 a[160:163], v247, s[16:19], s41 offen sc1
  v_mfma_f32_16x16x32_bf16 v[56:59], a[8:11], a[188:191], 0
  v_mfma_f32_16x16x32_bf16 v[56:59], a[28:31], a[196:199], v[56:59]
  s_add_u32 s41, s45, 196608
  v_mfma_f32_16x16x32_bf16 v[60:63], a[32:35], a[196:199], 0
  buffer_load_dwordx4 a[164:167], v246, s[16:19], s41 offen sc1
  v_mfma_f32_16x16x32_bf16 v[60:63], a[12:15], a[188:191], v[60:63]
  v_mfma_f32_16x16x32_bf16 v[64:67], a[16:19], a[188:191], 0
  buffer_load_dwordx4 a[168:171], v247, s[16:19], s41 offen sc1
  v_mfma_f32_16x16x32_bf16 v[64:67], a[36:39], a[196:199], v[64:67]
  s_waitcnt vmcnt(12)
  v_cvt_pk_bf16_f32 v208, v208, v209
  v_mfma_f32_16x16x32_bf16 v[84:87], a[36:39], a[200:203], 0
  s_add_u32 s41, s45, 262144
  v_cvt_pk_bf16_f32 v209, v210, v211
  ds_write_b64 v237, v[208:209]
  v_mfma_f32_16x16x32_bf16 v[84:87], a[16:19], a[192:195], v[84:87]
  v_mfma_f32_16x16x32_bf16 v[80:83], a[12:15], a[192:195], 0
  buffer_load_dwordx4 a[172:175], v244, s[16:19], s41 offen sc1
  v_mfma_f32_16x16x32_bf16 v[80:83], a[32:35], a[200:203], v[80:83]
  buffer_load_dwordx4 a[176:179], v245, s[16:19], s41 offen sc1
  s_waitcnt lgkmcnt(0)
  s_barrier
  v_mfma_f32_16x16x32_bf16 v[76:79], a[28:31], a[200:203], 0
  ds_read_b64 a[204:205], v168
  ds_read_b64 a[206:207], v169
  ds_read_b64 a[208:209], v170
  v_mfma_f32_16x16x32_bf16 v[76:79], a[8:11], a[192:195], v[76:79]
  buffer_load_dwordx4 a[180:183], v246, s[16:19], s41 offen sc1
  ds_read_b64 a[210:211], v171
  ds_read_b64 a[212:213], v172
  ds_read_b64 a[214:215], v173
  v_mfma_f32_16x16x32_bf16 v[72:75], a[4:7], a[192:195], 0
  ds_read_b64 a[216:217], v174
  ds_read_b64 a[218:219], v175
  v_mfma_f32_16x16x32_bf16 v[72:75], a[24:27], a[200:203], v[72:75]
  buffer_load_dwordx4 a[184:187], v247, s[16:19], s41 offen sc1
  ds_read_b64 a[220:221], v176
  ds_read_b64 a[222:223], v177
  ds_read_b64 a[224:225], v178
  v_mfma_f32_16x16x32_bf16 v[68:71], a[20:23], a[200:203], 0
  ds_read_b64 a[226:227], v179
  ds_read_b64 a[228:229], v180
  ds_read_b64 a[230:231], v181
  v_mfma_f32_16x16x32_bf16 v[68:71], a[0:3], a[192:195], v[68:71]
  ds_read_b64 a[232:233], v182
  ds_read_b64 a[234:235], v183
  s_waitcnt vmcnt(12) lgkmcnt(0)
  v_mfma_f32_16x16x32_bf16 v[220:223], a[228:231], a[240:243], 0
  v_mfma_f32_16x16x32_bf16 v[220:223], a[232:235], a[244:247], v[220:223]
  v_mfma_f32_16x16x32_bf16 v[208:211], a[204:207], a[240:243], 0
  v_mfma_f32_16x16x32_bf16 v[208:211], a[208:211], a[244:247], v[208:211]
  v_mfma_f32_16x16x32_bf16 v[212:215], a[212:215], a[240:243], 0
  v_mfma_f32_16x16x32_bf16 v[212:215], a[216:219], a[244:247], v[212:215]
  v_mfma_f32_16x16x32_bf16 v[216:219], a[220:223], a[240:243], 0
  v_mfma_f32_16x16x32_bf16 v[216:219], a[224:227], a[244:247], v[216:219]
  v_mfma_f32_16x16x32_bf16 v[236:239], a[228:231], a[248:251], 0
  v_mfma_f32_16x16x32_bf16 v[236:239], a[232:235], a[252:255], v[236:239]
  v_mfma_f32_16x16x32_bf16 v[224:227], a[204:207], a[248:251], 0
  v_mfma_f32_16x16x32_bf16 v[224:227], a[208:211], a[252:255], v[224:227]
  v_mfma_f32_16x16x32_bf16 v[228:231], a[212:215], a[248:251], 0
  v_mfma_f32_16x16x32_bf16 v[228:231], a[216:219], a[252:255], v[228:231]
  v_mfma_f32_16x16x32_bf16 v[232:235], a[220:223], a[248:251], 0
  v_mfma_f32_16x16x32_bf16 v[232:235], a[224:227], a[252:255], v[232:235]
  s_waitcnt vmcnt(8)
  v_mfma_f32_16x16x32_bf16 v[88:91], a[40:43], a[140:143], v[88:91]
  s_add_u32 s41, s45, 327680
  v_mfma_f32_16x16x32_bf16 v[88:91], a[60:63], a[148:151], v[88:91]
  v_add_f32 v220, 0x358637bd, v220
  v_add_f32 v221, 0x358637bd, v221
  v_add_f32 v222, 0x358637bd, v222
  v_mfma_f32_16x16x32_bf16 v[92:95], a[64:67], a[148:151], v[92:95]
  buffer_load_dwordx4 a[188:191], v245, s[16:19], s41 offen sc1
  v_rcp_f32 v220, v220
  v_rcp_f32 v221, v221
  v_rcp_f32 v222, v222
  v_mfma_f32_16x16x32_bf16 v[92:95], a[44:47], a[140:143], v[92:95]
  v_mul_f32 v208, v208, v220
  v_mul_f32 v209, v209, v220
  v_mul_f32 v210, v210, v220
  v_mfma_f32_16x16x32_bf16 v[96:99], a[48:51], a[140:143], v[96:99]
  v_mul_f32 v211, v211, v220
  v_mul_f32 v212, v212, v221
  v_mfma_f32_16x16x32_bf16 v[96:99], a[68:71], a[148:151], v[96:99]
  buffer_load_dwordx4 a[192:195], v246, s[16:19], s41 offen sc1
  v_mul_f32 v213, v213, v221
  v_mul_f32 v214, v214, v221
  v_mul_f32 v215, v215, v221
  v_mfma_f32_16x16x32_bf16 v[100:103], a[72:75], a[148:151], v[100:103]
  v_mul_f32 v216, v216, v222
  v_mul_f32 v217, v217, v222
  v_mul_f32 v218, v218, v222
  v_mfma_f32_16x16x32_bf16 v[100:103], a[52:55], a[140:143], v[100:103]
  v_mul_f32 v219, v219, v222
  v_cvt_pk_bf16_f32 v168, v208, v209
  v_cvt_pk_bf16_f32 v169, v210, v211
  v_mfma_f32_16x16x32_bf16 v[104:107], a[56:59], a[140:143], v[104:107]
  s_add_u32 s41, s45, 393216
  v_cvt_pk_bf16_f32 v170, v212, v213
  v_cvt_pk_bf16_f32 v171, v214, v215
  v_mfma_f32_16x16x32_bf16 v[104:107], a[76:79], a[148:151], v[104:107]
  v_cvt_pk_bf16_f32 v172, v216, v217
  v_cvt_pk_bf16_f32 v173, v218, v219
  buffer_store_dwordx4 v[168:171], v2, s[16:19], s63 offen offset:0 sc1
  v_mfma_f32_16x16x32_bf16 v[124:127], a[76:79], a[152:155], v[124:127]
  s_cmp_lt_u32 s20, 3
  s_cselect_b32 s41, s41, 1073741824
  buffer_store_dwordx2 v[172:173], v0, s[16:19], s63 offen offset:0 sc1
  v_add_f32 v236, 0x358637bd, v236
  v_add_f32 v237, 0x358637bd, v237
  v_mfma_f32_16x16x32_bf16 v[124:127], a[56:59], a[144:147], v[124:127]
  v_add_f32 v238, 0x358637bd, v238
  v_rcp_f32 v236, v236
  v_rcp_f32 v237, v237
  v_mfma_f32_16x16x32_bf16 v[120:123], a[52:55], a[144:147], v[120:123]
  v_rcp_f32 v238, v238
  v_mul_f32 v224, v224, v236
  v_mfma_f32_16x16x32_bf16 v[120:123], a[72:75], a[152:155], v[120:123]
  buffer_load_dwordx4 a[196:199], v245, s[16:19], s41 offen sc1
  v_mul_f32 v225, v225, v236
  v_mul_f32 v226, v226, v236
  v_mul_f32 v227, v227, v236
  v_mfma_f32_16x16x32_bf16 v[116:119], a[68:71], a[152:155], v[116:119]
  v_mul_f32 v228, v228, v237
  v_mul_f32 v229, v229, v237
  v_mul_f32 v230, v230, v237
  v_mfma_f32_16x16x32_bf16 v[116:119], a[48:51], a[144:147], v[116:119]
  v_mul_f32 v231, v231, v237
  v_mul_f32 v232, v232, v238
  v_mul_f32 v233, v233, v238
  v_mfma_f32_16x16x32_bf16 v[112:115], a[44:47], a[144:147], v[112:115]
  buffer_load_dwordx4 a[200:203], v246, s[16:19], s41 offen sc1
  v_mul_f32 v234, v234, v238
  v_mul_f32 v235, v235, v238
  v_mfma_f32_16x16x32_bf16 v[112:115], a[64:67], a[152:155], v[112:115]
  v_cvt_pk_bf16_f32 v174, v224, v225
  v_cvt_pk_bf16_f32 v175, v226, v227
  v_cvt_pk_bf16_f32 v176, v228, v229
  v_mfma_f32_16x16x32_bf16 v[108:111], a[60:63], a[152:155], v[108:111]
  v_cvt_pk_bf16_f32 v177, v230, v231
  v_cvt_pk_bf16_f32 v178, v232, v233
  v_cvt_pk_bf16_f32 v179, v234, v235
  v_mfma_f32_16x16x32_bf16 v[108:111], a[40:43], a[144:147], v[108:111]
  buffer_store_dwordx4 v[174:177], v2, s[16:19], s63 offen offset:1024 sc1
  buffer_store_dwordx2 v[178:179], v0, s[16:19], s63 offen offset:1024 sc1
  s_waitcnt vmcnt(12)
  v_mfma_f32_16x16x32_bf16 v[128:131], a[40:43], a[156:159], v[128:131]
  s_add_u32 s41, s45, 327680
  v_mfma_f32_16x16x32_bf16 v[128:131], a[60:63], a[164:167], v[128:131]
  v_mfma_f32_16x16x32_bf16 v[132:135], a[64:67], a[164:167], v[132:135]
  buffer_load_dwordx4 a[140:143], v247, s[16:19], s41 offen sc1
  v_mfma_f32_16x16x32_bf16 v[132:135], a[44:47], a[156:159], v[132:135]
  v_mfma_f32_16x16x32_bf16 v[136:139], a[48:51], a[156:159], v[136:139]
  v_mfma_f32_16x16x32_bf16 v[136:139], a[68:71], a[164:167], v[136:139]
  buffer_load_dwordx4 a[144:147], v244, s[16:19], s41 offen sc1
  v_mfma_f32_16x16x32_bf16 v[140:143], a[72:75], a[164:167], v[140:143]
  v_mfma_f32_16x16x32_bf16 v[140:143], a[52:55], a[156:159], v[140:143]
  v_mfma_f32_16x16x32_bf16 v[144:147], a[56:59], a[156:159], v[144:147]
  s_add_u32 s41, s45, 393216
  v_mfma_f32_16x16x32_bf16 v[144:147], a[76:79], a[164:167], v[144:147]
  v_mfma_f32_16x16x32_bf16 v[164:167], a[76:79], a[168:171], v[164:167]
  s_cmp_lt_u32 s20, 3
  s_cselect_b32 s41, s41, 1073741824
  v_mfma_f32_16x16x32_bf16 v[164:167], a[56:59], a[160:163], v[164:167]
  v_mfma_f32_16x16x32_bf16 v[160:163], a[52:55], a[160:163], v[160:163]
  v_mfma_f32_16x16x32_bf16 v[160:163], a[72:75], a[168:171], v[160:163]
  buffer_load_dwordx4 a[148:151], v247, s[16:19], s41 offen sc1
  v_mfma_f32_16x16x32_bf16 v[156:159], a[68:71], a[168:171], v[156:159]
  v_mfma_f32_16x16x32_bf16 v[156:159], a[48:51], a[160:163], v[156:159]
  v_mfma_f32_16x16x32_bf16 v[152:155], a[44:47], a[160:163], v[152:155]
  buffer_load_dwordx4 a[152:155], v244, s[16:19], s41 offen sc1
  v_mfma_f32_16x16x32_bf16 v[152:155], a[64:67], a[168:171], v[152:155]
  v_mfma_f32_16x16x32_bf16 v[148:151], a[60:63], a[168:171], v[148:151]
  v_mfma_f32_16x16x32_bf16 v[148:151], a[40:43], a[160:163], v[148:151]
  s_waitcnt vmcnt(12)
  v_mfma_f32_16x16x32_bf16 v[88:91], a[80:83], a[172:175], v[88:91]
  v_add_u32 v2, 51200, v4
  v_and_b32 v3, 15, v7
  s_add_u32 s41, s44, 131072
  v_mfma_f32_16x16x32_bf16 v[92:95], a[84:87], a[172:175], v[92:95]
  v_lshlrev_b32 v3, 4, v3
  v_mfma_f32_16x16x32_bf16 v[96:99], a[88:91], a[172:175], v[96:99]
  v_sub_u32 v3, v243, v3
  v_mfma_f32_16x16x32_bf16 v[100:103], a[92:95], a[172:175], v[100:103]
  s_waitcnt vmcnt(31)
  buffer_load_dwordx4 a[156:159], v244, s[16:19], s41 offen sc1
  v_mfma_f32_16x16x32_bf16 v[104:107], a[96:99], a[172:175], v[104:107]
  ds_read_b64 v[228:229], v3 offset:4096
  v_mfma_f32_16x16x32_bf16 v[124:127], a[96:99], a[176:179], v[124:127]
  ds_read_b64 v[230:231], v3 offset:4128
  v_mfma_f32_16x16x32_bf16 v[120:123], a[92:95], a[176:179], v[120:123]
  ds_read_b64 v[232:233], v3 offset:4160
  buffer_load_dwordx4 a[160:163], v245, s[16:19], s41 offen sc1
  v_mfma_f32_16x16x32_bf16 v[116:119], a[88:91], a[176:179], v[116:119]
  ds_read_b64 v[234:235], v3 offset:4192
  v_mfma_f32_16x16x32_bf16 v[112:115], a[84:87], a[176:179], v[112:115]
  ds_read_b64 v[236:237], v3 offset:4224
  v_mfma_f32_16x16x32_bf16 v[108:111], a[80:83], a[176:179], v[108:111]
  s_add_u32 s41, s44, 196608
  v_mfma_f32_16x16x32_bf16 v[128:131], a[80:83], a[180:183], v[128:131]
  v_mfma_f32_16x16x32_bf16 v[132:135], a[84:87], a[180:183], v[132:135]
  v_mfma_f32_16x16x32_bf16 v[136:139], a[88:91], a[180:183], v[136:139]
  buffer_load_dwordx4 a[164:167], v244, s[16:19], s41 offen sc1
  v_mfma_f32_16x16x32_bf16 v[140:143], a[92:95], a[180:183], v[140:143]
  v_mfma_f32_16x16x32_bf16 v[144:147], a[96:99], a[180:183], v[144:147]
  v_mfma_f32_16x16x32_bf16 v[164:167], a[96:99], a[184:187], v[164:167]
  buffer_load_dwordx4 a[168:171], v245, s[16:19], s41 offen sc1
  v_mfma_f32_16x16x32_bf16 v[160:163], a[92:95], a[184:187], v[160:163]
  v_mfma_f32_16x16x32_bf16 v[156:159], a[88:91], a[184:187], v[156:159]
  v_mfma_f32_16x16x32_bf16 v[152:155], a[84:87], a[184:187], v[152:155]
  v_mfma_f32_16x16x32_bf16 v[148:151], a[80:83], a[184:187], v[148:151]
  s_waitcnt vmcnt(8) lgkmcnt(0)
  s_barrier
  v_mfma_f32_16x16x32_bf16 v[108:111], a[100:103], a[188:191], v[108:111]
  v_mov_b32 v3, s39
  v_mfma_f32_16x16x32_bf16 v[108:111], a[120:123], a[196:199], v[108:111]
  v_mfma_f32_16x16x32_bf16 v[112:115], a[124:127], a[196:199], v[112:115]
  v_lshlrev_b32 v6, 25, v7
  v_mfma_f32_16x16x32_bf16 v[112:115], a[104:107], a[188:191], v[112:115]
  v_mfma_f32_16x16x32_bf16 v[116:119], a[108:111], a[188:191], v[116:119]
  buffer_store_dword v3, v6, s[16:19], s64 offen sc1
  v_mfma_f32_16x16x32_bf16 v[116:119], a[128:131], a[196:199], v[116:119]
  v_mfma_f32_16x16x32_bf16 v[120:123], a[132:135], a[196:199], v[120:123]
  s_add_u32 s41, s44, 131072
  v_mfma_f32_16x16x32_bf16 v[120:123], a[112:115], a[188:191], v[120:123]
  v_mfma_f32_16x16x32_bf16 v[124:127], a[116:119], a[188:191], v[124:127]
  buffer_load_dwordx4 a[172:175], v246, s[16:19], s41 offen sc1
  v_mfma_f32_16x16x32_bf16 v[124:127], a[136:139], a[196:199], v[124:127]
  v_mfma_f32_16x16x32_bf16 v[144:147], a[136:139], a[200:203], v[144:147]
  buffer_load_dwordx4 a[176:179], v247, s[16:19], s41 offen sc1
  v_mfma_f32_16x16x32_bf16 v[144:147], a[116:119], a[192:195], v[144:147]
  v_mfma_f32_16x16x32_bf16 v[140:143], a[112:115], a[192:195], v[140:143]
  s_add_u32 s41, s44, 196608
  ds_write_b128 v248, v[108:111] offset:0
  v_mfma_f32_16x16x32_bf16 v[140:143], a[132:135], a[200:203], v[140:143]
  v_mfma_f32_16x16x32_bf16 v[136:139], a[128:131], a[200:203], v[136:139]
  buffer_load_dwordx4 a[180:183], v246, s[16:19], s41 offen sc1
  ds_write_b128 v248, v[112:115] offset:1024
  v_mfma_f32_16x16x32_bf16 v[136:139], a[108:111], a[192:195], v[136:139]
  v_mfma_f32_16x16x32_bf16 v[132:135], a[104:107], a[192:195], v[132:135]
  buffer_load_dwordx4 a[184:187], v247, s[16:19], s41 offen sc1
  v_mfma_f32_16x16x32_bf16 v[132:135], a[124:127], a[200:203], v[132:135]
  ds_write_b128 v248, v[116:119] offset:2048
  v_mfma_f32_16x16x32_bf16 v[128:131], a[120:123], a[200:203], v[128:131]
  v_mfma_f32_16x16x32_bf16 v[128:131], a[100:103], a[192:195], v[128:131]
  s_waitcnt vmcnt(9)
  v_mfma_f32_16x16x32_bf16 v[148:151], a[100:103], a[140:143], v[148:151]
  s_add_u32 s41, s44, 262144
  ds_write_b128 v248, v[120:123] offset:3072
  v_mfma_f32_16x16x32_bf16 v[148:151], a[120:123], a[148:151], v[148:151]
  buffer_load_dwordx4 a[192:195], v245, s[16:19], s41 offen sc1
  v_mfma_f32_16x16x32_bf16 v[152:155], a[124:127], a[148:151], v[152:155]
  ds_write_b128 v248, v[124:127] offset:4096
  v_mfma_f32_16x16x32_bf16 v[152:155], a[104:107], a[140:143], v[152:155]
  buffer_load_dwordx4 a[196:199], v246, s[16:19], s41 offen sc1
  v_mfma_f32_16x16x32_bf16 v[156:159], a[108:111], a[140:143], v[156:159]
  v_mfma_f32_16x16x32_bf16 v[156:159], a[128:131], a[148:151], v[156:159]
  buffer_load_dwordx4 a[200:203], v247, s[16:19], s41 offen sc1
  ds_write_b128 v249, v[128:131] offset:0
  v_mfma_f32_16x16x32_bf16 v[160:163], a[132:135], a[148:151], v[160:163]
  buffer_load_dwordx4 a[188:191], v244, s[16:19], s41 offen sc1
  v_mfma_f32_16x16x32_bf16 v[160:163], a[112:115], a[140:143], v[160:163]
  v_mfma_f32_16x16x32_bf16 v[164:167], a[116:119], a[140:143], v[164:167]
  s_add_u32 s41, s44, 393216
  ds_write_b128 v249, v[132:135] offset:1024
  v_mfma_f32_16x16x32_bf16 v[164:167], a[136:139], a[148:151], v[164:167]
  v_mfma_f32_16x16x32_bf16 v[104:107], a[136:139], a[152:155], v[104:107]
  s_cmp_lt_u32 s20, 3
  s_cselect_b32 s41, s41, 1073741824
  v_mfma_f32_16x16x32_bf16 v[104:107], a[116:119], a[144:147], v[104:107]
  ds_write_b128 v249, v[136:139] offset:2048
  v_mfma_f32_16x16x32_bf16 v[100:103], a[112:115], a[144:147], v[100:103]
  buffer_load_dwordx4 a[208:211], v245, s[16:19], s41 offen sc1
  v_mfma_f32_16x16x32_bf16 v[100:103], a[132:135], a[152:155], v[100:103]
  buffer_load_dwordx4 a[212:215], v246, s[16:19], s41 offen sc1
  v_mfma_f32_16x16x32_bf16 v[96:99], a[128:131], a[152:155], v[96:99]
  ds_write_b128 v249, v[140:143] offset:3072
  v_mfma_f32_16x16x32_bf16 v[96:99], a[108:111], a[144:147], v[96:99]
  buffer_load_dwordx4 a[216:219], v247, s[16:19], s41 offen sc1
  v_mfma_f32_16x16x32_bf16 v[92:95], a[104:107], a[144:147], v[92:95]
  v_mfma_f32_16x16x32_bf16 v[92:95], a[124:127], a[152:155], v[92:95]
  buffer_load_dwordx4 a[204:207], v244, s[16:19], s41 offen sc1
  ds_write_b128 v249, v[144:147] offset:4096
  v_mfma_f32_16x16x32_bf16 v[88:91], a[120:123], a[152:155], v[88:91]
  v_mfma_f32_16x16x32_bf16 v[88:91], a[100:103], a[144:147], v[88:91]
  s_waitcnt vmcnt(13)
  v_mfma_f32_16x16x32_bf16 v[8:11], a[40:43], a[156:159], v[8:11]
  s_add_u32 s41, s44, 327680
  ds_write_b128 v250, v[148:151] offset:0
  v_lshlrev_b32 v184, 16, v228
  v_mfma_f32_16x16x32_bf16 v[8:11], a[60:63], a[164:167], v[8:11]
  v_and_b32 v185, 0xffff0000, v228
  v_mfma_f32_16x16x32_bf16 v[12:15], a[64:67], a[164:167], v[12:15]
  v_lshlrev_b32 v186, 16, v229
  v_mfma_f32_16x16x32_bf16 v[12:15], a[44:47], a[156:159], v[12:15]
  buffer_load_dwordx4 a[144:147], v245, s[16:19], s41 offen sc1
  ds_write_b128 v250, v[152:155] offset:1024
  v_and_b32 v187, 0xffff0000, v229
  v_mfma_f32_16x16x32_bf16 v[16:19], a[48:51], a[156:159], v[16:19]
  v_lshlrev_b32 v188, 16, v230
  v_mfma_f32_16x16x32_bf16 v[16:19], a[68:71], a[164:167], v[16:19]
  v_and_b32 v189, 0xffff0000, v230
  v_mfma_f32_16x16x32_bf16 v[20:23], a[72:75], a[164:167], v[20:23]
  ds_write_b128 v250, v[156:159] offset:2048
  v_lshlrev_b32 v190, 16, v231
  v_mfma_f32_16x16x32_bf16 v[20:23], a[52:55], a[156:159], v[20:23]
  buffer_load_dwordx4 a[148:151], v246, s[16:19], s41 offen sc1
  v_and_b32 v191, 0xffff0000, v231
  v_mfma_f32_16x16x32_bf16 v[24:27], a[56:59], a[156:159], v[24:27]
  v_lshlrev_b32 v192, 16, v232
  v_mfma_f32_16x16x32_bf16 v[24:27], a[76:79], a[164:167], v[24:27]
  ds_write_b128 v250, v[160:163] offset:3072
  v_and_b32 v193, 0xffff0000, v232
  v_mfma_f32_16x16x32_bf16 v[44:47], a[76:79], a[168:171], v[44:47]
  v_lshlrev_b32 v194, 16, v233
  v_mfma_f32_16x16x32_bf16 v[44:47], a[56:59], a[160:163], v[44:47]
  buffer_load_dwordx4 a[152:155], v247, s[16:19], s41 offen sc1
  v_and_b32 v195, 0xffff0000, v233
  v_mfma_f32_16x16x32_bf16 v[40:43], a[52:55], a[160:163], v[40:43]
  ds_write_b128 v250, v[164:167] offset:4096
  v_lshlrev_b32 v196, 16, v234
  v_mfma_f32_16x16x32_bf16 v[40:43], a[72:75], a[168:171], v[40:43]
  v_and_b32 v197, 0xffff0000, v234
  v_mfma_f32_16x16x32_bf16 v[36:39], a[68:71], a[168:171], v[36:39]
  v_lshlrev_b32 v198, 16, v235
  v_mfma_f32_16x16x32_bf16 v[36:39], a[48:51], a[160:163], v[36:39]
  buffer_load_dwordx4 a[140:143], v244, s[16:19], s41 offen sc1
  v_and_b32 v199, 0xffff0000, v235
  v_mfma_f32_16x16x32_bf16 v[32:35], a[44:47], a[160:163], v[32:35]
  v_lshlrev_b32 v200, 16, v236
  v_mfma_f32_16x16x32_bf16 v[32:35], a[64:67], a[168:171], v[32:35]
  v_and_b32 v201, 0xffff0000, v236
  v_mfma_f32_16x16x32_bf16 v[28:31], a[60:63], a[168:171], v[28:31]
  v_lshlrev_b32 v202, 16, v237
  v_mfma_f32_16x16x32_bf16 v[28:31], a[40:43], a[160:163], v[28:31]
  v_and_b32 v203, 0xffff0000, v237
  s_waitcnt vmcnt(12) lgkmcnt(0)
  s_barrier
  v_mfma_f32_16x16x32_bf16 v[48:51], a[40:43], a[172:175], v[48:51]
  buffer_load_dword v255, v254, s[16:19], s55 offen sc1
  ds_read_b128 v[108:111], v1 offset:0
  v_mfma_f32_16x16x32_bf16 v[48:51], a[60:63], a[180:183], v[48:51]
  ds_read_b128 v[128:131], v1 offset:5120
  v_mfma_f32_16x16x32_bf16 v[52:55], a[64:67], a[180:183], v[52:55]
  ds_read_b128 v[148:151], v1 offset:10240
  v_mfma_f32_16x16x32_bf16 v[52:55], a[44:47], a[172:175], v[52:55]
  ds_read_b128 v[112:115], v1 offset:1024
  v_mfma_f32_16x16x32_bf16 v[56:59], a[48:51], a[172:175], v[56:59]
  ds_read_b128 v[132:135], v1 offset:6144
  v_mfma_f32_16x16x32_bf16 v[56:59], a[68:71], a[180:183], v[56:59]
  ds_read_b128 v[152:155], v1 offset:11264
  v_mfma_f32_16x16x32_bf16 v[60:63], a[72:75], a[180:183], v[60:63]
  ds_read_b128 v[116:119], v1 offset:2048
  v_mfma_f32_16x16x32_bf16 v[60:63], a[52:55], a[172:175], v[60:63]
  ds_read_b128 v[136:139], v1 offset:7168
  v_mfma_f32_16x16x32_bf16 v[64:67], a[56:59], a[172:175], v[64:67]
  ds_read_b128 v[156:159], v1 offset:12288
  v_mfma_f32_16x16x32_bf16 v[64:67], a[76:79], a[180:183], v[64:67]
  ds_read_b128 v[120:123], v1 offset:3072
  v_mfma_f32_16x16x32_bf16 v[84:87], a[76:79], a[184:187], v[84:87]
  ds_read_b128 v[140:143], v1 offset:8192
  v_mfma_f32_16x16x32_bf16 v[84:87], a[56:59], a[176:179], v[84:87]
  ds_read_b128 v[160:163], v1 offset:13312
  v_mfma_f32_16x16x32_bf16 v[80:83], a[52:55], a[176:179], v[80:83]
  ds_read_b128 v[124:127], v1 offset:4096
  v_mfma_f32_16x16x32_bf16 v[80:83], a[72:75], a[184:187], v[80:83]
  ds_read_b128 v[144:147], v1 offset:9216
  v_mfma_f32_16x16x32_bf16 v[76:79], a[68:71], a[184:187], v[76:79]
  ds_read_b128 v[164:167], v1 offset:14336
  v_mfma_f32_16x16x32_bf16 v[76:79], a[48:51], a[176:179], v[76:79]
  v_mfma_f32_16x16x32_bf16 v[72:75], a[44:47], a[176:179], v[72:75]
  v_mfma_f32_16x16x32_bf16 v[72:75], a[64:67], a[184:187], v[72:75]
  v_mfma_f32_16x16x32_bf16 v[68:71], a[60:63], a[184:187], v[68:71]
  v_mfma_f32_16x16x32_bf16 v[68:71], a[40:43], a[176:179], v[68:71]
  s_waitcnt vmcnt(4)
  s_waitcnt lgkmcnt(0)
  s_nop 0
  v_pk_add_f32 v[88:89], v[88:89], v[108:109]
  v_pk_add_f32 v[90:91], v[90:91], v[110:111]
  v_pk_add_f32 v[92:93], v[92:93], v[112:113]
  v_pk_add_f32 v[94:95], v[94:95], v[114:115]
  v_pk_add_f32 v[96:97], v[96:97], v[116:117]
  v_pk_add_f32 v[98:99], v[98:99], v[118:119]
  v_pk_add_f32 v[100:101], v[100:101], v[120:121]
  v_pk_add_f32 v[102:103], v[102:103], v[122:123]
  v_pk_add_f32 v[104:105], v[104:105], v[124:125]
  v_pk_add_f32 v[106:107], v[106:107], v[126:127]
  v_pk_add_f32 v[88:89], v[88:89], v[128:129]
  v_pk_add_f32 v[90:91], v[90:91], v[130:131]
  v_pk_add_f32 v[92:93], v[92:93], v[132:133]
  v_pk_add_f32 v[94:95], v[94:95], v[134:135]
  v_pk_add_f32 v[96:97], v[96:97], v[136:137]
  v_pk_add_f32 v[98:99], v[98:99], v[138:139]
  v_pk_add_f32 v[100:101], v[100:101], v[140:141]
  v_pk_add_f32 v[102:103], v[102:103], v[142:143]
  v_pk_add_f32 v[104:105], v[104:105], v[144:145]
  v_pk_add_f32 v[106:107], v[106:107], v[146:147]
  v_pk_add_f32 v[88:89], v[88:89], v[148:149]
  v_pk_add_f32 v[90:91], v[90:91], v[150:151]
  v_pk_add_f32 v[92:93], v[92:93], v[152:153]
  v_pk_add_f32 v[94:95], v[94:95], v[154:155]
  v_pk_add_f32 v[96:97], v[96:97], v[156:157]
  v_pk_add_f32 v[98:99], v[98:99], v[158:159]
  v_pk_add_f32 v[100:101], v[100:101], v[160:161]
  v_pk_add_f32 v[102:103], v[102:103], v[162:163]
  v_pk_add_f32 v[104:105], v[104:105], v[164:165]
  v_pk_add_f32 v[106:107], v[106:107], v[166:167]
  v_mfma_f32_16x16x32_bf16 v[28:31], a[80:83], a[192:195], v[28:31]
  v_cvt_pk_bf16_f32 v168, v88, v89
  v_mfma_f32_16x16x32_bf16 v[28:31], a[100:103], a[144:147], v[28:31]
  v_cvt_pk_bf16_f32 v169, v90, v91
  v_mfma_f32_16x16x32_bf16 v[28:31], a[120:123], a[208:211], v[28:31]
  v_cvt_pk_bf16_f32 v170, v92, v93
  v_mfma_f32_16x16x32_bf16 v[32:35], a[124:127], a[208:211], v[32:35]
  v_cvt_pk_bf16_f32 v171, v94, v95
  v_mfma_f32_16x16x32_bf16 v[32:35], a[104:107], a[144:147], v[32:35]
  buffer_store_dwordx4 v[168:171], v4, s[16:19], s66 offen offset:0 sc1
  v_mfma_f32_16x16x32_bf16 v[32:35], a[84:87], a[192:195], v[32:35]
  v_cvt_pk_bf16_f32 v172, v96, v97
  v_mfma_f32_16x16x32_bf16 v[36:39], a[88:91], a[192:195], v[36:39]
  v_cvt_pk_bf16_f32 v173, v98, v99
  v_mfma_f32_16x16x32_bf16 v[36:39], a[108:111], a[144:147], v[36:39]
  v_cvt_pk_bf16_f32 v174, v100, v101
  v_mfma_f32_16x16x32_bf16 v[36:39], a[128:131], a[208:211], v[36:39]
  v_cvt_pk_bf16_f32 v175, v102, v103
  v_mfma_f32_16x16x32_bf16 v[40:43], a[132:135], a[208:211], v[40:43]
  buffer_store_dwordx4 v[172:175], v4, s[16:19], s66 offen offset:1024 sc1
  v_mfma_f32_16x16x32_bf16 v[40:43], a[112:115], a[144:147], v[40:43]
  v_cvt_pk_bf16_f32 v176, v104, v105
  v_mfma_f32_16x16x32_bf16 v[40:43], a[92:95], a[192:195], v[40:43]
  v_cvt_pk_bf16_f32 v177, v106, v107
  v_mfma_f32_16x16x32_bf16 v[44:47], a[96:99], a[192:195], v[44:47]
  v_lshlrev_b32 v0, 3, v7
  v_mfma_f32_16x16x32_bf16 v[44:47], a[116:119], a[144:147], v[44:47]
  buffer_store_dwordx2 v[176:177], v0, s[16:19], s66 offen offset:2048 sc1
  v_mfma_f32_16x16x32_bf16 v[44:47], a[136:139], a[208:211], v[44:47]
  s_waitcnt vmcnt(3)
  v_cmp_ne_u32 vcc, s39, v255
  s_nop 1
  s_and_b64 vcc, vcc, s[56:57]
  s_cbranch_scc1 k_so_slow
k_so_ok:
  s_barrier
  v_mfma_f32_16x16x32_bf16 v[48:51], a[80:83], a[196:199], v[48:51]
  s_add_u32 s43, s42, 0
  v_mfma_f32_16x16x32_bf16 v[48:51], a[100:103], a[148:151], v[48:51]
  v_mfma_f32_16x16x32_bf16 v[48:51], a[120:123], a[212:215], v[48:51]
  buffer_load_dwordx4 a[0:3], v4, s[16:19], s43 offen sc1
  ds_write_b128 v248, v[28:31] offset:0
  v_mfma_f32_16x16x32_bf16 v[52:55], a[124:127], a[212:215], v[52:55]
  v_mfma_f32_16x16x32_bf16 v[52:55], a[104:107], a[148:151], v[52:55]
  buffer_load_dwordx4 a[4:7], v5, s[16:19], s43 offen sc1
  ds_write_b128 v248, v[32:35] offset:1024
  v_mfma_f32_16x16x32_bf16 v[52:55], a[84:87], a[196:199], v[52:55]
  v_mfma_f32_16x16x32_bf16 v[56:59], a[88:91], a[196:199], v[56:59]
  v_mfma_f32_16x16x32_bf16 v[56:59], a[108:111], a[148:151], v[56:59]
  s_add_u32 s43, s42, 16384
  ds_write_b128 v248, v[36:39] offset:2048
  v_mfma_f32_16x16x32_bf16 v[56:59], a[128:131], a[212:215], v[56:59]
  v_mfma_f32_16x16x32_bf16 v[60:63], a[132:135], a[212:215], v[60:63]
  buffer_load_dwordx4 a[8:11], v4, s[16:19], s43 offen sc1
  ds_write_b128 v248, v[40:43] offset:3072
  v_mfma_f32_16x16x32_bf16 v[60:63], a[112:115], a[148:151], v[60:63]
  v_mfma_f32_16x16x32_bf16 v[60:63], a[92:95], a[196:199], v[60:63]
  buffer_load_dwordx4 a[12:15], v5, s[16:19], s43 offen sc1
  v_mfma_f32_16x16x32_bf16 v[64:67], a[96:99], a[196:199], v[64:67]
  ds_write_b128 v248, v[44:47] offset:4096
  v_mfma_f32_16x16x32_bf16 v[64:67], a[116:119], a[148:151], v[64:67]
  v_mfma_f32_16x16x32_bf16 v[64:67], a[136:139], a[212:215], v[64:67]
  s_waitcnt vmcnt(9)
  v_mfma_f32_16x16x32_bf16 v[68:71], a[80:83], a[200:203], v[68:71]
  s_add_u32 s43, s42, 32768
  ds_read_b128 v[88:91], v4 offset:0
  v_mfma_f32_16x16x32_bf16 v[68:71], a[100:103], a[152:155], v[68:71]
  v_mfma_f32_16x16x32_bf16 v[68:71], a[120:123], a[216:219], v[68:71]
  buffer_load_dwordx4 a[16:19], v4, s[16:19], s43 offen sc1
  ds_write_b128 v249, v[48:51] offset:0
  v_mfma_f32_16x16x32_bf16 v[72:75], a[124:127], a[216:219], v[72:75]
  ds_read_b128 v[108:111], v4 offset:5120
  v_mfma_f32_16x16x32_bf16 v[72:75], a[104:107], a[152:155], v[72:75]
  buffer_load_dwordx4 a[20:23], v5, s[16:19], s43 offen sc1
  ds_write_b128 v249, v[52:55] offset:1024
  v_mfma_f32_16x16x32_bf16 v[72:75], a[84:87], a[200:203], v[72:75]
  v_mfma_f32_16x16x32_bf16 v[76:79], a[88:91], a[200:203], v[76:79]
  v_mfma_f32_16x16x32_bf16 v[76:79], a[108:111], a[152:155], v[76:79]
  s_add_u32 s43, s42, 49152
  ds_write_b128 v249, v[56:59] offset:2048
  ds_read_b128 v[92:95], v4 offset:1024
  v_mfma_f32_16x16x32_bf16 v[76:79], a[128:131], a[216:219], v[76:79]
  v_mfma_f32_16x16x32_bf16 v[80:83], a[132:135], a[216:219], v[80:83]
  buffer_load_dwordx4 a[24:27], v4, s[16:19], s43 offen sc1
  ds_write_b128 v249, v[60:63] offset:3072
  v_mfma_f32_16x16x32_bf16 v[80:83], a[112:115], a[152:155], v[80:83]
  ds_read_b128 v[112:115], v4 offset:6144
  v_mfma_f32_16x16x32_bf16 v[80:83], a[92:95], a[200:203], v[80:83]
  buffer_load_dwordx4 a[28:31], v5, s[16:19], s43 offen sc1
  v_mfma_f32_16x16x32_bf16 v[84:87], a[96:99], a[200:203], v[84:87]
  ds_write_b128 v249, v[64:67] offset:4096
  v_mfma_f32_16x16x32_bf16 v[84:87], a[116:119], a[152:155], v[84:87]
  v_mfma_f32_16x16x32_bf16 v[84:87], a[136:139], a[216:219], v[84:87]
  s_waitcnt vmcnt(8)
  v_mfma_f32_16x16x32_bf16 v[8:11], a[80:83], a[188:191], v[8:11]
  v_mov_b32 v3, s39
  ds_read_b128 v[96:99], v4 offset:2048
  v_mfma_f32_16x16x32_bf16 v[8:11], a[100:103], a[140:143], v[8:11]
  v_lshlrev_b32 v6, 25, v7
  v_mfma_f32_16x16x32_bf16 v[8:11], a[120:123], a[204:207], v[8:11]
  ds_write_b128 v250, v[68:71] offset:0
  ds_read_b128 v[116:119], v4 offset:7168
  v_mfma_f32_16x16x32_bf16 v[12:15], a[124:127], a[204:207], v[12:15]
  buffer_store_dword v3, v6, s[16:19], s72 offen sc1
  v_mfma_f32_16x16x32_bf16 v[12:15], a[104:107], a[140:143], v[12:15]
  s_add_u32 s43, s42, 65536
  ds_write_b128 v250, v[72:75] offset:1024
  ds_read_b128 v[100:103], v4 offset:3072
  v_mfma_f32_16x16x32_bf16 v[12:15], a[84:87], a[188:191], v[12:15]
  v_mfma_f32_16x16x32_bf16 v[16:19], a[88:91], a[188:191], v[16:19]
  buffer_load_dwordx4 a[32:35], v4, s[16:19], s43 offen sc1
  v_mfma_f32_16x16x32_bf16 v[16:19], a[108:111], a[140:143], v[16:19]
  buffer_load_dwordx4 a[36:39], v5, s[16:19], s43 offen sc1
  ds_write_b128 v250, v[76:79] offset:2048
  ds_read_b128 v[120:123], v4 offset:8192
  v_mfma_f32_16x16x32_bf16 v[16:19], a[128:131], a[204:207], v[16:19]
  v_mfma_f32_16x16x32_bf16 v[20:23], a[132:135], a[204:207], v[20:23]
  s_add_u32 s43, s42, 81920
  ds_write_b128 v250, v[80:83] offset:3072
  ds_read_b128 v[104:107], v4 offset:4096
  v_mfma_f32_16x16x32_bf16 v[20:23], a[112:115], a[140:143], v[20:23]
  buffer_load_dwordx4 a[40:43], v4, s[16:19], s43 offen sc1
  v_mfma_f32_16x16x32_bf16 v[20:23], a[92:95], a[188:191], v[20:23]
  ds_read_b128 v[124:127], v4 offset:9216
  v_mfma_f32_16x16x32_bf16 v[24:27], a[96:99], a[188:191], v[24:27]
  buffer_load_dwordx4 a[44:47], v5, s[16:19], s43 offen sc1
  ds_write_b128 v250, v[84:87] offset:4096
  v_mfma_f32_16x16x32_bf16 v[24:27], a[116:119], a[140:143], v[24:27]
  v_mfma_f32_16x16x32_bf16 v[24:27], a[136:139], a[204:207], v[24:27]
  s_waitcnt vmcnt(11) lgkmcnt(12)
  v_mfma_f32_16x16x32_bf16 v[208:211], v[88:91], a[0:3], 0
  ds_read_b128 v[128:131], v4 offset:10240
  s_add_u32 s43, s42, 98304
  s_mov_b32 s30, 3216550459
  v_mfma_f32_16x16x32_bf16 v[208:211], v[108:111], a[4:7], v[208:211]
  ds_read_b128 a[80:83], v4 offset:15360
  buffer_load_dwordx4 a[48:51], v4, s[16:19], s43 offen sc1
  v_mfma_f32_16x16x32_bf16 v[212:215], v[112:115], a[4:7], 0
  ds_read_b128 v[132:135], v4 offset:11264
  buffer_load_dwordx4 a[52:55], v5, s[16:19], s43 offen sc1
  s_mov_b32 s31, 3216550459
  v_mfma_f32_16x16x32_bf16 v[212:215], v[92:95], a[0:3], v[212:215]
  ds_read_b128 a[84:87], v4 offset:16384
  s_waitcnt lgkmcnt(4)
  s_barrier
  v_mfma_f32_16x16x32_bf16 v[216:219], v[96:99], a[0:3], 0
  ds_read_b128 v[136:139], v4 offset:12288
  s_add_u32 s43, s42, 114688
  ds_read_b128 v[28:31], v1 offset:0
  v_mfma_f32_16x16x32_bf16 v[216:219], v[116:119], a[4:7], v[216:219]
  ds_read_b128 a[88:91], v4 offset:17408
  ds_read_b128 v[32:35], v1 offset:1024
  v_mfma_f32_16x16x32_bf16 v[220:223], v[120:123], a[4:7], 0
  ds_read_b128 v[140:143], v4 offset:13312
  buffer_load_dwordx4 a[56:59], v4, s[16:19], s43 offen sc1
  ds_read_b128 v[36:39], v1 offset:2048
  v_mfma_f32_16x16x32_bf16 v[220:223], v[100:103], a[0:3], v[220:223]
  ds_read_b128 a[92:95], v4 offset:18432
  ds_read_b128 v[40:43], v1 offset:3072
  v_mfma_f32_16x16x32_bf16 v[224:227], v[104:107], a[0:3], 0
  ds_read_b128 v[144:147], v4 offset:14336
  buffer_load_dwordx4 a[60:63], v5, s[16:19], s43 offen sc1
  ds_read_b128 v[44:47], v1 offset:4096
  v_mfma_f32_16x16x32_bf16 v[224:227], v[124:127], a[4:7], v[224:227]
  ds_read_b128 a[96:99], v4 offset:19456
  s_waitcnt vmcnt(13) lgkmcnt(11)
  v_mfma_f32_16x16x32_bf16 v[208:211], a[80:83], a[12:15], v[208:211]
  ds_read_b128 v[88:91], v4 offset:20480
  v_mov_b32 v254, s73
  buffer_load_dword v255, v254, s[16:19], 0 offen sc1
  ds_read_b128 v[48:51], v1 offset:5120
  ds_read_b128 v[52:55], v1 offset:6144
  v_mfma_f32_16x16x32_bf16 v[208:211], v[128:131], a[8:11], v[208:211]
  ds_read_b128 v[108:111], v4 offset:25600
  s_add_u32 s43, s42, 131072
  ds_read_b128 v[56:59], v1 offset:7168
  v_mfma_f32_16x16x32_bf16 v[212:215], v[132:135], a[8:11], v[212:215]
  ds_read_b128 v[92:95], v4 offset:21504
  buffer_load_dwordx4 a[64:67], v4, s[16:19], s43 offen sc1
  ds_read_b128 v[60:63], v1 offset:8192
  v_mfma_f32_16x16x32_bf16 v[212:215], a[84:87], a[12:15], v[212:215]
  ds_read_b128 v[112:115], v4 offset:26624
  buffer_load_dwordx4 a[68:71], v5, s[16:19], s43 offen sc1
  ds_read_b128 v[64:67], v1 offset:9216
  s_waitcnt lgkmcnt(9)
  v_mfma_f32_16x16x32_bf16 v[216:219], a[88:91], a[12:15], v[216:219]
  ds_read_b128 v[96:99], v4 offset:22528
  ds_read_b128 v[68:71], v1 offset:10240
  v_mfma_f32_16x16x32_bf16 v[216:219], v[136:139], a[8:11], v[216:219]
  ds_read_b128 v[116:119], v4 offset:27648
  ds_read_b128 v[72:75], v1 offset:11264
  v_mfma_f32_16x16x32_bf16 v[220:223], v[140:143], a[8:11], v[220:223]
  ds_read_b128 v[100:103], v4 offset:23552
  ds_read_b128 v[76:79], v1 offset:12288
  v_mfma_f32_16x16x32_bf16 v[220:223], a[92:95], a[12:15], v[220:223]
  ds_read_b128 v[120:123], v4 offset:28672
  ds_read_b128 v[80:83], v1 offset:13312
  v_mfma_f32_16x16x32_bf16 v[224:227], a[96:99], a[12:15], v[224:227]
  ds_read_b128 v[104:107], v4 offset:24576
  ds_read_b128 v[84:87], v1 offset:14336
  v_mfma_f32_16x16x32_bf16 v[224:227], v[144:147], a[8:11], v[224:227]
  ds_read_b128 v[124:127], v4 offset:29696
  s_waitcnt vmcnt(14) lgkmcnt(12)
  v_mfma_f32_16x16x32_bf16 v[208:211], v[88:91], a[16:19], v[208:211]
  ds_read_b128 v[128:131], v4 offset:30720
  s_add_u32 s43, s42, 147456
  v_mfma_f32_16x16x32_bf16 v[208:211], v[108:111], a[20:23], v[208:211]
  ds_read_b128 a[80:83], v4 offset:35840
  buffer_load_dwordx4 a[72:75], v4, s[16:19], s43 offen sc1
  v_mfma_f32_16x16x32_bf16 v[212:215], v[112:115], a[20:23], v[212:215]
  ds_read_b128 v[132:135], v4 offset:31744
  buffer_load_dwordx4 a[76:79], v5, s[16:19], s43 offen sc1
  v_mfma_f32_16x16x32_bf16 v[212:215], v[92:95], a[16:19], v[212:215]
  ds_read_b128 a[84:87], v4 offset:36864
  s_waitcnt lgkmcnt(4)
  v_mfma_f32_16x16x32_bf16 v[216:219], v[96:99], a[16:19], v[216:219]
  ds_read_b128 v[136:139], v4 offset:32768
  v_add_f32 v8, v8, v28
  v_add_f32 v9, v9, v29
  v_mfma_f32_16x16x32_bf16 v[216:219], v[116:119], a[20:23], v[216:219]
  ds_read_b128 a[88:91], v4 offset:37888
  v_add_f32 v10, v10, v30
  v_add_f32 v11, v11, v31
  v_mfma_f32_16x16x32_bf16 v[220:223], v[120:123], a[20:23], v[220:223]
  ds_read_b128 v[140:143], v4 offset:33792
  v_add_f32 v12, v12, v32
  v_add_f32 v13, v13, v33
  v_mfma_f32_16x16x32_bf16 v[220:223], v[100:103], a[16:19], v[220:223]
  ds_read_b128 a[92:95], v4 offset:38912
  v_add_f32 v14, v14, v34
  v_add_f32 v15, v15, v35
  v_mfma_f32_16x16x32_bf16 v[224:227], v[104:107], a[16:19], v[224:227]
  ds_read_b128 v[144:147], v4 offset:34816
  v_add_f32 v16, v16, v36
  v_add_f32 v17, v17, v37
  v_mfma_f32_16x16x32_bf16 v[224:227], v[124:127], a[20:23], v[224:227]
  ds_read_b128 a[96:99], v4 offset:39936
  v_add_f32 v18, v18, v38
  v_add_f32 v19, v19, v39
  s_waitcnt vmcnt(4) lgkmcnt(6)
  v_cmp_ne_u32 vcc, s39, v255
  s_nop 1
  s_cmp_lg_u64 vcc, 0
  s_cbranch_scc1 k_sx_slow
k_sx_ok:
  v_mfma_f32_16x16x32_bf16 v[208:211], a[80:83], a[28:31], v[208:211]
  ds_read_b128 v[88:91], v4 offset:40960
  buffer_load_dwordx4 v[168:171], v4, s[16:19], s65 offen offset:0 sc1
  v_add_f32 v20, v20, v40
  v_add_f32 v21, v21, v41
  v_mfma_f32_16x16x32_bf16 v[208:211], v[128:131], a[24:27], v[208:211]
  ds_read_b128 v[108:111], v4 offset:46080
  buffer_load_dwordx4 v[172:175], v4, s[16:19], s65 offen offset:1024 sc1
  v_add_f32 v22, v22, v42
  v_add_f32 v23, v23, v43
  v_mfma_f32_16x16x32_bf16 v[212:215], v[132:135], a[24:27], v[212:215]
  ds_read_b128 v[92:95], v4 offset:41984
  buffer_load_dwordx2 v[176:177], v0, s[16:19], s65 offen offset:2048 sc1
  v_add_f32 v24, v24, v44
  v_add_f32 v25, v25, v45
  v_mfma_f32_16x16x32_bf16 v[212:215], a[84:87], a[28:31], v[212:215]
  ds_read_b128 v[112:115], v4 offset:47104
  v_add_f32 v26, v26, v46
  v_add_f32 v27, v27, v47
  s_waitcnt lgkmcnt(4)
  v_mfma_f32_16x16x32_bf16 v[216:219], a[88:91], a[28:31], v[216:219]
  ds_read_b128 v[96:99], v4 offset:43008
  v_add_f32 v8, v8, v48
  v_add_f32 v9, v9, v49
  v_mfma_f32_16x16x32_bf16 v[216:219], v[136:139], a[24:27], v[216:219]
  ds_read_b128 v[116:119], v4 offset:48128
  v_add_f32 v10, v10, v50
  v_add_f32 v11, v11, v51
  v_mfma_f32_16x16x32_bf16 v[220:223], v[140:143], a[24:27], v[220:223]
  ds_read_b128 v[100:103], v4 offset:44032
  v_add_f32 v12, v12, v52
  v_add_f32 v13, v13, v53
  v_mfma_f32_16x16x32_bf16 v[220:223], a[92:95], a[28:31], v[220:223]
  ds_read_b128 v[120:123], v4 offset:49152
  v_add_f32 v14, v14, v54
  v_add_f32 v15, v15, v55
  v_mfma_f32_16x16x32_bf16 v[224:227], a[96:99], a[28:31], v[224:227]
  ds_read_b128 v[104:107], v4 offset:45056
  v_add_f32 v16, v16, v56
  v_add_f32 v17, v17, v57
  v_mfma_f32_16x16x32_bf16 v[224:227], v[144:147], a[24:27], v[224:227]
  ds_read_b128 v[124:127], v4 offset:50176
  v_add_f32 v18, v18, v58
  v_add_f32 v19, v19, v59
  s_waitcnt vmcnt(14) lgkmcnt(6)
  v_mfma_f32_16x16x32_bf16 v[208:211], v[88:91], a[32:35], v[208:211]
  ds_read_b128 v[128:131], v2 offset:0
  v_add_f32 v20, v20, v60
  v_add_f32 v21, v21, v61
  v_mfma_f32_16x16x32_bf16 v[208:211], v[108:111], a[36:39], v[208:211]
  ds_read_b128 a[80:83], v2 offset:5120
  v_add_f32 v22, v22, v62
  v_add_f32 v23, v23, v63
  v_mfma_f32_16x16x32_bf16 v[212:215], v[112:115], a[36:39], v[212:215]
  ds_read_b128 v[132:135], v2 offset:1024
  v_add_f32 v24, v24, v64
  v_add_f32 v25, v25, v65
  v_mfma_f32_16x16x32_bf16 v[212:215], v[92:95], a[32:35], v[212:215]
  ds_read_b128 a[84:87], v2 offset:6144
  v_add_f32 v26, v26, v66
  v_add_f32 v27, v27, v67
  s_waitcnt lgkmcnt(4)
  v_mfma_f32_16x16x32_bf16 v[216:219], v[96:99], a[32:35], v[216:219]
  ds_read_b128 v[136:139], v2 offset:2048
  v_add_f32 v8, v8, v68
  v_add_f32 v9, v9, v69
  v_mfma_f32_16x16x32_bf16 v[216:219], v[116:119], a[36:39], v[216:219]
  ds_read_b128 a[88:91], v2 offset:7168
  v_add_f32 v10, v10, v70
  v_add_f32 v11, v11, v71
  v_mfma_f32_16x16x32_bf16 v[220:223], v[120:123], a[36:39], v[220:223]
  ds_read_b128 v[140:143], v2 offset:3072
  v_add_f32 v12, v12, v72
  v_add_f32 v13, v13, v73
  v_mfma_f32_16x16x32_bf16 v[220:223], v[100:103], a[32:35], v[220:223]
  ds_read_b128 a[92:95], v2 offset:8192
  v_add_f32 v14, v14, v74
  v_add_f32 v15, v15, v75
  v_mfma_f32_16x16x32_bf16 v[224:227], v[104:107], a[32:35], v[224:227]
  ds_read_b128 v[144:147], v2 offset:4096
  v_add_f32 v16, v16, v76
  v_add_f32 v17, v17, v77
  v_mfma_f32_16x16x32_bf16 v[224:227], v[124:127], a[36:39], v[224:227]
  ds_read_b128 a[96:99], v2 offset:9216
  v_add_f32 v18, v18, v78
  v_add_f32 v19, v19, v79
  s_waitcnt vmcnt(12) lgkmcnt(6)
  v_mfma_f32_16x16x32_bf16 v[208:211], a[80:83], a[44:47], v[208:211]
  ds_read_b128 v[88:91], v2 offset:10240
  v_add_f32 v20, v20, v80
  v_add_f32 v21, v21, v81
  v_mfma_f32_16x16x32_bf16 v[208:211], v[128:131], a[40:43], v[208:211]
  ds_read_b128 v[108:111], v2 offset:15360
  v_add_f32 v22, v22, v82
  v_add_f32 v23, v23, v83
  v_mfma_f32_16x16x32_bf16 v[212:215], v[132:135], a[40:43], v[212:215]
  ds_read_b128 v[92:95], v2 offset:11264
  v_add_f32 v24, v24, v84
  v_add_f32 v25, v25, v85
  v_mfma_f32_16x16x32_bf16 v[212:215], a[84:87], a[44:47], v[212:215]
  ds_read_b128 v[112:115], v2 offset:16384
  v_add_f32 v26, v26, v86
  v_add_f32 v27, v27, v87
  s_waitcnt vmcnt(0) lgkmcnt(4)
  v_lshlrev_b32_e64 v148, 16, v168
  v_and_b32 v149, 0xffff0000, v168
  v_lshlrev_b32_e64 v150, 16, v169
  v_and_b32 v151, 0xffff0000, v169
  v_lshlrev_b32_e64 v152, 16, v170
  v_and_b32 v153, 0xffff0000, v170
  v_lshlrev_b32_e64 v154, 16, v171
  v_and_b32 v155, 0xffff0000, v171
  v_lshlrev_b32_e64 v156, 16, v172
  v_and_b32 v157, 0xffff0000, v172
  v_lshlrev_b32_e64 v158, 16, v173
  v_and_b32 v159, 0xffff0000, v173
  v_lshlrev_b32_e64 v160, 16, v174
  v_and_b32 v161, 0xffff0000, v174
  v_lshlrev_b32_e64 v162, 16, v175
  v_and_b32 v163, 0xffff0000, v175
  v_lshlrev_b32_e64 v164, 16, v176
  v_and_b32 v165, 0xffff0000, v176
  v_lshlrev_b32_e64 v166, 16, v177
  v_and_b32 v167, 0xffff0000, v177
  v_pk_add_f32 v[8:9], v[8:9], v[148:149]
  v_pk_add_f32 v[10:11], v[10:11], v[150:151]
  v_pk_add_f32 v[12:13], v[12:13], v[152:153]
  v_pk_add_f32 v[14:15], v[14:15], v[154:155]
  v_pk_add_f32 v[16:17], v[16:17], v[156:157]
  v_pk_add_f32 v[18:19], v[18:19], v[158:159]
  v_pk_add_f32 v[20:21], v[20:21], v[160:161]
  v_pk_add_f32 v[22:23], v[22:23], v[162:163]
  v_pk_add_f32 v[24:25], v[24:25], v[164:165]
  v_pk_add_f32 v[26:27], v[26:27], v[166:167]
  v_pk_mul_f32 v[28:29], v[8:9], s[30:31]
  v_pk_mul_f32 v[30:31], v[10:11], s[30:31]
  v_pk_mul_f32 v[32:33], v[12:13], s[30:31]
  v_pk_mul_f32 v[34:35], v[14:15], s[30:31]
  v_pk_mul_f32 v[36:37], v[16:17], s[30:31]
  v_pk_mul_f32 v[38:39], v[18:19], s[30:31]
  v_pk_mul_f32 v[40:41], v[20:21], s[30:31]
  v_pk_mul_f32 v[42:43], v[22:23], s[30:31]
  v_pk_mul_f32 v[44:45], v[24:25], s[30:31]
  v_pk_mul_f32 v[46:47], v[26:27], s[30:31]
  v_mfma_f32_16x16x32_bf16 v[216:219], a[88:91], a[44:47], v[216:219]
  ds_read_b128 v[96:99], v2 offset:12288
  v_exp_f32 v28, v28
  v_exp_f32 v29, v29
  v_mfma_f32_16x16x32_bf16 v[216:219], v[136:139], a[40:43], v[216:219]
  ds_read_b128 v[116:119], v2 offset:17408
  v_exp_f32 v30, v30
  v_mfma_f32_16x16x32_bf16 v[220:223], v[140:143], a[40:43], v[220:223]
  ds_read_b128 v[100:103], v2 offset:13312
  v_exp_f32 v31, v31
  v_mfma_f32_16x16x32_bf16 v[220:223], a[92:95], a[44:47], v[220:223]
  ds_read_b128 v[120:123], v2 offset:18432
  v_exp_f32 v32, v32
  v_exp_f32 v33, v33
  v_mfma_f32_16x16x32_bf16 v[224:227], a[96:99], a[44:47], v[224:227]
  ds_read_b128 v[104:107], v2 offset:14336
  v_exp_f32 v34, v34
  v_mfma_f32_16x16x32_bf16 v[224:227], v[144:147], a[40:43], v[224:227]
  ds_read_b128 v[124:127], v2 offset:19456
  v_exp_f32 v35, v35
  s_waitcnt vmcnt(10) lgkmcnt(6)
  v_mfma_f32_16x16x32_bf16 v[208:211], v[88:91], a[48:51], v[208:211]
  ds_read_b128 v[128:131], v2 offset:20480
  v_exp_f32 v36, v36
  v_exp_f32 v37, v37
  v_mfma_f32_16x16x32_bf16 v[208:211], v[108:111], a[52:55], v[208:211]
  ds_read_b128 a[80:83], v2 offset:25600
  v_exp_f32 v38, v38
  v_mfma_f32_16x16x32_bf16 v[212:215], v[112:115], a[52:55], v[212:215]
  ds_read_b128 v[132:135], v2 offset:21504
  v_exp_f32 v39, v39
  v_mfma_f32_16x16x32_bf16 v[212:215], v[92:95], a[48:51], v[212:215]
  ds_read_b128 a[84:87], v2 offset:26624
  v_exp_f32 v40, v40
  s_waitcnt lgkmcnt(4)
  v_mfma_f32_16x16x32_bf16 v[216:219], v[96:99], a[48:51], v[216:219]
  ds_read_b128 v[136:139], v2 offset:22528
  v_exp_f32 v41, v41
  v_exp_f32 v42, v42
  v_mfma_f32_16x16x32_bf16 v[216:219], v[116:119], a[52:55], v[216:219]
  ds_read_b128 a[88:91], v2 offset:27648
  v_exp_f32 v43, v43
  v_mfma_f32_16x16x32_bf16 v[220:223], v[120:123], a[52:55], v[220:223]
  ds_read_b128 v[140:143], v2 offset:23552
  v_exp_f32 v44, v44
  v_exp_f32 v45, v45
  v_mfma_f32_16x16x32_bf16 v[220:223], v[100:103], a[48:51], v[220:223]
  ds_read_b128 a[92:95], v2 offset:28672
  v_exp_f32 v46, v46
  v_mfma_f32_16x16x32_bf16 v[224:227], v[104:107], a[48:51], v[224:227]
  ds_read_b128 v[144:147], v2 offset:24576
  v_exp_f32 v47, v47
  v_add_f32 v28, 1.0, v28
  v_mfma_f32_16x16x32_bf16 v[224:227], v[124:127], a[52:55], v[224:227]
  ds_read_b128 a[96:99], v2 offset:29696
  v_add_f32 v29, 1.0, v29
  s_waitcnt vmcnt(8) lgkmcnt(6)
  v_mfma_f32_16x16x32_bf16 v[208:211], a[80:83], a[60:63], v[208:211]
  ds_read_b128 v[88:91], v2 offset:30720
  v_add_f32 v30, 1.0, v30
  v_add_f32 v31, 1.0, v31
  v_add_f32 v32, 1.0, v32
  v_mfma_f32_16x16x32_bf16 v[208:211], v[128:131], a[56:59], v[208:211]
  ds_read_b128 v[108:111], v2 offset:35840
  v_add_f32 v33, 1.0, v33
  v_add_f32 v34, 1.0, v34
  v_add_f32 v35, 1.0, v35
  v_mfma_f32_16x16x32_bf16 v[212:215], v[132:135], a[56:59], v[212:215]
  ds_read_b128 v[92:95], v2 offset:31744
  v_add_f32 v36, 1.0, v36
  v_add_f32 v37, 1.0, v37
  v_add_f32 v38, 1.0, v38
  v_mfma_f32_16x16x32_bf16 v[212:215], a[84:87], a[60:63], v[212:215]
  ds_read_b128 v[112:115], v2 offset:36864
  v_add_f32 v39, 1.0, v39
  v_add_f32 v40, 1.0, v40
  s_waitcnt lgkmcnt(4)
  v_mfma_f32_16x16x32_bf16 v[216:219], a[88:91], a[60:63], v[216:219]
  ds_read_b128 v[96:99], v2 offset:32768
  v_add_f32 v41, 1.0, v41
  v_add_f32 v42, 1.0, v42
  v_mfma_f32_16x16x32_bf16 v[216:219], v[136:139], a[56:59], v[216:219]
  ds_read_b128 v[116:119], v2 offset:37888
  v_add_f32 v43, 1.0, v43
  v_add_f32 v44, 1.0, v44
  v_mfma_f32_16x16x32_bf16 v[220:223], v[140:143], a[56:59], v[220:223]
  ds_read_b128 v[100:103], v2 offset:33792
  v_add_f32 v45, 1.0, v45
  v_add_f32 v46, 1.0, v46
  v_mfma_f32_16x16x32_bf16 v[220:223], a[92:95], a[60:63], v[220:223]
  ds_read_b128 v[120:123], v2 offset:38912
  v_add_f32 v47, 1.0, v47
  v_rcp_f32 v28, v28
  v_mfma_f32_16x16x32_bf16 v[224:227], a[96:99], a[60:63], v[224:227]
  ds_read_b128 v[104:107], v2 offset:34816
  v_rcp_f32 v29, v29
  v_rcp_f32 v30, v30
  v_mfma_f32_16x16x32_bf16 v[224:227], v[144:147], a[56:59], v[224:227]
  ds_read_b128 v[124:127], v2 offset:39936
  v_rcp_f32 v31, v31
  s_waitcnt vmcnt(5) lgkmcnt(6)
  v_mfma_f32_16x16x32_bf16 v[208:211], v[88:91], a[64:67], v[208:211]
  ds_read_b128 v[128:131], v2 offset:40960
  v_rcp_f32 v32, v32
  v_rcp_f32 v33, v33
  v_mfma_f32_16x16x32_bf16 v[208:211], v[108:111], a[68:71], v[208:211]
  ds_read_b128 a[80:83], v2 offset:46080
  v_rcp_f32 v34, v34
  v_mfma_f32_16x16x32_bf16 v[212:215], v[112:115], a[68:71], v[212:215]
  ds_read_b128 v[132:135], v2 offset:41984
  v_rcp_f32 v35, v35
  v_rcp_f32 v36, v36
  v_mfma_f32_16x16x32_bf16 v[212:215], v[92:95], a[64:67], v[212:215]
  ds_read_b128 a[84:87], v2 offset:47104
  v_rcp_f32 v37, v37
  s_waitcnt lgkmcnt(4)
  v_mfma_f32_16x16x32_bf16 v[216:219], v[96:99], a[64:67], v[216:219]
  ds_read_b128 v[136:139], v2 offset:43008
  v_rcp_f32 v38, v38
  v_rcp_f32 v39, v39
  v_mfma_f32_16x16x32_bf16 v[216:219], v[116:119], a[68:71], v[216:219]
  ds_read_b128 a[88:91], v2 offset:48128
  v_rcp_f32 v40, v40
  v_mfma_f32_16x16x32_bf16 v[220:223], v[120:123], a[68:71], v[220:223]
  ds_read_b128 v[140:143], v2 offset:44032
  v_rcp_f32 v41, v41
  v_mfma_f32_16x16x32_bf16 v[220:223], v[100:103], a[64:67], v[220:223]
  ds_read_b128 a[92:95], v2 offset:49152
  v_rcp_f32 v42, v42
  v_mfma_f32_16x16x32_bf16 v[224:227], v[104:107], a[64:67], v[224:227]
  ds_read_b128 v[144:147], v2 offset:45056
  v_rcp_f32 v43, v43
  v_mfma_f32_16x16x32_bf16 v[224:227], v[124:127], a[68:71], v[224:227]
  ds_read_b128 a[96:99], v2 offset:50176
  v_rcp_f32 v44, v44
  s_waitcnt vmcnt(3) lgkmcnt(6)
  v_mfma_f32_16x16x32_bf16 v[208:211], a[80:83], a[76:79], v[208:211]
  v_rcp_f32 v45, v45
  v_rcp_f32 v46, v46
  v_mfma_f32_16x16x32_bf16 v[208:211], v[128:131], a[72:75], v[208:211]
  v_rcp_f32 v47, v47
  v_mul_f32 v8, v8, v28
  v_mfma_f32_16x16x32_bf16 v[212:215], v[132:135], a[72:75], v[212:215]
  v_mul_f32 v9, v9, v29
  v_mul_f32 v10, v10, v30
  v_mfma_f32_16x16x32_bf16 v[212:215], a[84:87], a[76:79], v[212:215]
  v_mul_f32 v11, v11, v31
  v_mul_f32 v12, v12, v32
  s_waitcnt lgkmcnt(0)
  v_mfma_f32_16x16x32_bf16 v[216:219], a[88:91], a[76:79], v[216:219]
  v_mul_f32 v13, v13, v33
  v_mul_f32 v14, v14, v34
  v_mul_f32 v15, v15, v35
  v_mfma_f32_16x16x32_bf16 v[216:219], v[136:139], a[72:75], v[216:219]
  v_mul_f32 v16, v16, v36
  v_mul_f32 v17, v17, v37
  v_mfma_f32_16x16x32_bf16 v[220:223], v[140:143], a[72:75], v[220:223]
  v_mul_f32 v18, v18, v38
  v_mul_f32 v19, v19, v39
  v_mul_f32 v20, v20, v40
  v_mfma_f32_16x16x32_bf16 v[220:223], a[92:95], a[76:79], v[220:223]
  v_mul_f32 v21, v21, v41
  v_mul_f32 v22, v22, v42
  v_mfma_f32_16x16x32_bf16 v[224:227], a[96:99], a[76:79], v[224:227]
  v_mul_f32 v23, v23, v43
  v_mul_f32 v24, v24, v44
  v_mul_f32 v25, v25, v45
  v_mfma_f32_16x16x32_bf16 v[224:227], v[144:147], a[72:75], v[224:227]
  v_mul_f32 v26, v26, v46
  v_mul_f32 v27, v27, v47
  v_pk_fma_f32 v[208:209], v[208:209], v[8:9], v[184:185]
  v_pk_fma_f32 v[210:211], v[210:211], v[10:11], v[186:187]
  v_cvt_pk_bf16_f32 v228, v208, v209
  v_cvt_pk_bf16_f32 v229, v210, v211
  ds_write_b64 v243, v[228:229] offset:0
  v_pk_fma_f32 v[212:213], v[212:213], v[12:13], v[188:189]
  v_pk_fma_f32 v[214:215], v[214:215], v[14:15], v[190:191]
  v_cvt_pk_bf16_f32 v230, v212, v213
  v_cvt_pk_bf16_f32 v231, v214, v215
  ds_write_b64 v243, v[230:231] offset:32
  v_pk_fma_f32 v[216:217], v[216:217], v[16:17], v[192:193]
  v_pk_fma_f32 v[218:219], v[218:219], v[18:19], v[194:195]
  v_cvt_pk_bf16_f32 v232, v216, v217
  v_cvt_pk_bf16_f32 v233, v218, v219
  ds_write_b64 v243, v[232:233] offset:64
  v_pk_fma_f32 v[220:221], v[220:221], v[20:21], v[196:197]
  v_pk_fma_f32 v[222:223], v[222:223], v[22:23], v[198:199]
  v_cvt_pk_bf16_f32 v234, v220, v221
  v_cvt_pk_bf16_f32 v235, v222, v223
  ds_write_b64 v243, v[234:235] offset:96
  v_pk_fma_f32 v[224:225], v[224:225], v[24:25], v[200:201]
  v_pk_fma_f32 v[226:227], v[226:227], v[26:27], v[202:203]
  v_cvt_pk_bf16_f32 v236, v224, v225
  v_cvt_pk_bf16_f32 v237, v226, v227
  ds_write_b64 v243, v[236:237] offset:128
  s_waitcnt lgkmcnt(0)
  ds_read_b128 v[28:31], v240
  ds_read_b128 v[32:35], v241
  ds_read_b128 v[36:39], v242
  s_waitcnt lgkmcnt(2)
  buffer_store_dwordx4 v[28:31], v251, s[4:7], s48 offen
  s_waitcnt lgkmcnt(1)
  buffer_store_dwordx4 v[32:35], v252, s[4:7], s48 offen
  s_waitcnt lgkmcnt(0)
  buffer_store_dwordx4 v[36:39], v253, s[4:7], s48 offen
  s_endpgm
k_q:
  v_mul_f32 v214, s83, v213
  v_mul_f32 v218, s83, v217
  v_mul_f32 v222, s83, v221
  v_mul_f32 v226, s83, v225
  v_mul_f32 v230, s83, v229
  v_mul_f32_e64 v234, s83, v233
  v_pk_fma_f32 v[8:9], v[128:129], v[212:213], v[8:9] op_sel_hi:[1,0,1]
  v_pk_fma_f32 v[10:11], v[130:131], v[212:213], v[10:11] op_sel_hi:[1,0,1]
  v_pk_fma_f32 v[12:13], v[132:133], v[212:213], v[12:13] op_sel_hi:[1,0,1]
  v_pk_fma_f32 v[14:15], v[134:135], v[212:213], v[14:15] op_sel_hi:[1,0,1]
  v_pk_fma_f32 v[28:29], v[128:129], v[216:217], v[28:29] op_sel_hi:[1,0,1]
  v_pk_fma_f32 v[30:31], v[130:131], v[216:217], v[30:31] op_sel_hi:[1,0,1]
  s_add_u32 s68, s46, 786432
  s_cmp_lt_u32 s20, 3
  s_cselect_b32 s68, s68, 1073741824
  buffer_load_dwordx4 a[124:127], v4, s[16:19], s68 offen offset:1024 sc1
  v_pk_fma_f32 v[32:33], v[132:133], v[216:217], v[32:33] op_sel_hi:[1,0,1]
  v_pk_fma_f32 v[34:35], v[134:135], v[216:217], v[34:35] op_sel_hi:[1,0,1]
  v_pk_mul_f32 v[148:149], v[8:9], v[214:215] op_sel_hi:[1,0]
  v_pk_mul_f32 v[150:151], v[10:11], v[214:215] op_sel_hi:[1,0]
  v_pk_mul_f32 v[152:153], v[12:13], v[214:215] op_sel_hi:[1,0]
  v_pk_mul_f32 v[154:155], v[14:15], v[214:215] op_sel_hi:[1,0]
  v_pk_mul_f32 v[156:157], v[28:29], v[218:219] op_sel_hi:[1,0]
  v_pk_mul_f32 v[158:159], v[30:31], v[218:219] op_sel_hi:[1,0]
  v_pk_mul_f32 v[160:161], v[32:33], v[218:219] op_sel_hi:[1,0]
  v_pk_mul_f32 v[162:163], v[34:35], v[218:219] op_sel_hi:[1,0]
  buffer_load_dwordx4 a[128:131], v4, s[16:19], s68 offen offset:2048 sc1
  v_exp_f32_e64 v148, v148 clamp
  v_exp_f32_e64 v149, v149 clamp
  v_exp_f32_e64 v150, v150 clamp
  v_exp_f32_e64 v151, v151 clamp
  v_exp_f32_e64 v152, v152 clamp
  v_exp_f32_e64 v153, v153 clamp
  v_exp_f32_e64 v154, v154 clamp
  v_exp_f32_e64 v155, v155 clamp
  v_exp_f32_e64 v156, v156 clamp
  v_exp_f32_e64 v157, v157 clamp
  buffer_load_dwordx4 a[132:135], v4, s[16:19], s68 offen offset:3072 sc1
  v_exp_f32_e64 v158, v158 clamp
  v_exp_f32_e64 v159, v159 clamp
  v_exp_f32_e64 v160, v160 clamp
  v_exp_f32_e64 v161, v161 clamp
  v_exp_f32_e64 v162, v162 clamp
  v_exp_f32_e64 v163, v163 clamp
  v_pk_fma_f32 v[8:9], v[8:9], v[212:213], 1.0 op_sel:[0,1,0] op_sel_hi:[1,1,0]
  v_pk_fma_f32 v[10:11], v[10:11], v[212:213], 1.0 op_sel:[0,1,0] op_sel_hi:[1,1,0]
  v_pk_fma_f32 v[12:13], v[12:13], v[212:213], 1.0 op_sel:[0,1,0] op_sel_hi:[1,1,0]
  v_pk_fma_f32 v[14:15], v[14:15], v[212:213], 1.0 op_sel:[0,1,0] op_sel_hi:[1,1,0]
  buffer_load_dwordx4 a[136:139], v5, s[16:19], s68 offen sc1
  v_pk_fma_f32 v[28:29], v[28:29], v[216:217], 1.0 op_sel:[0,1,0] op_sel_hi:[1,1,0]
  v_pk_fma_f32 v[30:31], v[30:31], v[216:217], 1.0 op_sel:[0,1,0] op_sel_hi:[1,1,0]
  v_pk_fma_f32 v[32:33], v[32:33], v[216:217], 1.0 op_sel:[0,1,0] op_sel_hi:[1,1,0]
  v_pk_fma_f32 v[34:35], v[34:35], v[216:217], 1.0 op_sel:[0,1,0] op_sel_hi:[1,1,0]
  v_max_f32 v8, v8, v148
  v_max_f32 v9, v9, v149
  v_max_f32 v10, v10, v150
  v_max_f32 v11, v11, v151
  v_max_f32 v12, v12, v152
  v_max_f32 v13, v13, v153
  s_add_u32 m0, s69, 0
  s_add_u32 s71, s70, 0
  buffer_load_dwordx4 v4, s[16:19], s71 offen offset:0 sc1 lds
  v_max_f32 v14, v14, v154
  v_max_f32 v15, v15, v155
  v_max_f32 v28, v28, v156
  v_max_f32 v29, v29, v157
  v_max_f32 v30, v30, v158
  v_max_f32 v31, v31, v159
  v_max_f32 v32, v32, v160
  v_max_f32 v33, v33, v161
  v_max_f32 v34, v34, v162
  v_max_f32 v35, v35, v163
  v_pk_add_f32 v[8:9], v[8:9], v[240:241]
  v_pk_add_f32 v[10:11], v[10:11], v[240:241]
  v_pk_add_f32 v[12:13], v[12:13], v[240:241]
  v_pk_add_f32 v[14:15], v[14:15], v[240:241]
  v_cvt_pk_bf16_f32 v172, v8, v9
  v_cvt_pk_bf16_f32 v173, v10, v11
  v_cvt_pk_bf16_f32 v174, v12, v13
  v_cvt_pk_bf16_f32 v175, v14, v15
  buffer_store_dwordx4 v[172:175], v236, s[16:19], s80 offen offset:0 sc1
  v_pk_add_f32 v[28:29], v[28:29], v[240:241]
  v_pk_add_f32 v[30:31], v[30:31], v[240:241]
  v_pk_add_f32 v[32:33], v[32:33], v[240:241]
  v_pk_add_f32 v[34:35], v[34:35], v[240:241]
  v_cvt_pk_bf16_f32 v176, v28, v29
  v_cvt_pk_bf16_f32 v177, v30, v31
  v_cvt_pk_bf16_f32 v178, v32, v33
  v_cvt_pk_bf16_f32 v179, v34, v35
  v_pk_fma_f32 v[48:49], v[128:129], v[220:221], v[48:49] op_sel_hi:[1,0,1]
  v_pk_fma_f32 v[50:51], v[130:131], v[220:221], v[50:51] op_sel_hi:[1,0,1]
  v_pk_fma_f32 v[52:53], v[132:133], v[220:221], v[52:53] op_sel_hi:[1,0,1]
  v_pk_fma_f32 v[54:55], v[134:135], v[220:221], v[54:55] op_sel_hi:[1,0,1]
  v_pk_fma_f32 v[68:69], v[128:129], v[224:225], v[68:69] op_sel_hi:[1,0,1]
  v_pk_fma_f32 v[70:71], v[130:131], v[224:225], v[70:71] op_sel_hi:[1,0,1]
  buffer_store_dwordx4 v[176:179], v236, s[16:19], s80 offen offset:1024 sc1
  v_pk_fma_f32 v[72:73], v[132:133], v[224:225], v[72:73] op_sel_hi:[1,0,1]
  v_pk_fma_f32 v[74:75], v[134:135], v[224:225], v[74:75] op_sel_hi:[1,0,1]
  v_pk_mul_f32 v[148:149], v[48:49], v[222:223] op_sel_hi:[1,0]
  v_pk_mul_f32 v[150:151], v[50:51], v[222:223] op_sel_hi:[1,0]
  v_pk_mul_f32 v[152:153], v[52:53], v[222:223] op_sel_hi:[1,0]
  v_pk_mul_f32 v[154:155], v[54:55], v[222:223] op_sel_hi:[1,0]
  v_pk_mul_f32 v[156:157], v[68:69], v[226:227] op_sel_hi:[1,0]
  v_pk_mul_f32 v[158:159], v[70:71], v[226:227] op_sel_hi:[1,0]
  v_pk_mul_f32 v[160:161], v[72:73], v[226:227] op_sel_hi:[1,0]
  v_pk_mul_f32 v[162:163], v[74:75], v[226:227] op_sel_hi:[1,0]
  v_exp_f32_e64 v148, v148 clamp
  v_exp_f32_e64 v149, v149 clamp
  buffer_load_dwordx4 v4, s[16:19], s71 offen offset:1024 sc1 lds
  v_exp_f32_e64 v150, v150 clamp
  v_exp_f32_e64 v151, v151 clamp
  v_exp_f32_e64 v152, v152 clamp
  v_exp_f32_e64 v153, v153 clamp
  v_exp_f32_e64 v154, v154 clamp
  v_exp_f32_e64 v155, v155 clamp
  v_exp_f32_e64 v156, v156 clamp
  v_exp_f32_e64 v157, v157 clamp
  v_exp_f32_e64 v158, v158 clamp
  v_exp_f32_e64 v159, v159 clamp
  v_exp_f32_e64 v160, v160 clamp
  v_exp_f32_e64 v161, v161 clamp
  buffer_load_dwordx4 v4, s[16:19], s71 offen offset:2048 sc1 lds
  v_exp_f32_e64 v162, v162 clamp
  v_exp_f32_e64 v163, v163 clamp
  v_pk_fma_f32 v[48:49], v[48:49], v[220:221], 1.0 op_sel:[0,1,0] op_sel_hi:[1,1,0]
  v_pk_fma_f32 v[50:51], v[50:51], v[220:221], 1.0 op_sel:[0,1,0] op_sel_hi:[1,1,0]
  v_pk_fma_f32 v[52:53], v[52:53], v[220:221], 1.0 op_sel:[0,1,0] op_sel_hi:[1,1,0]
  v_pk_fma_f32 v[54:55], v[54:55], v[220:221], 1.0 op_sel:[0,1,0] op_sel_hi:[1,1,0]
  v_pk_fma_f32 v[68:69], v[68:69], v[224:225], 1.0 op_sel:[0,1,0] op_sel_hi:[1,1,0]
  v_pk_fma_f32 v[70:71], v[70:71], v[224:225], 1.0 op_sel:[0,1,0] op_sel_hi:[1,1,0]
  v_pk_fma_f32 v[72:73], v[72:73], v[224:225], 1.0 op_sel:[0,1,0] op_sel_hi:[1,1,0]
  v_pk_fma_f32 v[74:75], v[74:75], v[224:225], 1.0 op_sel:[0,1,0] op_sel_hi:[1,1,0]
  v_max_f32 v48, v48, v148
  v_max_f32 v49, v49, v149
  buffer_load_dwordx4 v4, s[16:19], s71 offen offset:3072 sc1 lds
  v_max_f32 v50, v50, v150
  v_max_f32 v51, v51, v151
  v_max_f32 v52, v52, v152
  v_max_f32 v53, v53, v153
  v_max_f32 v54, v54, v154
  v_max_f32 v55, v55, v155
  v_max_f32 v68, v68, v156
  v_max_f32 v69, v69, v157
  v_max_f32 v70, v70, v158
  v_max_f32 v71, v71, v159
  v_max_f32 v72, v72, v160
  v_max_f32 v73, v73, v161
  v_max_f32 v74, v74, v162
  v_max_f32 v75, v75, v163
  v_pk_add_f32 v[48:49], v[48:49], v[240:241]
  v_pk_add_f32 v[50:51], v[50:51], v[240:241]
  v_pk_add_f32 v[52:53], v[52:53], v[240:241]
  v_pk_add_f32 v[54:55], v[54:55], v[240:241]
  v_cvt_pk_bf16_f32 v184, v48, v49
  v_cvt_pk_bf16_f32 v185, v50, v51
  v_cvt_pk_bf16_f32 v186, v52, v53
  v_cvt_pk_bf16_f32 v187, v54, v55
  buffer_store_dwordx4 v[184:187], v236, s[16:19], s81 offen offset:0 sc1
  v_pk_add_f32 v[68:69], v[68:69], v[240:241]
  v_pk_add_f32 v[70:71], v[70:71], v[240:241]
  v_pk_add_f32 v[72:73], v[72:73], v[240:241]
  v_pk_add_f32 v[74:75], v[74:75], v[240:241]
  v_cvt_pk_bf16_f32 v188, v68, v69
  v_cvt_pk_bf16_f32 v189, v70, v71
  v_cvt_pk_bf16_f32 v190, v72, v73
  v_cvt_pk_bf16_f32 v191, v74, v75
  v_pk_fma_f32 v[88:89], v[128:129], v[228:229], v[88:89] op_sel_hi:[1,0,1]
  v_pk_fma_f32 v[90:91], v[130:131], v[228:229], v[90:91] op_sel_hi:[1,0,1]
  v_pk_fma_f32 v[92:93], v[132:133], v[228:229], v[92:93] op_sel_hi:[1,0,1]
  v_pk_fma_f32 v[94:95], v[134:135], v[228:229], v[94:95] op_sel_hi:[1,0,1]
  v_pk_fma_f32 v[108:109], v[128:129], v[232:233], v[108:109] op_sel_hi:[1,0,1]
  v_pk_fma_f32 v[110:111], v[130:131], v[232:233], v[110:111] op_sel_hi:[1,0,1]
  buffer_store_dwordx4 v[188:191], v236, s[16:19], s81 offen offset:1024 sc1
  v_pk_fma_f32 v[112:113], v[132:133], v[232:233], v[112:113] op_sel_hi:[1,0,1]
  v_pk_fma_f32 v[114:115], v[134:135], v[232:233], v[114:115] op_sel_hi:[1,0,1]
  v_pk_mul_f32 v[148:149], v[88:89], v[230:231] op_sel_hi:[1,0]
  v_pk_mul_f32 v[150:151], v[90:91], v[230:231] op_sel_hi:[1,0]
  v_pk_mul_f32 v[152:153], v[92:93], v[230:231] op_sel_hi:[1,0]
  v_pk_mul_f32 v[154:155], v[94:95], v[230:231] op_sel_hi:[1,0]
  v_pk_mul_f32 v[156:157], v[108:109], v[234:235] op_sel_hi:[1,0]
  v_pk_mul_f32 v[158:159], v[110:111], v[234:235] op_sel_hi:[1,0]
  v_pk_mul_f32 v[160:161], v[112:113], v[234:235] op_sel_hi:[1,0]
  v_pk_mul_f32 v[162:163], v[114:115], v[234:235] op_sel_hi:[1,0]
  v_exp_f32_e64 v148, v148 clamp
  v_exp_f32_e64 v149, v149 clamp
  s_add_u32 m0, s69, 4096
  s_add_u32 s71, s70, 0
  s_nop 0
  buffer_load_dwordx4 v5, s[16:19], s71 offen offset:0 sc1 lds
  v_exp_f32_e64 v150, v150 clamp
  v_exp_f32_e64 v151, v151 clamp
  v_exp_f32_e64 v152, v152 clamp
  v_exp_f32_e64 v153, v153 clamp
  v_exp_f32_e64 v154, v154 clamp
  v_exp_f32_e64 v155, v155 clamp
  v_exp_f32_e64 v156, v156 clamp
  v_exp_f32_e64 v157, v157 clamp
  v_exp_f32_e64 v158, v158 clamp
  v_exp_f32_e64 v159, v159 clamp
  v_exp_f32_e64 v160, v160 clamp
  v_exp_f32_e64 v161, v161 clamp
  s_add_u32 m0, s69, 20480
  s_add_u32 s71, s70, 65536
  buffer_load_dwordx4 v4, s[16:19], s71 offen offset:0 sc1 lds
  v_exp_f32_e64 v162, v162 clamp
  v_exp_f32_e64 v163, v163 clamp
  v_pk_fma_f32 v[88:89], v[88:89], v[228:229], 1.0 op_sel:[0,1,0] op_sel_hi:[1,1,0]
  v_pk_fma_f32 v[90:91], v[90:91], v[228:229], 1.0 op_sel:[0,1,0] op_sel_hi:[1,1,0]
  v_pk_fma_f32 v[92:93], v[92:93], v[228:229], 1.0 op_sel:[0,1,0] op_sel_hi:[1,1,0]
  v_pk_fma_f32 v[94:95], v[94:95], v[228:229], 1.0 op_sel:[0,1,0] op_sel_hi:[1,1,0]
  v_pk_fma_f32 v[108:109], v[108:109], v[232:233], 1.0 op_sel:[0,1,0] op_sel_hi:[1,1,0]
  v_pk_fma_f32 v[110:111], v[110:111], v[232:233], 1.0 op_sel:[0,1,0] op_sel_hi:[1,1,0]
  v_pk_fma_f32 v[112:113], v[112:113], v[232:233], 1.0 op_sel:[0,1,0] op_sel_hi:[1,1,0]
  v_pk_fma_f32 v[114:115], v[114:115], v[232:233], 1.0 op_sel:[0,1,0] op_sel_hi:[1,1,0]
  v_max_f32 v88, v88, v148
  v_max_f32 v89, v89, v149
  buffer_load_dwordx4 v4, s[16:19], s71 offen offset:1024 sc1 lds
  v_max_f32 v90, v90, v150
  v_max_f32 v91, v91, v151
  v_max_f32 v92, v92, v152
  v_max_f32 v93, v93, v153
  v_max_f32 v94, v94, v154
  v_max_f32 v95, v95, v155
  v_max_f32 v108, v108, v156
  v_max_f32 v109, v109, v157
  v_max_f32 v110, v110, v158
  v_max_f32 v111, v111, v159
  v_max_f32 v112, v112, v160
  v_max_f32 v113, v113, v161
  v_max_f32 v114, v114, v162
  v_max_f32 v115, v115, v163
  v_pk_add_f32 v[88:89], v[88:89], v[240:241]
  v_pk_add_f32 v[90:91], v[90:91], v[240:241]
  v_pk_add_f32 v[92:93], v[92:93], v[240:241]
  v_pk_add_f32 v[94:95], v[94:95], v[240:241]
  v_cvt_pk_bf16_f32 v172, v88, v89
  v_cvt_pk_bf16_f32 v173, v90, v91
  v_cvt_pk_bf16_f32 v174, v92, v93
  v_cvt_pk_bf16_f32 v175, v94, v95
  buffer_store_dwordx4 v[172:175], v236, s[16:19], s82 offen offset:0 sc1
  v_pk_add_f32 v[108:109], v[108:109], v[240:241]
  v_pk_add_f32 v[110:111], v[110:111], v[240:241]
  v_pk_add_f32 v[112:113], v[112:113], v[240:241]
  v_pk_add_f32 v[114:115], v[114:115], v[240:241]
  v_cvt_pk_bf16_f32 v176, v108, v109
  v_cvt_pk_bf16_f32 v177, v110, v111
  v_cvt_pk_bf16_f32 v178, v112, v113
  v_cvt_pk_bf16_f32 v179, v114, v115
  v_pk_fma_f32 v[16:17], v[136:137], v[212:213], v[16:17] op_sel_hi:[1,0,1]
  v_pk_fma_f32 v[18:19], v[138:139], v[212:213], v[18:19] op_sel_hi:[1,0,1]
  v_pk_fma_f32 v[20:21], v[140:141], v[212:213], v[20:21] op_sel_hi:[1,0,1]
  v_pk_fma_f32 v[22:23], v[142:143], v[212:213], v[22:23] op_sel_hi:[1,0,1]
  v_pk_fma_f32 v[36:37], v[136:137], v[216:217], v[36:37] op_sel_hi:[1,0,1]
  v_pk_fma_f32 v[38:39], v[138:139], v[216:217], v[38:39] op_sel_hi:[1,0,1]
  buffer_store_dwordx4 v[176:179], v236, s[16:19], s82 offen offset:1024 sc1
  v_pk_fma_f32 v[40:41], v[140:141], v[216:217], v[40:41] op_sel_hi:[1,0,1]
  v_pk_fma_f32 v[42:43], v[142:143], v[216:217], v[42:43] op_sel_hi:[1,0,1]
  v_pk_mul_f32 v[148:149], v[16:17], v[214:215] op_sel_hi:[1,0]
  v_pk_mul_f32 v[150:151], v[18:19], v[214:215] op_sel_hi:[1,0]
  v_pk_mul_f32 v[152:153], v[20:21], v[214:215] op_sel_hi:[1,0]
  v_pk_mul_f32 v[154:155], v[22:23], v[214:215] op_sel_hi:[1,0]
  v_pk_mul_f32 v[156:157], v[36:37], v[218:219] op_sel_hi:[1,0]
  v_pk_mul_f32 v[158:159], v[38:39], v[218:219] op_sel_hi:[1,0]
  v_pk_mul_f32 v[160:161], v[40:41], v[218:219] op_sel_hi:[1,0]
  v_pk_mul_f32 v[162:163], v[42:43], v[218:219] op_sel_hi:[1,0]
  v_exp_f32_e64 v148, v148 clamp
  v_exp_f32_e64 v149, v149 clamp
  buffer_load_dwordx4 v4, s[16:19], s71 offen offset:2048 sc1 lds
  v_exp_f32_e64 v150, v150 clamp
  v_exp_f32_e64 v151, v151 clamp
  v_exp_f32_e64 v152, v152 clamp
  v_exp_f32_e64 v153, v153 clamp
  v_exp_f32_e64 v154, v154 clamp
  v_exp_f32_e64 v155, v155 clamp
  v_exp_f32_e64 v156, v156 clamp
  v_exp_f32_e64 v157, v157 clamp
  v_exp_f32_e64 v158, v158 clamp
  v_exp_f32_e64 v159, v159 clamp
  v_exp_f32_e64 v160, v160 clamp
  v_exp_f32_e64 v161, v161 clamp
  buffer_load_dwordx4 v4, s[16:19], s71 offen offset:3072 sc1 lds
  v_exp_f32_e64 v162, v162 clamp
  v_exp_f32_e64 v163, v163 clamp
  v_pk_fma_f32 v[16:17], v[16:17], v[212:213], 1.0 op_sel:[0,1,0] op_sel_hi:[1,1,0]
  v_pk_fma_f32 v[18:19], v[18:19], v[212:213], 1.0 op_sel:[0,1,0] op_sel_hi:[1,1,0]
  v_pk_fma_f32 v[20:21], v[20:21], v[212:213], 1.0 op_sel:[0,1,0] op_sel_hi:[1,1,0]
  v_pk_fma_f32 v[22:23], v[22:23], v[212:213], 1.0 op_sel:[0,1,0] op_sel_hi:[1,1,0]
  v_pk_fma_f32 v[36:37], v[36:37], v[216:217], 1.0 op_sel:[0,1,0] op_sel_hi:[1,1,0]
  v_pk_fma_f32 v[38:39], v[38:39], v[216:217], 1.0 op_sel:[0,1,0] op_sel_hi:[1,1,0]
  v_pk_fma_f32 v[40:41], v[40:41], v[216:217], 1.0 op_sel:[0,1,0] op_sel_hi:[1,1,0]
  v_pk_fma_f32 v[42:43], v[42:43], v[216:217], 1.0 op_sel:[0,1,0] op_sel_hi:[1,1,0]
  v_max_f32 v16, v16, v148
  v_max_f32 v17, v17, v149
  s_add_u32 m0, s69, 24576
  s_add_u32 s71, s70, 65536
  buffer_load_dwordx4 v5, s[16:19], s71 offen offset:0 sc1 lds
  v_max_f32 v18, v18, v150
  v_max_f32 v19, v19, v151
  v_max_f32 v20, v20, v152
  v_max_f32 v21, v21, v153
  v_max_f32 v22, v22, v154
  v_max_f32 v23, v23, v155
  v_max_f32 v36, v36, v156
  v_max_f32 v37, v37, v157
  v_max_f32 v38, v38, v158
  v_max_f32 v39, v39, v159
  v_max_f32 v40, v40, v160
  v_max_f32 v41, v41, v161
  v_max_f32 v42, v42, v162
  v_max_f32 v43, v43, v163
  v_pk_add_f32 v[16:17], v[16:17], v[240:241]
  v_pk_add_f32 v[18:19], v[18:19], v[240:241]
  v_pk_add_f32 v[20:21], v[20:21], v[240:241]
  v_pk_add_f32 v[22:23], v[22:23], v[240:241]
  v_cvt_pk_bf16_f32 v184, v16, v17
  v_cvt_pk_bf16_f32 v185, v18, v19
  v_cvt_pk_bf16_f32 v186, v20, v21
  v_cvt_pk_bf16_f32 v187, v22, v23
  buffer_store_dwordx4 v[184:187], v237, s[16:19], s80 offen offset:0 sc1
  v_pk_add_f32 v[36:37], v[36:37], v[240:241]
  v_pk_add_f32 v[38:39], v[38:39], v[240:241]
  v_pk_add_f32 v[40:41], v[40:41], v[240:241]
  v_pk_add_f32 v[42:43], v[42:43], v[240:241]
  v_cvt_pk_bf16_f32 v188, v36, v37
  v_cvt_pk_bf16_f32 v189, v38, v39
  v_cvt_pk_bf16_f32 v190, v40, v41
  v_cvt_pk_bf16_f32 v191, v42, v43
  v_pk_fma_f32 v[56:57], v[136:137], v[220:221], v[56:57] op_sel_hi:[1,0,1]
  v_pk_fma_f32 v[58:59], v[138:139], v[220:221], v[58:59] op_sel_hi:[1,0,1]
  v_pk_fma_f32 v[60:61], v[140:141], v[220:221], v[60:61] op_sel_hi:[1,0,1]
  v_pk_fma_f32 v[62:63], v[142:143], v[220:221], v[62:63] op_sel_hi:[1,0,1]
  v_pk_fma_f32 v[76:77], v[136:137], v[224:225], v[76:77] op_sel_hi:[1,0,1]
  v_pk_fma_f32 v[78:79], v[138:139], v[224:225], v[78:79] op_sel_hi:[1,0,1]
  buffer_store_dwordx4 v[188:191], v237, s[16:19], s80 offen offset:1024 sc1
  v_pk_fma_f32 v[80:81], v[140:141], v[224:225], v[80:81] op_sel_hi:[1,0,1]
  v_pk_fma_f32 v[82:83], v[142:143], v[224:225], v[82:83] op_sel_hi:[1,0,1]
  v_pk_mul_f32 v[148:149], v[56:57], v[222:223] op_sel_hi:[1,0]
  v_pk_mul_f32 v[150:151], v[58:59], v[222:223] op_sel_hi:[1,0]
  v_pk_mul_f32 v[152:153], v[60:61], v[222:223] op_sel_hi:[1,0]
  v_pk_mul_f32 v[154:155], v[62:63], v[222:223] op_sel_hi:[1,0]
  v_pk_mul_f32 v[156:157], v[76:77], v[226:227] op_sel_hi:[1,0]
  v_pk_mul_f32 v[158:159], v[78:79], v[226:227] op_sel_hi:[1,0]
  v_pk_mul_f32 v[160:161], v[80:81], v[226:227] op_sel_hi:[1,0]
  v_pk_mul_f32 v[162:163], v[82:83], v[226:227] op_sel_hi:[1,0]
  v_exp_f32_e64 v148, v148 clamp
  v_exp_f32_e64 v149, v149 clamp
  s_add_u32 m0, s69, 40960
  s_add_u32 s71, s70, 131072
  buffer_load_dwordx4 v4, s[16:19], s71 offen offset:0 sc1 lds
  v_exp_f32_e64 v150, v150 clamp
  v_exp_f32_e64 v151, v151 clamp
  v_exp_f32_e64 v152, v152 clamp
  v_exp_f32_e64 v153, v153 clamp
  v_exp_f32_e64 v154, v154 clamp
  v_exp_f32_e64 v155, v155 clamp
  v_exp_f32_e64 v156, v156 clamp
  v_exp_f32_e64 v157, v157 clamp
  v_exp_f32_e64 v158, v158 clamp
  v_exp_f32_e64 v159, v159 clamp
  v_exp_f32_e64 v160, v160 clamp
  v_exp_f32_e64 v161, v161 clamp
  buffer_load_dwordx4 v4, s[16:19], s71 offen offset:1024 sc1 lds
  v_exp_f32_e64 v162, v162 clamp
  v_exp_f32_e64 v163, v163 clamp
  v_pk_fma_f32 v[56:57], v[56:57], v[220:221], 1.0 op_sel:[0,1,0] op_sel_hi:[1,1,0]
  v_pk_fma_f32 v[58:59], v[58:59], v[220:221], 1.0 op_sel:[0,1,0] op_sel_hi:[1,1,0]
  v_pk_fma_f32 v[60:61], v[60:61], v[220:221], 1.0 op_sel:[0,1,0] op_sel_hi:[1,1,0]
  v_pk_fma_f32 v[62:63], v[62:63], v[220:221], 1.0 op_sel:[0,1,0] op_sel_hi:[1,1,0]
  v_pk_fma_f32 v[76:77], v[76:77], v[224:225], 1.0 op_sel:[0,1,0] op_sel_hi:[1,1,0]
  v_pk_fma_f32 v[78:79], v[78:79], v[224:225], 1.0 op_sel:[0,1,0] op_sel_hi:[1,1,0]
  v_pk_fma_f32 v[80:81], v[80:81], v[224:225], 1.0 op_sel:[0,1,0] op_sel_hi:[1,1,0]
  v_pk_fma_f32 v[82:83], v[82:83], v[224:225], 1.0 op_sel:[0,1,0] op_sel_hi:[1,1,0]
  v_max_f32 v56, v56, v148
  v_max_f32 v57, v57, v149
  s_waitcnt vmcnt(7)
  s_barrier
  v_mov_b32 v3, s39
  v_lshlrev_b32 v6, 25, v7
  buffer_store_dword v3, v6, s[16:19], s75 offen sc1
  v_max_f32 v58, v58, v150
  v_max_f32 v59, v59, v151
  v_max_f32 v60, v60, v152
  v_max_f32 v61, v61, v153
  v_max_f32 v62, v62, v154
  v_max_f32 v63, v63, v155
  v_max_f32 v76, v76, v156
  v_max_f32 v77, v77, v157
  v_max_f32 v78, v78, v158
  v_max_f32 v79, v79, v159
  v_max_f32 v80, v80, v160
  v_max_f32 v81, v81, v161
  v_max_f32 v82, v82, v162
  v_max_f32 v83, v83, v163
  v_pk_add_f32 v[56:57], v[56:57], v[240:241]
  v_pk_add_f32 v[58:59], v[58:59], v[240:241]
  v_pk_add_f32 v[60:61], v[60:61], v[240:241]
  v_pk_add_f32 v[62:63], v[62:63], v[240:241]
  v_cvt_pk_bf16_f32 v172, v56, v57
  v_cvt_pk_bf16_f32 v173, v58, v59
  v_cvt_pk_bf16_f32 v174, v60, v61
  v_cvt_pk_bf16_f32 v175, v62, v63
  buffer_store_dwordx4 v[172:175], v237, s[16:19], s81 offen offset:0 sc1
  v_pk_add_f32 v[76:77], v[76:77], v[240:241]
  v_pk_add_f32 v[78:79], v[78:79], v[240:241]
  v_pk_add_f32 v[80:81], v[80:81], v[240:241]
  v_pk_add_f32 v[82:83], v[82:83], v[240:241]
  v_cvt_pk_bf16_f32 v176, v76, v77
  v_cvt_pk_bf16_f32 v177, v78, v79
  v_cvt_pk_bf16_f32 v178, v80, v81
  v_cvt_pk_bf16_f32 v179, v82, v83
  v_pk_fma_f32 v[96:97], v[136:137], v[228:229], v[96:97] op_sel_hi:[1,0,1]
  v_pk_fma_f32 v[98:99], v[138:139], v[228:229], v[98:99] op_sel_hi:[1,0,1]
  v_pk_fma_f32 v[100:101], v[140:141], v[228:229], v[100:101] op_sel_hi:[1,0,1]
  v_pk_fma_f32 v[102:103], v[142:143], v[228:229], v[102:103] op_sel_hi:[1,0,1]
  v_pk_fma_f32 v[116:117], v[136:137], v[232:233], v[116:117] op_sel_hi:[1,0,1]
  v_pk_fma_f32 v[118:119], v[138:139], v[232:233], v[118:119] op_sel_hi:[1,0,1]
  buffer_store_dwordx4 v[176:179], v237, s[16:19], s81 offen offset:1024 sc1
  v_pk_fma_f32 v[120:121], v[140:141], v[232:233], v[120:121] op_sel_hi:[1,0,1]
  v_pk_fma_f32 v[122:123], v[142:143], v[232:233], v[122:123] op_sel_hi:[1,0,1]
  v_pk_mul_f32 v[148:149], v[96:97], v[230:231] op_sel_hi:[1,0]
  v_pk_mul_f32 v[150:151], v[98:99], v[230:231] op_sel_hi:[1,0]
  v_pk_mul_f32 v[152:153], v[100:101], v[230:231] op_sel_hi:[1,0]
  v_pk_mul_f32 v[154:155], v[102:103], v[230:231] op_sel_hi:[1,0]
  v_pk_mul_f32 v[156:157], v[116:117], v[234:235] op_sel_hi:[1,0]
  v_pk_mul_f32 v[158:159], v[118:119], v[234:235] op_sel_hi:[1,0]
  v_pk_mul_f32 v[160:161], v[120:121], v[234:235] op_sel_hi:[1,0]
  v_pk_mul_f32 v[162:163], v[122:123], v[234:235] op_sel_hi:[1,0]
  v_exp_f32_e64 v148, v148 clamp
  v_exp_f32_e64 v149, v149 clamp
  buffer_load_dwordx4 v4, s[16:19], s71 offen offset:2048 sc1 lds
  v_exp_f32_e64 v150, v150 clamp
  v_exp_f32_e64 v151, v151 clamp
  v_exp_f32_e64 v152, v152 clamp
  v_exp_f32_e64 v153, v153 clamp
  v_exp_f32_e64 v154, v154 clamp
  v_exp_f32_e64 v155, v155 clamp
  v_exp_f32_e64 v156, v156 clamp
  v_exp_f32_e64 v157, v157 clamp
  v_exp_f32_e64 v158, v158 clamp
  v_exp_f32_e64 v159, v159 clamp
  v_exp_f32_e64 v160, v160 clamp
  v_exp_f32_e64 v161, v161 clamp
  buffer_load_dwordx4 v4, s[16:19], s71 offen offset:3072 sc1 lds
  v_exp_f32_e64 v162, v162 clamp
  v_exp_f32_e64 v163, v163 clamp
  v_pk_fma_f32 v[96:97], v[96:97], v[228:229], 1.0 op_sel:[0,1,0] op_sel_hi:[1,1,0]
  v_pk_fma_f32 v[98:99], v[98:99], v[228:229], 1.0 op_sel:[0,1,0] op_sel_hi:[1,1,0]
  v_pk_fma_f32 v[100:101], v[100:101], v[228:229], 1.0 op_sel:[0,1,0] op_sel_hi:[1,1,0]
  v_pk_fma_f32 v[102:103], v[102:103], v[228:229], 1.0 op_sel:[0,1,0] op_sel_hi:[1,1,0]
  v_pk_fma_f32 v[116:117], v[116:117], v[232:233], 1.0 op_sel:[0,1,0] op_sel_hi:[1,1,0]
  v_pk_fma_f32 v[118:119], v[118:119], v[232:233], 1.0 op_sel:[0,1,0] op_sel_hi:[1,1,0]
  v_pk_fma_f32 v[120:121], v[120:121], v[232:233], 1.0 op_sel:[0,1,0] op_sel_hi:[1,1,0]
  v_pk_fma_f32 v[122:123], v[122:123], v[232:233], 1.0 op_sel:[0,1,0] op_sel_hi:[1,1,0]
  v_max_f32 v96, v96, v148
  v_max_f32 v97, v97, v149
  s_add_u32 m0, s69, 45056
  s_add_u32 s71, s70, 131072
  buffer_load_dwordx4 v5, s[16:19], s71 offen offset:0 sc1 lds
  v_max_f32 v98, v98, v150
  v_max_f32 v99, v99, v151
  v_max_f32 v100, v100, v152
  v_max_f32 v101, v101, v153
  v_max_f32 v102, v102, v154
  v_max_f32 v103, v103, v155
  v_max_f32 v116, v116, v156
  v_max_f32 v117, v117, v157
  v_max_f32 v118, v118, v158
  v_max_f32 v119, v119, v159
  v_max_f32 v120, v120, v160
  v_max_f32 v121, v121, v161
  v_max_f32 v122, v122, v162
  v_max_f32 v123, v123, v163
  v_pk_add_f32 v[96:97], v[96:97], v[240:241]
  v_pk_add_f32 v[98:99], v[98:99], v[240:241]
  v_pk_add_f32 v[100:101], v[100:101], v[240:241]
  v_pk_add_f32 v[102:103], v[102:103], v[240:241]
  v_cvt_pk_bf16_f32 v184, v96, v97
  v_cvt_pk_bf16_f32 v185, v98, v99
  v_cvt_pk_bf16_f32 v186, v100, v101
  v_cvt_pk_bf16_f32 v187, v102, v103
  buffer_store_dwordx4 v[184:187], v237, s[16:19], s82 offen offset:0 sc1
  v_pk_add_f32 v[116:117], v[116:117], v[240:241]
  v_pk_add_f32 v[118:119], v[118:119], v[240:241]
  v_pk_add_f32 v[120:121], v[120:121], v[240:241]
  v_pk_add_f32 v[122:123], v[122:123], v[240:241]
  v_cvt_pk_bf16_f32 v188, v116, v117
  v_cvt_pk_bf16_f32 v189, v118, v119
  v_cvt_pk_bf16_f32 v190, v120, v121
  v_cvt_pk_bf16_f32 v191, v122, v123
  v_pk_fma_f32 v[24:25], v[144:145], v[212:213], v[24:25] op_sel_hi:[1,0,1]
  v_pk_fma_f32 v[26:27], v[146:147], v[212:213], v[26:27] op_sel_hi:[1,0,1]
  v_pk_fma_f32 v[44:45], v[144:145], v[216:217], v[44:45] op_sel_hi:[1,0,1]
  v_pk_fma_f32 v[46:47], v[146:147], v[216:217], v[46:47] op_sel_hi:[1,0,1]
  v_pk_fma_f32 v[64:65], v[144:145], v[220:221], v[64:65] op_sel_hi:[1,0,1]
  v_pk_fma_f32 v[66:67], v[146:147], v[220:221], v[66:67] op_sel_hi:[1,0,1]
  buffer_store_dwordx4 v[188:191], v237, s[16:19], s82 offen offset:1024 sc1
  v_pk_fma_f32 v[84:85], v[144:145], v[224:225], v[84:85] op_sel_hi:[1,0,1]
  v_pk_fma_f32 v[86:87], v[146:147], v[224:225], v[86:87] op_sel_hi:[1,0,1]
  v_pk_fma_f32 v[104:105], v[144:145], v[228:229], v[104:105] op_sel_hi:[1,0,1]
  v_pk_fma_f32 v[106:107], v[146:147], v[228:229], v[106:107] op_sel_hi:[1,0,1]
  v_pk_fma_f32 v[124:125], v[144:145], v[232:233], v[124:125] op_sel_hi:[1,0,1]
  v_pk_fma_f32 v[126:127], v[146:147], v[232:233], v[126:127] op_sel_hi:[1,0,1]
  v_pk_mul_f32 v[148:149], v[24:25], v[214:215] op_sel_hi:[1,0]
  v_pk_mul_f32 v[150:151], v[26:27], v[214:215] op_sel_hi:[1,0]
  v_pk_mul_f32 v[152:153], v[44:45], v[218:219] op_sel_hi:[1,0]
  v_pk_mul_f32 v[154:155], v[46:47], v[218:219] op_sel_hi:[1,0]
  v_pk_mul_f32 v[156:157], v[64:65], v[222:223] op_sel_hi:[1,0]
  v_pk_mul_f32 v[158:159], v[66:67], v[222:223] op_sel_hi:[1,0]
  v_pk_mul_f32 v[160:161], v[84:85], v[226:227] op_sel_hi:[1,0]
  v_pk_mul_f32 v[162:163], v[86:87], v[226:227] op_sel_hi:[1,0]
  v_pk_mul_f32 v[164:165], v[104:105], v[230:231] op_sel_hi:[1,0]
  v_pk_mul_f32 v[166:167], v[106:107], v[230:231] op_sel_hi:[1,0]
  v_pk_mul_f32 v[168:169], v[124:125], v[234:235] op_sel_hi:[1,0]
  v_pk_mul_f32 v[170:171], v[126:127], v[234:235] op_sel_hi:[1,0]
  v_exp_f32_e64 v148, v148 clamp
  v_exp_f32_e64 v149, v149 clamp
  v_exp_f32_e64 v150, v150 clamp
  v_exp_f32_e64 v151, v151 clamp
  v_exp_f32_e64 v152, v152 clamp
  v_exp_f32_e64 v153, v153 clamp
  v_exp_f32_e64 v154, v154 clamp
  v_exp_f32_e64 v155, v155 clamp
  s_add_u32 m0, s69, 61440
  s_add_u32 s71, s70, 196608
  buffer_load_dwordx4 v4, s[16:19], s71 offen offset:0 sc1 lds
  v_exp_f32_e64 v156, v156 clamp
  v_exp_f32_e64 v157, v157 clamp
  v_exp_f32_e64 v158, v158 clamp
  v_exp_f32_e64 v159, v159 clamp
  v_exp_f32_e64 v160, v160 clamp
  v_exp_f32_e64 v161, v161 clamp
  v_exp_f32_e64 v162, v162 clamp
  v_exp_f32_e64 v163, v163 clamp
  v_exp_f32_e64 v164, v164 clamp
  v_exp_f32_e64 v165, v165 clamp
  v_exp_f32_e64 v166, v166 clamp
  v_exp_f32_e64 v167, v167 clamp
  v_exp_f32_e64 v168, v168 clamp
  v_exp_f32_e64 v169, v169 clamp
  v_exp_f32_e64 v170, v170 clamp
  v_exp_f32_e64 v171, v171 clamp
  v_pk_fma_f32 v[24:25], v[24:25], v[212:213], 1.0 op_sel:[0,1,0] op_sel_hi:[1,1,0]
  v_pk_fma_f32 v[26:27], v[26:27], v[212:213], 1.0 op_sel:[0,1,0] op_sel_hi:[1,1,0]
  v_pk_fma_f32 v[44:45], v[44:45], v[216:217], 1.0 op_sel:[0,1,0] op_sel_hi:[1,1,0]
  v_pk_fma_f32 v[46:47], v[46:47], v[216:217], 1.0 op_sel:[0,1,0] op_sel_hi:[1,1,0]
  v_pk_fma_f32 v[64:65], v[64:65], v[220:221], 1.0 op_sel:[0,1,0] op_sel_hi:[1,1,0]
  v_pk_fma_f32 v[66:67], v[66:67], v[220:221], 1.0 op_sel:[0,1,0] op_sel_hi:[1,1,0]
  v_pk_fma_f32 v[84:85], v[84:85], v[224:225], 1.0 op_sel:[0,1,0] op_sel_hi:[1,1,0]
  v_pk_fma_f32 v[86:87], v[86:87], v[224:225], 1.0 op_sel:[0,1,0] op_sel_hi:[1,1,0]
  v_pk_fma_f32 v[104:105], v[104:105], v[228:229], 1.0 op_sel:[0,1,0] op_sel_hi:[1,1,0]
  v_pk_fma_f32 v[106:107], v[106:107], v[228:229], 1.0 op_sel:[0,1,0] op_sel_hi:[1,1,0]
  buffer_load_dwordx4 v4, s[16:19], s71 offen offset:1024 sc1 lds
  v_pk_fma_f32 v[124:125], v[124:125], v[232:233], 1.0 op_sel:[0,1,0] op_sel_hi:[1,1,0]
  v_pk_fma_f32 v[126:127], v[126:127], v[232:233], 1.0 op_sel:[0,1,0] op_sel_hi:[1,1,0]
  v_max_f32 v24, v24, v148
  v_max_f32 v25, v25, v149
  v_max_f32 v26, v26, v150
  v_max_f32 v27, v27, v151
  v_max_f32 v44, v44, v152
  v_max_f32 v45, v45, v153
  v_max_f32 v46, v46, v154
  v_max_f32 v47, v47, v155
  v_max_f32 v64, v64, v156
  v_max_f32 v65, v65, v157
  v_max_f32 v66, v66, v158
  v_max_f32 v67, v67, v159
  v_max_f32 v84, v84, v160
  v_max_f32 v85, v85, v161
  v_max_f32 v86, v86, v162
  v_max_f32 v87, v87, v163
  v_max_f32 v104, v104, v164
  v_max_f32 v105, v105, v165
  v_max_f32 v106, v106, v166
  v_max_f32 v107, v107, v167
  v_max_f32 v124, v124, v168
  v_max_f32 v125, v125, v169
  v_max_f32 v126, v126, v170
  v_max_f32 v127, v127, v171
  v_pk_add_f32 v[24:25], v[24:25], v[240:241]
  v_pk_add_f32 v[26:27], v[26:27], v[240:241]
  v_pk_add_f32 v[44:45], v[44:45], v[240:241]
  v_pk_add_f32 v[46:47], v[46:47], v[240:241]
  v_cvt_pk_bf16_f32 v172, v24, v25
  v_cvt_pk_bf16_f32 v173, v26, v27
  v_cvt_pk_bf16_f32 v174, v44, v45
  v_cvt_pk_bf16_f32 v175, v46, v47
  s_nop 0
  v_permlane16_swap_b32 v172, v174
  v_permlane16_swap_b32 v173, v175
  s_nop 0
  buffer_store_dwordx4 v[172:175], v238, s[16:19], s80 offen sc1
  v_pk_add_f32 v[64:65], v[64:65], v[240:241]
  v_pk_add_f32 v[66:67], v[66:67], v[240:241]
  v_pk_add_f32 v[84:85], v[84:85], v[240:241]
  v_pk_add_f32 v[86:87], v[86:87], v[240:241]
  v_cvt_pk_bf16_f32 v176, v64, v65
  v_cvt_pk_bf16_f32 v177, v66, v67
  v_cvt_pk_bf16_f32 v178, v84, v85
  v_cvt_pk_bf16_f32 v179, v86, v87
  s_nop 0
  v_permlane16_swap_b32 v176, v178
  v_permlane16_swap_b32 v177, v179
  s_nop 0
  buffer_store_dwordx4 v[176:179], v238, s[16:19], s81 offen sc1
  v_pk_add_f32 v[104:105], v[104:105], v[240:241]
  v_pk_add_f32 v[106:107], v[106:107], v[240:241]
  v_pk_add_f32 v[124:125], v[124:125], v[240:241]
  v_pk_add_f32 v[126:127], v[126:127], v[240:241]
  v_cvt_pk_bf16_f32 v180, v104, v105
  v_cvt_pk_bf16_f32 v181, v106, v107
  v_cvt_pk_bf16_f32 v182, v124, v125
  v_cvt_pk_bf16_f32 v183, v126, v127
  s_nop 0
  v_permlane16_swap_b32 v180, v182
  v_permlane16_swap_b32 v181, v183
  s_nop 0
  buffer_store_dwordx4 v[180:183], v238, s[16:19], s82 offen sc1
  s_branch k_p2
k_kv:
  s_waitcnt vmcnt(12)
  s_barrier
  ds_read_b64_tr_b16 v[196:197], v249 offset:0
  ds_read_b64_tr_b16 v[198:199], v249 offset:1280
  ds_read_b64_tr_b16 v[216:217], v249 offset:10240
  ds_read_b64_tr_b16 v[218:219], v249 offset:11520
  ds_read_b64_tr_b16 v[200:201], v250 offset:0
  ds_read_b64_tr_b16 v[202:203], v250 offset:1280
  ds_read_b64_tr_b16 v[220:221], v250 offset:10240
  ds_read_b64_tr_b16 v[222:223], v250 offset:11520
  ds_read_b64_tr_b16 v[204:205], v249 offset:64
  ds_read_b64_tr_b16 v[206:207], v249 offset:1344
  ds_read_b64_tr_b16 v[224:225], v249 offset:10304
  ds_read_b64_tr_b16 v[226:227], v249 offset:11584
  ds_read_b64_tr_b16 v[208:209], v250 offset:64
  ds_read_b64_tr_b16 v[210:211], v250 offset:1344
  ds_read_b64_tr_b16 v[228:229], v250 offset:10304
  ds_read_b64_tr_b16 v[230:231], v250 offset:11584
  ds_read_b64_tr_b16 v[212:213], v251 offset:0
  ds_read_b64_tr_b16 v[214:215], v251 offset:1280
  ds_read_b64_tr_b16 v[232:233], v251 offset:10240
  ds_read_b64_tr_b16 v[234:235], v251 offset:11520
  ds_read_b128 v[148:151], v247 offset:0
  ds_read_b128 v[172:175], v248 offset:0
  s_waitcnt lgkmcnt(2)
  v_mfma_f32_16x16x32_bf16 v[128:131], a[240:243], v[196:199], 0
  ds_read_b128 v[152:155], v247 offset:2048
  s_add_u32 m0, s40, 90112
  v_mfma_f32_16x16x32_bf16 v[128:131], a[240:243], v[216:219], v[128:131]
  v_mfma_f32_16x16x32_bf16 v[132:135], a[240:243], v[200:203], 0
  ds_read_b128 v[176:179], v248 offset:2048
  buffer_load_dwordx4 v236, s[8:11], s42 offen offset:0 lds
  v_mfma_f32_16x16x32_bf16 v[132:135], a[240:243], v[220:223], v[132:135]
  v_mfma_f32_16x16x32_bf16 v[136:139], a[240:243], v[204:207], 0
  ds_read_b128 v[156:159], v247 offset:4096
  v_mfma_f32_16x16x32_bf16 v[136:139], a[240:243], v[224:227], v[136:139]
  buffer_load_dwordx4 v237, s[8:11], s42 offen offset:1024 lds
  v_mfma_f32_16x16x32_bf16 v[140:143], a[240:243], v[208:211], 0
  v_mfma_f32_16x16x32_bf16 v[140:143], a[240:243], v[228:231], v[140:143]
  ds_read_b128 v[180:183], v248 offset:4096
  buffer_load_dwordx4 v238, s[8:11], s42 offen offset:2048 lds
  v_mfma_f32_16x16x32_bf16 v[144:147], a[240:243], v[212:215], 0
  v_mfma_f32_16x16x32_bf16 v[144:147], a[240:243], v[232:235], v[144:147]
  ds_read_b128 v[160:163], v247 offset:6144
  s_waitcnt lgkmcnt(5)
  v_mfma_f32_16x16x32_bf16 v[8:11], v[148:151], v[196:199], 0
  buffer_load_dwordx4 v239, s[8:11], s42 offen offset:3072 lds
  v_mfma_f32_16x16x32_bf16 v[8:11], v[172:175], v[216:219], v[8:11]
  v_mfma_f32_16x16x32_bf16 v[12:15], v[172:175], v[220:223], 0
  ds_read_b128 v[184:187], v248 offset:6144
  v_mfma_f32_16x16x32_bf16 v[12:15], v[148:151], v[200:203], v[12:15]
  s_add_u32 m0, s40, 94208
  v_mfma_f32_16x16x32_bf16 v[16:19], v[148:151], v[204:207], 0
  ds_read_b128 v[164:167], v247 offset:8192
  v_mfma_f32_16x16x32_bf16 v[16:19], v[172:175], v[224:227], v[16:19]
  buffer_load_dwordx4 v240, s[8:11], s42 offen offset:0 lds
  v_mfma_f32_16x16x32_bf16 v[20:23], v[172:175], v[228:231], 0
  ds_read_b128 v[188:191], v248 offset:8192
  v_mfma_f32_16x16x32_bf16 v[20:23], v[148:151], v[208:211], v[20:23]
  v_mfma_f32_16x16x32_bf16 v[24:27], v[148:151], v[212:215], 0
  buffer_load_dwordx4 v241, s[8:11], s42 offen offset:1024 lds
  v_mfma_f32_16x16x32_bf16 v[24:27], v[172:175], v[232:235], v[24:27]
  ds_read_b128 v[168:171], v247 offset:10240
  s_waitcnt lgkmcnt(7)
  v_mfma_f32_16x16x32_bf16 v[44:47], v[176:179], v[232:235], 0
  s_add_u32 m0, s41, 90112
  v_mfma_f32_16x16x32_bf16 v[44:47], v[152:155], v[212:215], v[44:47]
  ds_read_b128 v[192:195], v248 offset:10240
  v_mfma_f32_16x16x32_bf16 v[40:43], v[152:155], v[208:211], 0
  v_mfma_f32_16x16x32_bf16 v[40:43], v[176:179], v[228:231], v[40:43]
  buffer_load_dwordx4 v242, s[12:15], s43 offen offset:0 lds
  v_mfma_f32_16x16x32_bf16 v[36:39], v[176:179], v[224:227], 0
  v_cmp_le_u32 vcc, 16, v7
  v_mfma_f32_16x16x32_bf16 v[36:39], v[152:155], v[204:207], v[36:39]
  v_cmp_le_u32 s[28:29], 32, v7
  v_mfma_f32_16x16x32_bf16 v[32:35], v[152:155], v[200:203], 0
  buffer_load_dwordx4 v243, s[12:15], s43 offen offset:1024 lds
  v_cmp_le_u32 s[30:31], 48, v7
  v_mfma_f32_16x16x32_bf16 v[32:35], v[176:179], v[220:223], v[32:35]
  v_cndmask_b32 v145, v128, v132, vcc
  v_mfma_f32_16x16x32_bf16 v[28:31], v[176:179], v[216:219], 0
  buffer_load_dwordx4 v244, s[12:15], s43 offen offset:2048 lds
  v_cndmask_b32 v145, v145, v136, s[28:29]
  v_mfma_f32_16x16x32_bf16 v[28:31], v[152:155], v[196:199], v[28:31]
  s_waitcnt lgkmcnt(6)
  v_cndmask_b32 v145, v145, v140, s[30:31]
  v_mfma_f32_16x16x32_bf16 v[48:51], v[156:159], v[196:199], 0
  buffer_store_dword v145, v253, s[16:19], s64 offen sc1
  v_mfma_f32_16x16x32_bf16 v[48:51], v[180:183], v[216:219], v[48:51]
  buffer_load_dwordx4 v245, s[12:15], s43 offen offset:3072 lds
  v_mfma_f32_16x16x32_bf16 v[52:55], v[180:183], v[220:223], 0
  buffer_store_dword v144, v254, s[16:19], s64 offen sc1
  v_mfma_f32_16x16x32_bf16 v[52:55], v[156:159], v[200:203], v[52:55]
  s_add_u32 m0, s41, 94208
  v_add_u32 v128, 90112, v247
  v_mfma_f32_16x16x32_bf16 v[56:59], v[156:159], v[204:207], 0
  v_add_u32 v129, 90112, v248
  v_mfma_f32_16x16x32_bf16 v[56:59], v[180:183], v[224:227], v[56:59]
  v_add_u32 v130, 90112, v249
  v_mfma_f32_16x16x32_bf16 v[60:63], v[180:183], v[228:231], 0
  buffer_load_dwordx4 v246, s[12:15], s43 offen offset:0 lds
  v_add_u32 v131, 90112, v250
  v_mfma_f32_16x16x32_bf16 v[60:63], v[156:159], v[208:211], v[60:63]
  v_add_u32 v132, 90112, v251
  v_mfma_f32_16x16x32_bf16 v[64:67], v[156:159], v[212:215], 0
  v_mfma_f32_16x16x32_bf16 v[64:67], v[180:183], v[232:235], v[64:67]
  s_cmp_le_u32 s54, 2
  s_cselect_b32 s44, 3, 2
  s_lshl_b32 s42, s44, 7
  s_mul_i32 s43, s44, s45
  s_waitcnt lgkmcnt(0)
  v_mfma_f32_16x16x32_bf16 v[84:87], v[160:163], v[212:215], 0
  v_mfma_f32_16x16x32_bf16 v[84:87], v[184:187], v[232:235], v[84:87]
  s_waitcnt vmcnt(14)
  s_barrier
  v_mfma_f32_16x16x32_bf16 v[80:83], v[184:187], v[228:231], 0
  ds_read_b128 v[148:151], v247 offset:45056
  v_mfma_f32_16x16x32_bf16 v[80:83], v[160:163], v[208:211], v[80:83]
  ds_read_b128 v[172:175], v248 offset:45056
  v_mfma_f32_16x16x32_bf16 v[76:79], v[160:163], v[204:207], 0
  ds_read_b64_tr_b16 a[140:141], v249 offset:45056
  v_mfma_f32_16x16x32_bf16 v[76:79], v[184:187], v[224:227], v[76:79]
  ds_read_b64_tr_b16 a[142:143], v249 offset:46336
  s_add_u32 m0, s40, 0
  v_mfma_f32_16x16x32_bf16 v[72:75], v[184:187], v[220:223], 0
  ds_read_b64_tr_b16 a[160:161], v249 offset:55296
  buffer_load_dwordx4 v236, s[8:11], s42 offen offset:0 lds
  v_mfma_f32_16x16x32_bf16 v[72:75], v[160:163], v[200:203], v[72:75]
  ds_read_b64_tr_b16 a[162:163], v249 offset:56576
  v_mfma_f32_16x16x32_bf16 v[68:71], v[160:163], v[196:199], 0
  ds_read_b64_tr_b16 a[144:145], v250 offset:45056
  v_mfma_f32_16x16x32_bf16 v[68:71], v[184:187], v[216:219], v[68:71]
  ds_read_b64_tr_b16 a[146:147], v250 offset:46336
  v_mfma_f32_16x16x32_bf16 v[88:91], v[188:191], v[216:219], 0
  ds_read_b64_tr_b16 a[164:165], v250 offset:55296
  v_mfma_f32_16x16x32_bf16 v[88:91], v[164:167], v[196:199], v[88:91]
  ds_read_b64_tr_b16 a[166:167], v250 offset:56576
  buffer_load_dwordx4 v237, s[8:11], s42 offen offset:1024 lds
  v_mfma_f32_16x16x32_bf16 v[92:95], v[164:167], v[200:203], 0
  ds_read_b64_tr_b16 a[148:149], v249 offset:45120
  v_mfma_f32_16x16x32_bf16 v[92:95], v[188:191], v[220:223], v[92:95]
  ds_read_b64_tr_b16 a[150:151], v249 offset:46400
  v_mfma_f32_16x16x32_bf16 v[96:99], v[188:191], v[224:227], 0
  ds_read_b64_tr_b16 a[168:169], v249 offset:55360
  v_mfma_f32_16x16x32_bf16 v[96:99], v[164:167], v[204:207], v[96:99]
  ds_read_b64_tr_b16 a[170:171], v249 offset:56640
  v_mfma_f32_16x16x32_bf16 v[100:103], v[164:167], v[208:211], 0
  ds_read_b64_tr_b16 a[152:153], v250 offset:45120
  buffer_load_dwordx4 v238, s[8:11], s42 offen offset:2048 lds
  v_mfma_f32_16x16x32_bf16 v[100:103], v[188:191], v[228:231], v[100:103]
  ds_read_b64_tr_b16 a[154:155], v250 offset:46400
  v_mfma_f32_16x16x32_bf16 v[104:107], v[188:191], v[232:235], 0
  ds_read_b64_tr_b16 a[172:173], v250 offset:55360
  v_mfma_f32_16x16x32_bf16 v[104:107], v[164:167], v[212:215], v[104:107]
  ds_read_b64_tr_b16 a[174:175], v250 offset:56640
  v_mfma_f32_16x16x32_bf16 v[124:127], v[168:171], v[212:215], 0
  ds_read_b64_tr_b16 a[156:157], v251 offset:45056
  v_mfma_f32_16x16x32_bf16 v[124:127], v[192:195], v[232:235], v[124:127]
  ds_read_b64_tr_b16 a[158:159], v251 offset:46336
  buffer_load_dwordx4 v239, s[8:11], s42 offen offset:3072 lds
  v_mfma_f32_16x16x32_bf16 v[120:123], v[192:195], v[228:231], 0
  ds_read_b64_tr_b16 a[176:177], v251 offset:55296
  v_mfma_f32_16x16x32_bf16 v[120:123], v[168:171], v[208:211], v[120:123]
  ds_read_b64_tr_b16 a[178:179], v251 offset:56576
  v_mfma_f32_16x16x32_bf16 v[116:119], v[168:171], v[204:207], 0
  v_mfma_f32_16x16x32_bf16 v[116:119], v[192:195], v[224:227], v[116:119]
  s_add_u32 m0, s40, 4096
  v_mfma_f32_16x16x32_bf16 v[112:115], v[192:195], v[220:223], 0
  buffer_load_dwordx4 v240, s[8:11], s42 offen offset:0 lds
  v_mfma_f32_16x16x32_bf16 v[112:115], v[168:171], v[200:203], v[112:115]
  v_mfma_f32_16x16x32_bf16 v[108:111], v[168:171], v[196:199], 0
  v_mfma_f32_16x16x32_bf16 v[108:111], v[192:195], v[216:219], v[108:111]
  s_waitcnt lgkmcnt(0)
  v_mfma_f32_16x16x32_bf16 v[8:11], v[148:151], a[140:143], v[8:11]
  ds_read_b128 v[152:155], v247 offset:47104
  s_mul_i32 s28, s22, 11
  v_mfma_f32_16x16x32_bf16 v[8:11], v[172:175], a[160:163], v[8:11]
  ds_read_b128 v[176:179], v248 offset:47104
  buffer_load_dwordx4 v241, s[8:11], s42 offen offset:1024 lds
  s_add_u32 s28, s28, s21
  v_mfma_f32_16x16x32_bf16 v[12:15], v[172:175], a[164:167], v[12:15]
  ds_read_b128 v[156:159], v247 offset:49152
  s_lshl_b32 s28, s28, 2
  v_mfma_f32_16x16x32_bf16 v[12:15], v[148:151], a[144:147], v[12:15]
  v_mfma_f32_16x16x32_bf16 v[16:19], v[148:151], a[148:151], v[16:19]
  ds_read_b128 v[180:183], v248 offset:49152
  s_add_u32 s28, s28, s20
  v_mfma_f32_16x16x32_bf16 v[16:19], v[172:175], a[168:171], v[16:19]
  ds_read_b128 v[160:163], v247 offset:51200
  s_add_u32 m0, s41, 0
  s_not_b32 s30, s39
  v_mfma_f32_16x16x32_bf16 v[20:23], v[172:175], a[172:175], v[20:23]
  buffer_load_dwordx4 v242, s[12:15], s43 offen offset:0 lds
  v_mfma_f32_16x16x32_bf16 v[20:23], v[148:151], a[152:155], v[20:23]
  ds_read_b128 v[184:187], v248 offset:51200
  s_sub_u32 s29, s28, 96
  v_mfma_f32_16x16x32_bf16 v[24:27], v[148:151], a[156:159], v[24:27]
  ds_read_b128 v[164:167], v247 offset:53248
  s_cmp_lt_u32 s29, 64
  s_cselect_b32 s30, 0, s30
  v_mfma_f32_16x16x32_bf16 v[24:27], v[172:175], a[176:179], v[24:27]
  ds_read_b128 v[188:191], v248 offset:53248
  s_waitcnt lgkmcnt(6)
  v_mfma_f32_16x16x32_bf16 v[44:47], v[176:179], a[176:179], v[44:47]
  v_mov_b32 v136, s30
  v_mfma_f32_16x16x32_bf16 v[44:47], v[152:155], a[156:159], v[44:47]
  ds_read_b128 v[168:171], v247 offset:55296
  buffer_load_dwordx4 v243, s[12:15], s43 offen offset:1024 lds
  v_mov_b32 v137, s30
  v_mfma_f32_16x16x32_bf16 v[40:43], v[152:155], a[152:155], v[40:43]
  ds_read_b128 v[192:195], v248 offset:55296
  v_mfma_f32_16x16x32_bf16 v[40:43], v[176:179], a[172:175], v[40:43]
  v_mov_b32 v138, s30
  v_mfma_f32_16x16x32_bf16 v[36:39], v[176:179], a[168:171], v[36:39]
  v_mov_b32 v139, s30
  v_mfma_f32_16x16x32_bf16 v[36:39], v[152:155], a[148:151], v[36:39]
  s_lshl_b32 s29, s28, 10
  v_mfma_f32_16x16x32_bf16 v[32:35], v[152:155], a[144:147], v[32:35]
  buffer_load_dwordx4 v244, s[12:15], s43 offen offset:2048 lds
  v_mfma_f32_16x16x32_bf16 v[32:35], v[176:179], a[164:167], v[32:35]
  s_cmp_lt_u32 s28, 64
  s_mov_b32 s30, 163840
  s_cselect_b32 s30, 983040, s30
  v_mfma_f32_16x16x32_bf16 v[28:31], v[176:179], a[160:163], v[28:31]
  s_add_u32 s29, s29, s30
  v_mfma_f32_16x16x32_bf16 v[28:31], v[152:155], a[140:143], v[28:31]
  s_waitcnt lgkmcnt(6)
  v_mfma_f32_16x16x32_bf16 v[48:51], v[156:159], a[140:143], v[48:51]
  s_lshl_b32 s30, s28, 15
  v_mfma_f32_16x16x32_bf16 v[48:51], v[180:183], a[160:163], v[48:51]
  buffer_load_dwordx4 v245, s[12:15], s43 offen offset:3072 lds
  s_add_u32 s30, s30, 22023168
  v_mfma_f32_16x16x32_bf16 v[52:55], v[180:183], a[164:167], v[52:55]
  v_mfma_f32_16x16x32_bf16 v[52:55], v[156:159], a[144:147], v[52:55]
  s_cmp_lt_u32 s28, 160
  s_cselect_b32 s29, s29, s30
  s_cselect_b32 s30, 0, 3968
  v_mfma_f32_16x16x32_bf16 v[56:59], v[156:159], a[148:151], v[56:59]
  v_lshrrev_b32 v135, 3, v7
  v_mfma_f32_16x16x32_bf16 v[56:59], v[180:183], a[168:171], v[56:59]
  s_add_u32 m0, s41, 4096
  v_mfma_f32_16x16x32_bf16 v[60:63], v[180:183], a[172:175], v[60:63]
  buffer_load_dwordx4 v246, s[12:15], s43 offen offset:0 lds
  v_mad_u32_u24 v135, v135, s30, v4
  v_mfma_f32_16x16x32_bf16 v[60:63], v[156:159], a[152:155], v[60:63]
  s_cmp_le_u32 s54, 3
  s_cselect_b32 s44, 4, 3
  buffer_store_dwordx4 v[136:139], v135, s[16:19], s29 offen sc1
  v_mfma_f32_16x16x32_bf16 v[64:67], v[156:159], a[156:159], v[64:67]
  s_lshl_b32 s42, s44, 7
  v_mfma_f32_16x16x32_bf16 v[64:67], v[180:183], a[176:179], v[64:67]
  s_mul_i32 s43, s44, s45
  s_waitcnt lgkmcnt(0)
  v_mfma_f32_16x16x32_bf16 v[84:87], v[160:163], a[156:159], v[84:87]
  v_mfma_f32_16x16x32_bf16 v[84:87], v[184:187], a[176:179], v[84:87]
  s_waitcnt vmcnt(12)
  s_barrier
  v_mfma_f32_16x16x32_bf16 v[80:83], v[184:187], a[172:175], v[80:83]
  ds_read_b128 v[148:151], v128 offset:0
  v_mfma_f32_16x16x32_bf16 v[80:83], v[160:163], a[152:155], v[80:83]
  ds_read_b128 v[172:175], v129 offset:0
  v_mfma_f32_16x16x32_bf16 v[76:79], v[160:163], a[148:151], v[76:79]
  ds_read_b64_tr_b16 v[196:197], v130 offset:0
  v_mfma_f32_16x16x32_bf16 v[76:79], v[184:187], a[168:171], v[76:79]
  ds_read_b64_tr_b16 v[198:199], v130 offset:1280
  s_add_u32 m0, s40, 45056
  v_mfma_f32_16x16x32_bf16 v[72:75], v[184:187], a[164:167], v[72:75]
  ds_read_b64_tr_b16 v[216:217], v130 offset:10240
  buffer_load_dwordx4 v236, s[8:11], s42 offen offset:0 lds
  v_mfma_f32_16x16x32_bf16 v[72:75], v[160:163], a[144:147], v[72:75]
  ds_read_b64_tr_b16 v[218:219], v130 offset:11520
  v_mfma_f32_16x16x32_bf16 v[68:71], v[160:163], a[140:143], v[68:71]
  ds_read_b64_tr_b16 v[200:201], v131 offset:0
  v_mfma_f32_16x16x32_bf16 v[68:71], v[184:187], a[160:163], v[68:71]
  ds_read_b64_tr_b16 v[202:203], v131 offset:1280
  v_mfma_f32_16x16x32_bf16 v[88:91], v[188:191], a[160:163], v[88:91]
  ds_read_b64_tr_b16 v[220:221], v131 offset:10240
  v_mfma_f32_16x16x32_bf16 v[88:91], v[164:167], a[140:143], v[88:91]
  ds_read_b64_tr_b16 v[222:223], v131 offset:11520
  buffer_load_dwordx4 v237, s[8:11], s42 offen offset:1024 lds
  v_mfma_f32_16x16x32_bf16 v[92:95], v[164:167], a[144:147], v[92:95]
  ds_read_b64_tr_b16 v[204:205], v130 offset:64
  v_mfma_f32_16x16x32_bf16 v[92:95], v[188:191], a[164:167], v[92:95]
  ds_read_b64_tr_b16 v[206:207], v130 offset:1344
  v_mfma_f32_16x16x32_bf16 v[96:99], v[188:191], a[168:171], v[96:99]
  ds_read_b64_tr_b16 v[224:225], v130 offset:10304
  v_mfma_f32_16x16x32_bf16 v[96:99], v[164:167], a[148:151], v[96:99]
  ds_read_b64_tr_b16 v[226:227], v130 offset:11584
  v_mfma_f32_16x16x32_bf16 v[100:103], v[164:167], a[152:155], v[100:103]
  ds_read_b64_tr_b16 v[208:209], v131 offset:64
  buffer_load_dwordx4 v238, s[8:11], s42 offen offset:2048 lds
  v_mfma_f32_16x16x32_bf16 v[100:103], v[188:191], a[172:175], v[100:103]
  ds_read_b64_tr_b16 v[210:211], v131 offset:1344
  v_mfma_f32_16x16x32_bf16 v[104:107], v[188:191], a[176:179], v[104:107]
  ds_read_b64_tr_b16 v[228:229], v131 offset:10304
  v_mfma_f32_16x16x32_bf16 v[104:107], v[164:167], a[156:159], v[104:107]
  ds_read_b64_tr_b16 v[230:231], v131 offset:11584
  v_mfma_f32_16x16x32_bf16 v[124:127], v[168:171], a[156:159], v[124:127]
  ds_read_b64_tr_b16 v[212:213], v132 offset:0
  v_mfma_f32_16x16x32_bf16 v[124:127], v[192:195], a[176:179], v[124:127]
  ds_read_b64_tr_b16 v[214:215], v132 offset:1280
  buffer_load_dwordx4 v239, s[8:11], s42 offen offset:3072 lds
  v_mfma_f32_16x16x32_bf16 v[120:123], v[192:195], a[172:175], v[120:123]
  ds_read_b64_tr_b16 v[232:233], v132 offset:10240
  v_mfma_f32_16x16x32_bf16 v[120:123], v[168:171], a[152:155], v[120:123]
  ds_read_b64_tr_b16 v[234:235], v132 offset:11520
  v_mfma_f32_16x16x32_bf16 v[116:119], v[168:171], a[148:151], v[116:119]
  v_mfma_f32_16x16x32_bf16 v[116:119], v[192:195], a[168:171], v[116:119]
  s_add_u32 m0, s40, 49152
  v_mfma_f32_16x16x32_bf16 v[112:115], v[192:195], a[164:167], v[112:115]
  buffer_load_dwordx4 v240, s[8:11], s42 offen offset:0 lds
  v_mfma_f32_16x16x32_bf16 v[112:115], v[168:171], a[144:147], v[112:115]
  v_mfma_f32_16x16x32_bf16 v[108:111], v[168:171], a[140:143], v[108:111]
  v_mfma_f32_16x16x32_bf16 v[108:111], v[192:195], a[160:163], v[108:111]
  s_waitcnt lgkmcnt(0)
  v_mfma_f32_16x16x32_bf16 v[8:11], v[148:151], v[196:199], v[8:11]
  ds_read_b128 v[152:155], v128 offset:2048
  v_mfma_f32_16x16x32_bf16 v[8:11], v[172:175], v[216:219], v[8:11]
  ds_read_b128 v[176:179], v129 offset:2048
  buffer_load_dwordx4 v241, s[8:11], s42 offen offset:1024 lds
  v_mfma_f32_16x16x32_bf16 v[12:15], v[172:175], v[220:223], v[12:15]
  ds_read_b128 v[156:159], v128 offset:4096
  v_mfma_f32_16x16x32_bf16 v[12:15], v[148:151], v[200:203], v[12:15]
  v_mfma_f32_16x16x32_bf16 v[16:19], v[148:151], v[204:207], v[16:19]
  ds_read_b128 v[180:183], v129 offset:4096
  v_mfma_f32_16x16x32_bf16 v[16:19], v[172:175], v[224:227], v[16:19]
  ds_read_b128 v[160:163], v128 offset:6144
  s_add_u32 m0, s41, 45056
  v_mfma_f32_16x16x32_bf16 v[20:23], v[172:175], v[228:231], v[20:23]
  buffer_load_dwordx4 v242, s[12:15], s43 offen offset:0 lds
  v_mfma_f32_16x16x32_bf16 v[20:23], v[148:151], v[208:211], v[20:23]
  ds_read_b128 v[184:187], v129 offset:6144
  v_mfma_f32_16x16x32_bf16 v[24:27], v[148:151], v[212:215], v[24:27]
  ds_read_b128 v[164:167], v128 offset:8192
  v_mfma_f32_16x16x32_bf16 v[24:27], v[172:175], v[232:235], v[24:27]
  ds_read_b128 v[188:191], v129 offset:8192
  s_waitcnt lgkmcnt(6)
  v_mfma_f32_16x16x32_bf16 v[44:47], v[176:179], v[232:235], v[44:47]
  v_mfma_f32_16x16x32_bf16 v[44:47], v[152:155], v[212:215], v[44:47]
  ds_read_b128 v[168:171], v128 offset:10240
  buffer_load_dwordx4 v243, s[12:15], s43 offen offset:1024 lds
  v_mfma_f32_16x16x32_bf16 v[40:43], v[152:155], v[208:211], v[40:43]
  ds_read_b128 v[192:195], v129 offset:10240
  v_mfma_f32_16x16x32_bf16 v[40:43], v[176:179], v[228:231], v[40:43]
  v_mfma_f32_16x16x32_bf16 v[36:39], v[176:179], v[224:227], v[36:39]
  v_mfma_f32_16x16x32_bf16 v[36:39], v[152:155], v[204:207], v[36:39]
  v_mfma_f32_16x16x32_bf16 v[32:35], v[152:155], v[200:203], v[32:35]
  buffer_load_dwordx4 v244, s[12:15], s43 offen offset:2048 lds
  v_mfma_f32_16x16x32_bf16 v[32:35], v[176:179], v[220:223], v[32:35]
  v_mfma_f32_16x16x32_bf16 v[28:31], v[176:179], v[216:219], v[28:31]
  v_mfma_f32_16x16x32_bf16 v[28:31], v[152:155], v[196:199], v[28:31]
  s_waitcnt lgkmcnt(6)
  v_mfma_f32_16x16x32_bf16 v[48:51], v[156:159], v[196:199], v[48:51]
  v_mfma_f32_16x16x32_bf16 v[48:51], v[180:183], v[216:219], v[48:51]
  buffer_load_dwordx4 v245, s[12:15], s43 offen offset:3072 lds
  v_mfma_f32_16x16x32_bf16 v[52:55], v[180:183], v[220:223], v[52:55]
  v_mfma_f32_16x16x32_bf16 v[52:55], v[156:159], v[200:203], v[52:55]
  v_mfma_f32_16x16x32_bf16 v[56:59], v[156:159], v[204:207], v[56:59]
  v_mfma_f32_16x16x32_bf16 v[56:59], v[180:183], v[224:227], v[56:59]
  s_add_u32 m0, s41, 49152
  v_mfma_f32_16x16x32_bf16 v[60:63], v[180:183], v[228:231], v[60:63]
  buffer_load_dwordx4 v246, s[12:15], s43 offen offset:0 lds
  v_mfma_f32_16x16x32_bf16 v[60:63], v[156:159], v[208:211], v[60:63]
  s_cmp_le_u32 s54, 4
  s_cselect_b32 s44, 5, 4
  v_mfma_f32_16x16x32_bf16 v[64:67], v[156:159], v[212:215], v[64:67]
  s_lshl_b32 s42, s44, 7
  v_mfma_f32_16x16x32_bf16 v[64:67], v[180:183], v[232:235], v[64:67]
  s_mul_i32 s43, s44, s45
  s_waitcnt lgkmcnt(0)
  v_mfma_f32_16x16x32_bf16 v[84:87], v[160:163], v[212:215], v[84:87]
  v_mfma_f32_16x16x32_bf16 v[84:87], v[184:187], v[232:235], v[84:87]
  s_waitcnt vmcnt(11)
  s_barrier
  v_mfma_f32_16x16x32_bf16 v[80:83], v[184:187], v[228:231], v[80:83]
  ds_read_b128 v[148:151], v247 offset:0
  v_mov_b32 v3, s39
  v_mfma_f32_16x16x32_bf16 v[80:83], v[160:163], v[208:211], v[80:83]
  ds_read_b128 v[172:175], v248 offset:0
  v_lshlrev_b32 v6, 25, v7
  v_mfma_f32_16x16x32_bf16 v[76:79], v[160:163], v[204:207], v[76:79]
  ds_read_b64_tr_b16 a[140:141], v249 offset:0
  buffer_store_dword v3, v6, s[16:19], s49 offen sc1
  v_mfma_f32_16x16x32_bf16 v[76:79], v[184:187], v[224:227], v[76:79]
  ds_read_b64_tr_b16 a[142:143], v249 offset:1280
  s_add_u32 m0, s40, 90112
  v_mfma_f32_16x16x32_bf16 v[72:75], v[184:187], v[220:223], v[72:75]
  ds_read_b64_tr_b16 a[160:161], v249 offset:10240
  buffer_load_dwordx4 v236, s[8:11], s42 offen offset:0 lds
  v_mfma_f32_16x16x32_bf16 v[72:75], v[160:163], v[200:203], v[72:75]
  ds_read_b64_tr_b16 a[162:163], v249 offset:11520
  v_mfma_f32_16x16x32_bf16 v[68:71], v[160:163], v[196:199], v[68:71]
  ds_read_b64_tr_b16 a[144:145], v250 offset:0
  v_mfma_f32_16x16x32_bf16 v[68:71], v[184:187], v[216:219], v[68:71]
  ds_read_b64_tr_b16 a[146:147], v250 offset:1280
  v_mfma_f32_16x16x32_bf16 v[88:91], v[188:191], v[216:219], v[88:91]
  ds_read_b64_tr_b16 a[164:165], v250 offset:10240
  v_mfma_f32_16x16x32_bf16 v[88:91], v[164:167], v[196:199], v[88:91]
  ds_read_b64_tr_b16 a[166:167], v250 offset:11520
  buffer_load_dwordx4 v237, s[8:11], s42 offen offset:1024 lds
  v_mfma_f32_16x16x32_bf16 v[92:95], v[164:167], v[200:203], v[92:95]
  ds_read_b64_tr_b16 a[148:149], v249 offset:64
  v_mfma_f32_16x16x32_bf16 v[92:95], v[188:191], v[220:223], v[92:95]
  ds_read_b64_tr_b16 a[150:151], v249 offset:1344
  v_mfma_f32_16x16x32_bf16 v[96:99], v[188:191], v[224:227], v[96:99]
  ds_read_b64_tr_b16 a[168:169], v249 offset:10304
  v_mfma_f32_16x16x32_bf16 v[96:99], v[164:167], v[204:207], v[96:99]
  ds_read_b64_tr_b16 a[170:171], v249 offset:11584
  v_mfma_f32_16x16x32_bf16 v[100:103], v[164:167], v[208:211], v[100:103]
  ds_read_b64_tr_b16 a[152:153], v250 offset:64
  buffer_load_dwordx4 v238, s[8:11], s42 offen offset:2048 lds
  v_mfma_f32_16x16x32_bf16 v[100:103], v[188:191], v[228:231], v[100:103]
  ds_read_b64_tr_b16 a[154:155], v250 offset:1344
  v_mfma_f32_16x16x32_bf16 v[104:107], v[188:191], v[232:235], v[104:107]
  ds_read_b64_tr_b16 a[172:173], v250 offset:10304
  v_mfma_f32_16x16x32_bf16 v[104:107], v[164:167], v[212:215], v[104:107]
  ds_read_b64_tr_b16 a[174:175], v250 offset:11584
  v_mfma_f32_16x16x32_bf16 v[124:127], v[168:171], v[212:215], v[124:127]
  ds_read_b64_tr_b16 a[156:157], v251 offset:0
  v_mfma_f32_16x16x32_bf16 v[124:127], v[192:195], v[232:235], v[124:127]
  ds_read_b64_tr_b16 a[158:159], v251 offset:1280
  buffer_load_dwordx4 v239, s[8:11], s42 offen offset:3072 lds
  v_mfma_f32_16x16x32_bf16 v[120:123], v[192:195], v[228:231], v[120:123]
  ds_read_b64_tr_b16 a[176:177], v251 offset:10240
  v_mfma_f32_16x16x32_bf16 v[120:123], v[168:171], v[208:211], v[120:123]
  ds_read_b64_tr_b16 a[178:179], v251 offset:11520
  v_mfma_f32_16x16x32_bf16 v[116:119], v[168:171], v[204:207], v[116:119]
  v_mfma_f32_16x16x32_bf16 v[116:119], v[192:195], v[224:227], v[116:119]
  s_add_u32 m0, s40, 94208
  v_mfma_f32_16x16x32_bf16 v[112:115], v[192:195], v[220:223], v[112:115]
  buffer_load_dwordx4 v240, s[8:11], s42 offen offset:0 lds
  v_mfma_f32_16x16x32_bf16 v[112:115], v[168:171], v[200:203], v[112:115]
  v_mfma_f32_16x16x32_bf16 v[108:111], v[168:171], v[196:199], v[108:111]
  v_mfma_f32_16x16x32_bf16 v[108:111], v[192:195], v[216:219], v[108:111]
  s_waitcnt lgkmcnt(0)
  v_mfma_f32_16x16x32_bf16 v[8:11], v[148:151], a[140:143], v[8:11]
  ds_read_b128 v[152:155], v247 offset:2048
  v_mfma_f32_16x16x32_bf16 v[8:11], v[172:175], a[160:163], v[8:11]
  ds_read_b128 v[176:179], v248 offset:2048
  buffer_load_dwordx4 v241, s[8:11], s42 offen offset:1024 lds
  v_mfma_f32_16x16x32_bf16 v[12:15], v[172:175], a[164:167], v[12:15]
  ds_read_b128 v[156:159], v247 offset:4096
  v_mfma_f32_16x16x32_bf16 v[12:15], v[148:151], a[144:147], v[12:15]
  v_mfma_f32_16x16x32_bf16 v[16:19], v[148:151], a[148:151], v[16:19]
  ds_read_b128 v[180:183], v248 offset:4096
  v_and_b32 v1, 15, v7
  v_lshrrev_b32 v2, 4, v7
  v_mfma_f32_16x16x32_bf16 v[16:19], v[172:175], a[168:171], v[16:19]
  ds_read_b128 v[160:163], v247 offset:6144
  s_add_u32 m0, s41, 90112
  v_cmp_gt_u32 s[32:33], 8, v1
  v_mfma_f32_16x16x32_bf16 v[20:23], v[172:175], a[172:175], v[20:23]
  buffer_load_dwordx4 v242, s[12:15], s43 offen offset:0 lds
  s_cmp_eq_u32 s21, 10
  s_cselect_b32 s36, s51, 0
  v_mfma_f32_16x16x32_bf16 v[20:23], v[148:151], a[152:155], v[20:23]
  ds_read_b128 v[184:187], v248 offset:6144
  s_lshl_b32 s37, s22, 1
  v_mfma_f32_16x16x32_bf16 v[24:27], v[148:151], a[156:159], v[24:27]
  ds_read_b128 v[164:167], v247 offset:8192
  s_add_u32 s37, s37, s52
  v_mfma_f32_16x16x32_bf16 v[24:27], v[172:175], a[176:179], v[24:27]
  ds_read_b128 v[188:191], v248 offset:8192
  s_waitcnt lgkmcnt(6)
  s_lshl_b32 s37, s37, 12
  v_mfma_f32_16x16x32_bf16 v[44:47], v[176:179], a[176:179], v[44:47]
  s_add_u32 s37, s37, 262144
  s_lshl_b32 s60, s20, 12
  v_mfma_f32_16x16x32_bf16 v[44:47], v[152:155], a[156:159], v[44:47]
  ds_read_b128 v[168:171], v247 offset:10240
  buffer_load_dwordx4 v243, s[12:15], s43 offen offset:1024 lds
  s_add_u32 s60, s60, 145408
  v_mfma_f32_16x16x32_bf16 v[40:43], v[152:155], a[152:155], v[40:43]
  ds_read_b128 v[192:195], v248 offset:10240
  v_and_b32 v254, 31, v7
  v_mfma_f32_16x16x32_bf16 v[40:43], v[176:179], a[172:175], v[40:43]
  v_add_u32 v254, 224, v254
  v_mfma_f32_16x16x32_bf16 v[36:39], v[176:179], a[168:171], v[36:39]
  v_add_u32 v3, 0, v2
  v_mfma_f32_16x16x32_bf16 v[36:39], v[152:155], a[148:151], v[36:39]
  v_cmp_le_u32 vcc, 5, v3
  v_mfma_f32_16x16x32_bf16 v[32:35], v[152:155], a[144:147], v[32:35]
  buffer_load_dwordx4 v244, s[12:15], s43 offen offset:2048 lds
  v_add_u32 v252, -8, v1
  v_cmp_gt_u32 s[62:63], 10, v3
  v_mfma_f32_16x16x32_bf16 v[32:35], v[176:179], a[164:167], v[32:35]
  v_cndmask_b32 v253, 0, 20, vcc
  v_mfma_f32_16x16x32_bf16 v[28:31], v[176:179], a[160:163], v[28:31]
  v_sub_u32 v252, v252, v253
  v_mfma_f32_16x16x32_bf16 v[28:31], v[152:155], a[140:143], v[28:31]
  s_waitcnt lgkmcnt(6)
  v_cmp_eq_u32 vcc, 0, v1
  v_mfma_f32_16x16x32_bf16 v[48:51], v[156:159], a[140:143], v[48:51]
  s_nop 0
  v_cndmask_b32 v253, v252, 0, vcc
  v_mfma_f32_16x16x32_bf16 v[48:51], v[180:183], a[160:163], v[48:51]
  buffer_load_dwordx4 v245, s[12:15], s43 offen offset:3072 lds
  v_cndmask_b32 v252, v252, 20, vcc
  v_mfma_f32_16x16x32_bf16 v[52:55], v[180:183], a[164:167], v[52:55]
  v_cmp_gt_u32 vcc, 20, v253
  v_mad_u32_u24 v252, v3, 21, v252
  v_mfma_f32_16x16x32_bf16 v[52:55], v[156:159], a[144:147], v[52:55]
  s_and_b64 vcc, vcc, s[62:63]
  v_mfma_f32_16x16x32_bf16 v[56:59], v[156:159], a[148:151], v[56:59]
  v_cndmask_b32 v252, v254, v252, vcc
  v_mfma_f32_16x16x32_bf16 v[56:59], v[180:183], a[168:171], v[56:59]
  s_add_u32 m0, s41, 94208
  v_lshl_add_u32 v252, v252, 4, s60
  v_mfma_f32_16x16x32_bf16 v[60:63], v[180:183], a[172:175], v[60:63]
  buffer_load_dwordx4 v246, s[12:15], s43 offen offset:0 lds
  v_accvgpr_write_b32 a244, v252
  v_mfma_f32_16x16x32_bf16 v[60:63], v[156:159], a[152:155], v[60:63]
  s_cmp_le_u32 s54, 5
  s_cselect_b32 s44, 6, 5
  v_add_u32 v3, 0, v2
  v_mfma_f32_16x16x32_bf16 v[64:67], v[156:159], a[156:159], v[64:67]
  s_lshl_b32 s42, s44, 7
  v_cmp_le_u32 vcc, 5, v3
  v_mfma_f32_16x16x32_bf16 v[64:67], v[180:183], a[176:179], v[64:67]
  s_mul_i32 s43, s44, s45
  s_waitcnt lgkmcnt(0)
  v_mfma_f32_16x16x32_bf16 v[84:87], v[160:163], a[156:159], v[84:87]
  v_mfma_f32_16x16x32_bf16 v[84:87], v[184:187], a[176:179], v[84:87]
  s_waitcnt vmcnt(12)
  s_barrier
  v_mfma_f32_16x16x32_bf16 v[80:83], v[184:187], a[172:175], v[80:83]
  ds_read_b128 v[148:151], v247 offset:45056
  v_mfma_f32_16x16x32_bf16 v[80:83], v[160:163], a[152:155], v[80:83]
  ds_read_b128 v[172:175], v248 offset:45056
  v_mfma_f32_16x16x32_bf16 v[76:79], v[160:163], a[148:151], v[76:79]
  ds_read_b64_tr_b16 v[196:197], v249 offset:45056
  v_mfma_f32_16x16x32_bf16 v[76:79], v[184:187], a[168:171], v[76:79]
  ds_read_b64_tr_b16 v[198:199], v249 offset:46336
  s_add_u32 m0, s40, 0
  v_mfma_f32_16x16x32_bf16 v[72:75], v[184:187], a[164:167], v[72:75]
  ds_read_b64_tr_b16 v[216:217], v249 offset:55296
  buffer_load_dwordx4 v236, s[8:11], s42 offen offset:0 lds
  v_mfma_f32_16x16x32_bf16 v[72:75], v[160:163], a[144:147], v[72:75]
  ds_read_b64_tr_b16 v[218:219], v249 offset:56576
  v_mfma_f32_16x16x32_bf16 v[68:71], v[160:163], a[140:143], v[68:71]
  ds_read_b64_tr_b16 v[200:201], v250 offset:45056
  v_mfma_f32_16x16x32_bf16 v[68:71], v[184:187], a[160:163], v[68:71]
  ds_read_b64_tr_b16 v[202:203], v250 offset:46336
  v_mfma_f32_16x16x32_bf16 v[88:91], v[188:191], a[160:163], v[88:91]
  ds_read_b64_tr_b16 v[220:221], v250 offset:55296
  v_mfma_f32_16x16x32_bf16 v[88:91], v[164:167], a[140:143], v[88:91]
  ds_read_b64_tr_b16 v[222:223], v250 offset:56576
  buffer_load_dwordx4 v237, s[8:11], s42 offen offset:1024 lds
  v_mfma_f32_16x16x32_bf16 v[92:95], v[164:167], a[144:147], v[92:95]
  ds_read_b64_tr_b16 v[204:205], v249 offset:45120
  v_mfma_f32_16x16x32_bf16 v[92:95], v[188:191], a[164:167], v[92:95]
  ds_read_b64_tr_b16 v[206:207], v249 offset:46400
  v_mfma_f32_16x16x32_bf16 v[96:99], v[188:191], a[168:171], v[96:99]
  ds_read_b64_tr_b16 v[224:225], v249 offset:55360
  v_mfma_f32_16x16x32_bf16 v[96:99], v[164:167], a[148:151], v[96:99]
  ds_read_b64_tr_b16 v[226:227], v249 offset:56640
  v_mfma_f32_16x16x32_bf16 v[100:103], v[164:167], a[152:155], v[100:103]
  ds_read_b64_tr_b16 v[208:209], v250 offset:45120
  buffer_load_dwordx4 v238, s[8:11], s42 offen offset:2048 lds
  v_mfma_f32_16x16x32_bf16 v[100:103], v[188:191], a[172:175], v[100:103]
  ds_read_b64_tr_b16 v[210:211], v250 offset:46400
  v_mfma_f32_16x16x32_bf16 v[104:107], v[188:191], a[176:179], v[104:107]
  ds_read_b64_tr_b16 v[228:229], v250 offset:55360
  v_mfma_f32_16x16x32_bf16 v[104:107], v[164:167], a[156:159], v[104:107]
  ds_read_b64_tr_b16 v[230:231], v250 offset:56640
  v_mfma_f32_16x16x32_bf16 v[124:127], v[168:171], a[156:159], v[124:127]
  ds_read_b64_tr_b16 v[212:213], v251 offset:45056
  v_mfma_f32_16x16x32_bf16 v[124:127], v[192:195], a[176:179], v[124:127]
  ds_read_b64_tr_b16 v[214:215], v251 offset:46336
  buffer_load_dwordx4 v239, s[8:11], s42 offen offset:3072 lds
  v_mfma_f32_16x16x32_bf16 v[120:123], v[192:195], a[172:175], v[120:123]
  ds_read_b64_tr_b16 v[232:233], v251 offset:55296
  v_mfma_f32_16x16x32_bf16 v[120:123], v[168:171], a[152:155], v[120:123]
  ds_read_b64_tr_b16 v[234:235], v251 offset:56576
  v_mfma_f32_16x16x32_bf16 v[116:119], v[168:171], a[148:151], v[116:119]
  v_mfma_f32_16x16x32_bf16 v[116:119], v[192:195], a[168:171], v[116:119]
  s_add_u32 m0, s40, 4096
  v_mfma_f32_16x16x32_bf16 v[112:115], v[192:195], a[164:167], v[112:115]
  buffer_load_dwordx4 v240, s[8:11], s42 offen offset:0 lds
  v_mfma_f32_16x16x32_bf16 v[112:115], v[168:171], a[144:147], v[112:115]
  v_mfma_f32_16x16x32_bf16 v[108:111], v[168:171], a[140:143], v[108:111]
  v_mfma_f32_16x16x32_bf16 v[108:111], v[192:195], a[160:163], v[108:111]
  s_waitcnt lgkmcnt(0)
  v_mfma_f32_16x16x32_bf16 v[8:11], v[148:151], v[196:199], v[8:11]
  ds_read_b128 v[152:155], v247 offset:47104
  v_mfma_f32_16x16x32_bf16 v[8:11], v[172:175], v[216:219], v[8:11]
  ds_read_b128 v[176:179], v248 offset:47104
  buffer_load_dwordx4 v241, s[8:11], s42 offen offset:1024 lds
  v_mfma_f32_16x16x32_bf16 v[12:15], v[172:175], v[220:223], v[12:15]
  ds_read_b128 v[156:159], v247 offset:49152
  v_mfma_f32_16x16x32_bf16 v[12:15], v[148:151], v[200:203], v[12:15]
  v_mfma_f32_16x16x32_bf16 v[16:19], v[148:151], v[204:207], v[16:19]
  ds_read_b128 v[180:183], v248 offset:49152
  v_add_u32 v252, 8, v1
  v_cmp_gt_u32 s[62:63], 10, v3
  v_mfma_f32_16x16x32_bf16 v[16:19], v[172:175], v[224:227], v[16:19]
  ds_read_b128 v[160:163], v247 offset:51200
  s_add_u32 m0, s41, 0
  v_cndmask_b32 v253, 0, 20, vcc
  v_mfma_f32_16x16x32_bf16 v[20:23], v[172:175], v[228:231], v[20:23]
  buffer_load_dwordx4 v242, s[12:15], s43 offen offset:0 lds
  v_sub_u32 v252, v252, v253
  v_mfma_f32_16x16x32_bf16 v[20:23], v[148:151], v[208:211], v[20:23]
  ds_read_b128 v[184:187], v248 offset:51200
  v_cmp_gt_u32 vcc, 20, v252
  v_mfma_f32_16x16x32_bf16 v[24:27], v[148:151], v[212:215], v[24:27]
  ds_read_b128 v[164:167], v247 offset:53248
  v_mad_u32_u24 v252, v3, 21, v252
  v_mfma_f32_16x16x32_bf16 v[24:27], v[172:175], v[232:235], v[24:27]
  ds_read_b128 v[188:191], v248 offset:53248
  s_waitcnt lgkmcnt(6)
  s_and_b64 vcc, vcc, s[62:63]
  v_mfma_f32_16x16x32_bf16 v[44:47], v[176:179], v[232:235], v[44:47]
  v_cndmask_b32 v252, v254, v252, vcc
  v_lshl_add_u32 v252, v252, 4, s60
  v_mfma_f32_16x16x32_bf16 v[44:47], v[152:155], v[212:215], v[44:47]
  ds_read_b128 v[168:171], v247 offset:55296
  buffer_load_dwordx4 v243, s[12:15], s43 offen offset:1024 lds
  v_accvgpr_write_b32 a245, v252
  v_mfma_f32_16x16x32_bf16 v[40:43], v[152:155], v[208:211], v[40:43]
  ds_read_b128 v[192:195], v248 offset:55296
  v_add_u32 v3, 4, v2
  v_mfma_f32_16x16x32_bf16 v[40:43], v[176:179], v[228:231], v[40:43]
  v_cmp_le_u32 vcc, 5, v3
  v_mfma_f32_16x16x32_bf16 v[36:39], v[176:179], v[224:227], v[36:39]
  v_add_u32 v252, -8, v1
  v_mfma_f32_16x16x32_bf16 v[36:39], v[152:155], v[204:207], v[36:39]
  v_cmp_gt_u32 s[62:63], 10, v3
  v_mfma_f32_16x16x32_bf16 v[32:35], v[152:155], v[200:203], v[32:35]
  buffer_load_dwordx4 v244, s[12:15], s43 offen offset:2048 lds
  v_cndmask_b32 v253, 0, 20, vcc
  v_sub_u32 v252, v252, v253
  v_mfma_f32_16x16x32_bf16 v[32:35], v[176:179], v[220:223], v[32:35]
  v_cmp_eq_u32 vcc, 0, v1
  v_mfma_f32_16x16x32_bf16 v[28:31], v[176:179], v[216:219], v[28:31]
  s_nop 0
  v_cndmask_b32 v253, v252, 0, vcc
  v_mfma_f32_16x16x32_bf16 v[28:31], v[152:155], v[196:199], v[28:31]
  s_waitcnt lgkmcnt(6)
  v_cndmask_b32 v252, v252, 20, vcc
  v_mfma_f32_16x16x32_bf16 v[48:51], v[156:159], v[196:199], v[48:51]
  v_cmp_gt_u32 vcc, 20, v253
  v_mfma_f32_16x16x32_bf16 v[48:51], v[180:183], v[216:219], v[48:51]
  buffer_load_dwordx4 v245, s[12:15], s43 offen offset:3072 lds
  v_mad_u32_u24 v252, v3, 21, v252
  v_mfma_f32_16x16x32_bf16 v[52:55], v[180:183], v[220:223], v[52:55]
  s_and_b64 vcc, vcc, s[62:63]
  v_cndmask_b32 v252, v254, v252, vcc
  v_mfma_f32_16x16x32_bf16 v[52:55], v[156:159], v[200:203], v[52:55]
  v_lshl_add_u32 v252, v252, 4, s60
  v_mfma_f32_16x16x32_bf16 v[56:59], v[156:159], v[204:207], v[56:59]
  v_accvgpr_write_b32 a246, v252
  v_mfma_f32_16x16x32_bf16 v[56:59], v[180:183], v[224:227], v[56:59]
  s_add_u32 m0, s41, 4096
  v_add_u32 v3, 4, v2
  v_mfma_f32_16x16x32_bf16 v[60:63], v[180:183], v[228:231], v[60:63]
  buffer_load_dwordx4 v246, s[12:15], s43 offen offset:0 lds
  v_cmp_le_u32 vcc, 5, v3
  v_mfma_f32_16x16x32_bf16 v[60:63], v[156:159], v[208:211], v[60:63]
  s_cmp_le_u32 s54, 6
  s_cselect_b32 s44, 7, 6
  v_add_u32 v252, 8, v1
  v_mfma_f32_16x16x32_bf16 v[64:67], v[156:159], v[212:215], v[64:67]
  s_lshl_b32 s42, s44, 7
  v_cmp_gt_u32 s[62:63], 10, v3
  v_mfma_f32_16x16x32_bf16 v[64:67], v[180:183], v[232:235], v[64:67]
  s_mul_i32 s43, s44, s45
  s_waitcnt lgkmcnt(0)
  v_mfma_f32_16x16x32_bf16 v[84:87], v[160:163], v[212:215], v[84:87]
  v_mfma_f32_16x16x32_bf16 v[84:87], v[184:187], v[232:235], v[84:87]
  s_waitcnt vmcnt(11)
  s_barrier
  v_mfma_f32_16x16x32_bf16 v[80:83], v[184:187], v[228:231], v[80:83]
  ds_read_b128 v[148:151], v128 offset:0
  v_mfma_f32_16x16x32_bf16 v[80:83], v[160:163], v[208:211], v[80:83]
  ds_read_b128 v[172:175], v129 offset:0
  v_mfma_f32_16x16x32_bf16 v[76:79], v[160:163], v[204:207], v[76:79]
  ds_read_b64_tr_b16 a[140:141], v130 offset:0
  v_mfma_f32_16x16x32_bf16 v[76:79], v[184:187], v[224:227], v[76:79]
  ds_read_b64_tr_b16 a[142:143], v130 offset:1280
  s_add_u32 m0, s40, 45056
  v_mfma_f32_16x16x32_bf16 v[72:75], v[184:187], v[220:223], v[72:75]
  ds_read_b64_tr_b16 a[160:161], v130 offset:10240
  buffer_load_dwordx4 v236, s[8:11], s42 offen offset:0 lds
  v_mfma_f32_16x16x32_bf16 v[72:75], v[160:163], v[200:203], v[72:75]
  ds_read_b64_tr_b16 a[162:163], v130 offset:11520
  v_mfma_f32_16x16x32_bf16 v[68:71], v[160:163], v[196:199], v[68:71]
  ds_read_b64_tr_b16 a[144:145], v131 offset:0
  v_mfma_f32_16x16x32_bf16 v[68:71], v[184:187], v[216:219], v[68:71]
  ds_read_b64_tr_b16 a[146:147], v131 offset:1280
  v_mfma_f32_16x16x32_bf16 v[88:91], v[188:191], v[216:219], v[88:91]
  ds_read_b64_tr_b16 a[164:165], v131 offset:10240
  v_mfma_f32_16x16x32_bf16 v[88:91], v[164:167], v[196:199], v[88:91]
  ds_read_b64_tr_b16 a[166:167], v131 offset:11520
  buffer_load_dwordx4 v237, s[8:11], s42 offen offset:1024 lds
  v_mfma_f32_16x16x32_bf16 v[92:95], v[164:167], v[200:203], v[92:95]
  ds_read_b64_tr_b16 a[148:149], v130 offset:64
  v_mfma_f32_16x16x32_bf16 v[92:95], v[188:191], v[220:223], v[92:95]
  ds_read_b64_tr_b16 a[150:151], v130 offset:1344
  v_mfma_f32_16x16x32_bf16 v[96:99], v[188:191], v[224:227], v[96:99]
  ds_read_b64_tr_b16 a[168:169], v130 offset:10304
  v_mfma_f32_16x16x32_bf16 v[96:99], v[164:167], v[204:207], v[96:99]
  ds_read_b64_tr_b16 a[170:171], v130 offset:11584
  v_mfma_f32_16x16x32_bf16 v[100:103], v[164:167], v[208:211], v[100:103]
  ds_read_b64_tr_b16 a[152:153], v131 offset:64
  buffer_load_dwordx4 v238, s[8:11], s42 offen offset:2048 lds
  v_mfma_f32_16x16x32_bf16 v[100:103], v[188:191], v[228:231], v[100:103]
  ds_read_b64_tr_b16 a[154:155], v131 offset:1344
  v_mfma_f32_16x16x32_bf16 v[104:107], v[188:191], v[232:235], v[104:107]
  ds_read_b64_tr_b16 a[172:173], v131 offset:10304
  v_mfma_f32_16x16x32_bf16 v[104:107], v[164:167], v[212:215], v[104:107]
  ds_read_b64_tr_b16 a[174:175], v131 offset:11584
  v_mfma_f32_16x16x32_bf16 v[124:127], v[168:171], v[212:215], v[124:127]
  ds_read_b64_tr_b16 a[156:157], v132 offset:0
  v_mfma_f32_16x16x32_bf16 v[124:127], v[192:195], v[232:235], v[124:127]
  ds_read_b64_tr_b16 a[158:159], v132 offset:1280
  buffer_load_dwordx4 v239, s[8:11], s42 offen offset:3072 lds
  v_mfma_f32_16x16x32_bf16 v[120:123], v[192:195], v[228:231], v[120:123]
  ds_read_b64_tr_b16 a[176:177], v132 offset:10240
  v_mfma_f32_16x16x32_bf16 v[120:123], v[168:171], v[208:211], v[120:123]
  ds_read_b64_tr_b16 a[178:179], v132 offset:11520
  v_mfma_f32_16x16x32_bf16 v[116:119], v[168:171], v[204:207], v[116:119]
  v_mfma_f32_16x16x32_bf16 v[116:119], v[192:195], v[224:227], v[116:119]
  s_add_u32 m0, s40, 49152
  v_mfma_f32_16x16x32_bf16 v[112:115], v[192:195], v[220:223], v[112:115]
  buffer_load_dwordx4 v240, s[8:11], s42 offen offset:0 lds
  v_mfma_f32_16x16x32_bf16 v[112:115], v[168:171], v[200:203], v[112:115]
  v_mfma_f32_16x16x32_bf16 v[108:111], v[168:171], v[196:199], v[108:111]
  v_mfma_f32_16x16x32_bf16 v[108:111], v[192:195], v[216:219], v[108:111]
  s_waitcnt lgkmcnt(0)
  v_mfma_f32_16x16x32_bf16 v[8:11], v[148:151], a[140:143], v[8:11]
  ds_read_b128 v[152:155], v128 offset:2048
  v_mfma_f32_16x16x32_bf16 v[8:11], v[172:175], a[160:163], v[8:11]
  ds_read_b128 v[176:179], v129 offset:2048
  buffer_load_dwordx4 v241, s[8:11], s42 offen offset:1024 lds
  v_mfma_f32_16x16x32_bf16 v[12:15], v[172:175], a[164:167], v[12:15]
  ds_read_b128 v[156:159], v128 offset:4096
  v_mfma_f32_16x16x32_bf16 v[12:15], v[148:151], a[144:147], v[12:15]
  v_mfma_f32_16x16x32_bf16 v[16:19], v[148:151], a[148:151], v[16:19]
  ds_read_b128 v[180:183], v129 offset:4096
  v_cndmask_b32 v253, 0, 20, vcc
  v_sub_u32 v252, v252, v253
  v_mfma_f32_16x16x32_bf16 v[16:19], v[172:175], a[168:171], v[16:19]
  ds_read_b128 v[160:163], v128 offset:6144
  s_add_u32 m0, s41, 45056
  v_cmp_gt_u32 vcc, 20, v252
  v_mfma_f32_16x16x32_bf16 v[20:23], v[172:175], a[172:175], v[20:23]
  buffer_load_dwordx4 v242, s[12:15], s43 offen offset:0 lds
  v_mad_u32_u24 v252, v3, 21, v252
  v_mfma_f32_16x16x32_bf16 v[20:23], v[148:151], a[152:155], v[20:23]
  ds_read_b128 v[184:187], v129 offset:6144
  s_and_b64 vcc, vcc, s[62:63]
  v_mfma_f32_16x16x32_bf16 v[24:27], v[148:151], a[156:159], v[24:27]
  ds_read_b128 v[164:167], v128 offset:8192
  v_cndmask_b32 v252, v254, v252, vcc
  v_mfma_f32_16x16x32_bf16 v[24:27], v[172:175], a[176:179], v[24:27]
  ds_read_b128 v[188:191], v129 offset:8192
  s_waitcnt lgkmcnt(6)
  v_lshl_add_u32 v252, v252, 4, s60
  v_mfma_f32_16x16x32_bf16 v[44:47], v[176:179], a[176:179], v[44:47]
  v_accvgpr_write_b32 a247, v252
  v_add_u32 v3, 4, v2
  v_mfma_f32_16x16x32_bf16 v[44:47], v[152:155], a[156:159], v[44:47]
  ds_read_b128 v[168:171], v128 offset:10240
  buffer_load_dwordx4 v243, s[12:15], s43 offen offset:1024 lds
  v_cmp_le_u32 vcc, 5, v3
  v_mfma_f32_16x16x32_bf16 v[40:43], v[152:155], a[152:155], v[40:43]
  ds_read_b128 v[192:195], v129 offset:10240
  v_add_u32 v252, 24, v1
  v_mfma_f32_16x16x32_bf16 v[40:43], v[176:179], a[172:175], v[40:43]
  v_cmp_gt_u32 s[62:63], 10, v3
  v_mfma_f32_16x16x32_bf16 v[36:39], v[176:179], a[168:171], v[36:39]
  v_cndmask_b32 v253, 0, 20, vcc
  v_mfma_f32_16x16x32_bf16 v[36:39], v[152:155], a[148:151], v[36:39]
  v_sub_u32 v252, v252, v253
  v_mfma_f32_16x16x32_bf16 v[32:35], v[152:155], a[144:147], v[32:35]
  buffer_load_dwordx4 v244, s[12:15], s43 offen offset:2048 lds
  v_cmp_gt_u32 vcc, 20, v252
  v_mad_u32_u24 v252, v3, 21, v252
  v_mfma_f32_16x16x32_bf16 v[32:35], v[176:179], a[164:167], v[32:35]
  s_and_b64 vcc, vcc, s[62:63]
  v_mfma_f32_16x16x32_bf16 v[28:31], v[176:179], a[160:163], v[28:31]
  v_cndmask_b32 v252, v254, v252, vcc
  v_mfma_f32_16x16x32_bf16 v[28:31], v[152:155], a[140:143], v[28:31]
  s_waitcnt lgkmcnt(6)
  v_lshl_add_u32 v252, v252, 4, s60
  v_mfma_f32_16x16x32_bf16 v[48:51], v[156:159], a[140:143], v[48:51]
  v_accvgpr_write_b32 a248, v252
  v_mfma_f32_16x16x32_bf16 v[48:51], v[180:183], a[160:163], v[48:51]
  buffer_load_dwordx4 v245, s[12:15], s43 offen offset:3072 lds
  v_add_u32 v3, 8, v2
  v_mfma_f32_16x16x32_bf16 v[52:55], v[180:183], a[164:167], v[52:55]
  v_cmp_le_u32 vcc, 5, v3
  v_add_u32 v252, -8, v1
  v_mfma_f32_16x16x32_bf16 v[52:55], v[156:159], a[144:147], v[52:55]
  v_cmp_gt_u32 s[62:63], 10, v3
  v_mfma_f32_16x16x32_bf16 v[56:59], v[156:159], a[148:151], v[56:59]
  v_cndmask_b32 v253, 0, 20, vcc
  v_mfma_f32_16x16x32_bf16 v[56:59], v[180:183], a[168:171], v[56:59]
  s_add_u32 m0, s41, 49152
  v_sub_u32 v252, v252, v253
  v_mfma_f32_16x16x32_bf16 v[60:63], v[180:183], a[172:175], v[60:63]
  buffer_load_dwordx4 v246, s[12:15], s43 offen offset:0 lds
  v_cmp_eq_u32 vcc, 0, v1
  v_mfma_f32_16x16x32_bf16 v[60:63], v[156:159], a[152:155], v[60:63]
  s_cmp_le_u32 s54, 7
  s_cselect_b32 s44, 8, 7
  v_cndmask_b32 v253, v252, 0, vcc
  v_mfma_f32_16x16x32_bf16 v[64:67], v[156:159], a[156:159], v[64:67]
  s_lshl_b32 s42, s44, 7
  v_cndmask_b32 v252, v252, 20, vcc
  v_mfma_f32_16x16x32_bf16 v[64:67], v[180:183], a[176:179], v[64:67]
  s_mul_i32 s43, s44, s45
  s_waitcnt lgkmcnt(0)
  v_mfma_f32_16x16x32_bf16 v[84:87], v[160:163], a[156:159], v[84:87]
  v_mfma_f32_16x16x32_bf16 v[84:87], v[184:187], a[176:179], v[84:87]
  s_waitcnt vmcnt(11)
  s_barrier
  v_mfma_f32_16x16x32_bf16 v[80:83], v[184:187], a[172:175], v[80:83]
  ds_read_b128 v[148:151], v247 offset:0
  v_mfma_f32_16x16x32_bf16 v[80:83], v[160:163], a[152:155], v[80:83]
  ds_read_b128 v[172:175], v248 offset:0
  v_mfma_f32_16x16x32_bf16 v[76:79], v[160:163], a[148:151], v[76:79]
  ds_read_b64_tr_b16 v[196:197], v249 offset:0
  v_mfma_f32_16x16x32_bf16 v[76:79], v[184:187], a[168:171], v[76:79]
  ds_read_b64_tr_b16 v[198:199], v249 offset:1280
  s_add_u32 m0, s40, 90112
  v_mfma_f32_16x16x32_bf16 v[72:75], v[184:187], a[164:167], v[72:75]
  ds_read_b64_tr_b16 v[216:217], v249 offset:10240
  buffer_load_dwordx4 v236, s[8:11], s42 offen offset:0 lds
  v_mfma_f32_16x16x32_bf16 v[72:75], v[160:163], a[144:147], v[72:75]
  ds_read_b64_tr_b16 v[218:219], v249 offset:11520
  v_mfma_f32_16x16x32_bf16 v[68:71], v[160:163], a[140:143], v[68:71]
  ds_read_b64_tr_b16 v[200:201], v250 offset:0
  v_mfma_f32_16x16x32_bf16 v[68:71], v[184:187], a[160:163], v[68:71]
  ds_read_b64_tr_b16 v[202:203], v250 offset:1280
  v_mfma_f32_16x16x32_bf16 v[88:91], v[188:191], a[160:163], v[88:91]
  ds_read_b64_tr_b16 v[220:221], v250 offset:10240
  v_mfma_f32_16x16x32_bf16 v[88:91], v[164:167], a[140:143], v[88:91]
  ds_read_b64_tr_b16 v[222:223], v250 offset:11520
  buffer_load_dwordx4 v237, s[8:11], s42 offen offset:1024 lds
  v_mfma_f32_16x16x32_bf16 v[92:95], v[164:167], a[144:147], v[92:95]
  ds_read_b64_tr_b16 v[204:205], v249 offset:64
  v_mfma_f32_16x16x32_bf16 v[92:95], v[188:191], a[164:167], v[92:95]
  ds_read_b64_tr_b16 v[206:207], v249 offset:1344
  v_mfma_f32_16x16x32_bf16 v[96:99], v[188:191], a[168:171], v[96:99]
  ds_read_b64_tr_b16 v[224:225], v249 offset:10304
  v_mfma_f32_16x16x32_bf16 v[96:99], v[164:167], a[148:151], v[96:99]
  ds_read_b64_tr_b16 v[226:227], v249 offset:11584
  v_mfma_f32_16x16x32_bf16 v[100:103], v[164:167], a[152:155], v[100:103]
  ds_read_b64_tr_b16 v[208:209], v250 offset:64
  buffer_load_dwordx4 v238, s[8:11], s42 offen offset:2048 lds
  v_mfma_f32_16x16x32_bf16 v[100:103], v[188:191], a[172:175], v[100:103]
  ds_read_b64_tr_b16 v[210:211], v250 offset:1344
  v_mfma_f32_16x16x32_bf16 v[104:107], v[188:191], a[176:179], v[104:107]
  ds_read_b64_tr_b16 v[228:229], v250 offset:10304
  v_mfma_f32_16x16x32_bf16 v[104:107], v[164:167], a[156:159], v[104:107]
  ds_read_b64_tr_b16 v[230:231], v250 offset:11584
  v_mfma_f32_16x16x32_bf16 v[124:127], v[168:171], a[156:159], v[124:127]
  ds_read_b64_tr_b16 v[212:213], v251 offset:0
  v_mfma_f32_16x16x32_bf16 v[124:127], v[192:195], a[176:179], v[124:127]
  ds_read_b64_tr_b16 v[214:215], v251 offset:1280
  buffer_load_dwordx4 v239, s[8:11], s42 offen offset:3072 lds
  v_mfma_f32_16x16x32_bf16 v[120:123], v[192:195], a[172:175], v[120:123]
  ds_read_b64_tr_b16 v[232:233], v251 offset:10240
  v_mfma_f32_16x16x32_bf16 v[120:123], v[168:171], a[152:155], v[120:123]
  ds_read_b64_tr_b16 v[234:235], v251 offset:11520
  v_mfma_f32_16x16x32_bf16 v[116:119], v[168:171], a[148:151], v[116:119]
  v_mfma_f32_16x16x32_bf16 v[116:119], v[192:195], a[168:171], v[116:119]
  s_add_u32 m0, s40, 94208
  v_mfma_f32_16x16x32_bf16 v[112:115], v[192:195], a[164:167], v[112:115]
  buffer_load_dwordx4 v240, s[8:11], s42 offen offset:0 lds
  v_mfma_f32_16x16x32_bf16 v[112:115], v[168:171], a[144:147], v[112:115]
  v_mfma_f32_16x16x32_bf16 v[108:111], v[168:171], a[140:143], v[108:111]
  v_mfma_f32_16x16x32_bf16 v[108:111], v[192:195], a[160:163], v[108:111]
  s_waitcnt lgkmcnt(0)
  v_mfma_f32_16x16x32_bf16 v[8:11], v[148:151], v[196:199], v[8:11]
  ds_read_b128 v[152:155], v247 offset:2048
  v_mfma_f32_16x16x32_bf16 v[8:11], v[172:175], v[216:219], v[8:11]
  ds_read_b128 v[176:179], v248 offset:2048
  buffer_load_dwordx4 v241, s[8:11], s42 offen offset:1024 lds
  v_mfma_f32_16x16x32_bf16 v[12:15], v[172:175], v[220:223], v[12:15]
  ds_read_b128 v[156:159], v247 offset:4096
  v_mfma_f32_16x16x32_bf16 v[12:15], v[148:151], v[200:203], v[12:15]
  v_mfma_f32_16x16x32_bf16 v[16:19], v[148:151], v[204:207], v[16:19]
  ds_read_b128 v[180:183], v248 offset:4096
  v_cmp_gt_u32 vcc, 20, v253
  v_mad_u32_u24 v252, v3, 21, v252
  v_mfma_f32_16x16x32_bf16 v[16:19], v[172:175], v[224:227], v[16:19]
  ds_read_b128 v[160:163], v247 offset:6144
  s_add_u32 m0, s41, 90112
  s_and_b64 vcc, vcc, s[62:63]
  v_mfma_f32_16x16x32_bf16 v[20:23], v[172:175], v[228:231], v[20:23]
  buffer_load_dwordx4 v242, s[12:15], s43 offen offset:0 lds
  v_cndmask_b32 v252, v254, v252, vcc
  v_mfma_f32_16x16x32_bf16 v[20:23], v[148:151], v[208:211], v[20:23]
  ds_read_b128 v[184:187], v248 offset:6144
  v_lshl_add_u32 v252, v252, 4, s60
  v_mfma_f32_16x16x32_bf16 v[24:27], v[148:151], v[212:215], v[24:27]
  ds_read_b128 v[164:167], v247 offset:8192
  v_accvgpr_write_b32 a249, v252
  v_mfma_f32_16x16x32_bf16 v[24:27], v[172:175], v[232:235], v[24:27]
  ds_read_b128 v[188:191], v248 offset:8192
  s_waitcnt lgkmcnt(6)
  v_add_u32 v3, 8, v2
  v_cmp_le_u32 vcc, 5, v3
  v_mfma_f32_16x16x32_bf16 v[44:47], v[176:179], v[232:235], v[44:47]
  v_add_u32 v252, 8, v1
  v_mfma_f32_16x16x32_bf16 v[44:47], v[152:155], v[212:215], v[44:47]
  ds_read_b128 v[168:171], v247 offset:10240
  buffer_load_dwordx4 v243, s[12:15], s43 offen offset:1024 lds
  v_cmp_gt_u32 s[62:63], 10, v3
  v_mfma_f32_16x16x32_bf16 v[40:43], v[152:155], v[208:211], v[40:43]
  ds_read_b128 v[192:195], v248 offset:10240
  v_cndmask_b32 v253, 0, 20, vcc
  v_mfma_f32_16x16x32_bf16 v[40:43], v[176:179], v[228:231], v[40:43]
  v_sub_u32 v252, v252, v253
  v_mfma_f32_16x16x32_bf16 v[36:39], v[176:179], v[224:227], v[36:39]
  v_cmp_gt_u32 vcc, 20, v252
  v_mad_u32_u24 v252, v3, 21, v252
  v_mfma_f32_16x16x32_bf16 v[36:39], v[152:155], v[204:207], v[36:39]
  s_and_b64 vcc, vcc, s[62:63]
  v_mfma_f32_16x16x32_bf16 v[32:35], v[152:155], v[200:203], v[32:35]
  buffer_load_dwordx4 v244, s[12:15], s43 offen offset:2048 lds
  v_cndmask_b32 v252, v254, v252, vcc
  v_mfma_f32_16x16x32_bf16 v[32:35], v[176:179], v[220:223], v[32:35]
  v_lshl_add_u32 v252, v252, 4, s60
  v_mfma_f32_16x16x32_bf16 v[28:31], v[176:179], v[216:219], v[28:31]
  v_accvgpr_write_b32 a250, v252
  v_mfma_f32_16x16x32_bf16 v[28:31], v[152:155], v[196:199], v[28:31]
  s_waitcnt lgkmcnt(6)
  v_add_u32 v3, 8, v2
  v_cmp_le_u32 vcc, 5, v3
  v_mfma_f32_16x16x32_bf16 v[48:51], v[156:159], v[196:199], v[48:51]
  v_add_u32 v252, 24, v1
  v_mfma_f32_16x16x32_bf16 v[48:51], v[180:183], v[216:219], v[48:51]
  buffer_load_dwordx4 v245, s[12:15], s43 offen offset:3072 lds
  v_cmp_gt_u32 s[62:63], 10, v3
  v_mfma_f32_16x16x32_bf16 v[52:55], v[180:183], v[220:223], v[52:55]
  v_cndmask_b32 v253, 0, 20, vcc
  v_mfma_f32_16x16x32_bf16 v[52:55], v[156:159], v[200:203], v[52:55]
  v_sub_u32 v252, v252, v253
  v_mfma_f32_16x16x32_bf16 v[56:59], v[156:159], v[204:207], v[56:59]
  v_cmp_gt_u32 vcc, 20, v252
  v_mad_u32_u24 v252, v3, 21, v252
  v_mfma_f32_16x16x32_bf16 v[56:59], v[180:183], v[224:227], v[56:59]
  s_add_u32 m0, s41, 94208
  s_and_b64 vcc, vcc, s[62:63]
  v_mfma_f32_16x16x32_bf16 v[60:63], v[180:183], v[228:231], v[60:63]
  buffer_load_dwordx4 v246, s[12:15], s43 offen offset:0 lds
  v_cndmask_b32 v252, v254, v252, vcc
  v_mfma_f32_16x16x32_bf16 v[60:63], v[156:159], v[208:211], v[60:63]
  s_cmp_le_u32 s54, 8
  s_cselect_b32 s44, 9, 8
  v_lshl_add_u32 v252, v252, 4, s60
  v_mfma_f32_16x16x32_bf16 v[64:67], v[156:159], v[212:215], v[64:67]
  s_lshl_b32 s42, s44, 7
  v_accvgpr_write_b32 a251, v252
  v_mfma_f32_16x16x32_bf16 v[64:67], v[180:183], v[232:235], v[64:67]
  s_mul_i32 s43, s44, s45
  v_add_u32 v136, s50, v4
  v_min_u32 v136, 48336, v136
  s_cmp_gt_u32 s50, 48336
  s_cbranch_scc1 k_n_c2
  global_load_dwordx4 v[140:143], v136, s[0:1]
k_n_c2:
  s_waitcnt lgkmcnt(0)
  v_mfma_f32_16x16x32_bf16 v[84:87], v[160:163], v[212:215], v[84:87]
  v_mfma_f32_16x16x32_bf16 v[84:87], v[184:187], v[232:235], v[84:87]
  s_waitcnt vmcnt(11)
  s_barrier
  v_mfma_f32_16x16x32_bf16 v[80:83], v[184:187], v[228:231], v[80:83]
  ds_read_b128 v[148:151], v247 offset:45056
  v_lshlrev_b32 v6, 4, v0
  v_mfma_f32_16x16x32_bf16 v[80:83], v[160:163], v[208:211], v[80:83]
  ds_read_b128 v[172:175], v248 offset:45056
  v_add_u32 v6, 32768, v6
  v_mfma_f32_16x16x32_bf16 v[76:79], v[160:163], v[204:207], v[76:79]
  ds_read_b64_tr_b16 a[140:141], v249 offset:45056
  buffer_load_dword v255, v6, s[16:19], 0 offen sc1
  v_mfma_f32_16x16x32_bf16 v[76:79], v[184:187], v[224:227], v[76:79]
  ds_read_b64_tr_b16 a[142:143], v249 offset:46336
  s_add_u32 m0, s40, 0
  v_mfma_f32_16x16x32_bf16 v[72:75], v[184:187], v[220:223], v[72:75]
  ds_read_b64_tr_b16 a[160:161], v249 offset:55296
  buffer_load_dwordx4 v236, s[8:11], s42 offen offset:0 lds
  v_mfma_f32_16x16x32_bf16 v[72:75], v[160:163], v[200:203], v[72:75]
  ds_read_b64_tr_b16 a[162:163], v249 offset:56576
  v_mfma_f32_16x16x32_bf16 v[68:71], v[160:163], v[196:199], v[68:71]
  ds_read_b64_tr_b16 a[144:145], v250 offset:45056
  v_mfma_f32_16x16x32_bf16 v[68:71], v[184:187], v[216:219], v[68:71]
  ds_read_b64_tr_b16 a[146:147], v250 offset:46336
  v_mfma_f32_16x16x32_bf16 v[88:91], v[188:191], v[216:219], v[88:91]
  ds_read_b64_tr_b16 a[164:165], v250 offset:55296
  v_mfma_f32_16x16x32_bf16 v[88:91], v[164:167], v[196:199], v[88:91]
  ds_read_b64_tr_b16 a[166:167], v250 offset:56576
  buffer_load_dwordx4 v237, s[8:11], s42 offen offset:1024 lds
  v_mfma_f32_16x16x32_bf16 v[92:95], v[164:167], v[200:203], v[92:95]
  ds_read_b64_tr_b16 a[148:149], v249 offset:45120
  v_mfma_f32_16x16x32_bf16 v[92:95], v[188:191], v[220:223], v[92:95]
  ds_read_b64_tr_b16 a[150:151], v249 offset:46400
  v_mfma_f32_16x16x32_bf16 v[96:99], v[188:191], v[224:227], v[96:99]
  ds_read_b64_tr_b16 a[168:169], v249 offset:55360
  v_mfma_f32_16x16x32_bf16 v[96:99], v[164:167], v[204:207], v[96:99]
  ds_read_b64_tr_b16 a[170:171], v249 offset:56640
  v_mfma_f32_16x16x32_bf16 v[100:103], v[164:167], v[208:211], v[100:103]
  ds_read_b64_tr_b16 a[152:153], v250 offset:45120
  buffer_load_dwordx4 v238, s[8:11], s42 offen offset:2048 lds
  v_mfma_f32_16x16x32_bf16 v[100:103], v[188:191], v[228:231], v[100:103]
  ds_read_b64_tr_b16 a[154:155], v250 offset:46400
  v_mfma_f32_16x16x32_bf16 v[104:107], v[188:191], v[232:235], v[104:107]
  ds_read_b64_tr_b16 a[172:173], v250 offset:55360
  v_mfma_f32_16x16x32_bf16 v[104:107], v[164:167], v[212:215], v[104:107]
  ds_read_b64_tr_b16 a[174:175], v250 offset:56640
  v_mfma_f32_16x16x32_bf16 v[124:127], v[168:171], v[212:215], v[124:127]
  ds_read_b64_tr_b16 a[156:157], v251 offset:45056
  v_mfma_f32_16x16x32_bf16 v[124:127], v[192:195], v[232:235], v[124:127]
  ds_read_b64_tr_b16 a[158:159], v251 offset:46336
  buffer_load_dwordx4 v239, s[8:11], s42 offen offset:3072 lds
  v_mfma_f32_16x16x32_bf16 v[120:123], v[192:195], v[228:231], v[120:123]
  ds_read_b64_tr_b16 a[176:177], v251 offset:55296
  v_mfma_f32_16x16x32_bf16 v[120:123], v[168:171], v[208:211], v[120:123]
  ds_read_b64_tr_b16 a[178:179], v251 offset:56576
  v_mfma_f32_16x16x32_bf16 v[116:119], v[168:171], v[204:207], v[116:119]
  v_mfma_f32_16x16x32_bf16 v[116:119], v[192:195], v[224:227], v[116:119]
  s_add_u32 m0, s40, 4096
  v_mfma_f32_16x16x32_bf16 v[112:115], v[192:195], v[220:223], v[112:115]
  buffer_load_dwordx4 v240, s[8:11], s42 offen offset:0 lds
  v_mfma_f32_16x16x32_bf16 v[112:115], v[168:171], v[200:203], v[112:115]
  v_mfma_f32_16x16x32_bf16 v[108:111], v[168:171], v[196:199], v[108:111]
  v_mfma_f32_16x16x32_bf16 v[108:111], v[192:195], v[216:219], v[108:111]
  s_waitcnt lgkmcnt(0)
  v_mfma_f32_16x16x32_bf16 v[8:11], v[148:151], a[140:143], v[8:11]
  ds_read_b128 v[152:155], v247 offset:47104
  v_mfma_f32_16x16x32_bf16 v[8:11], v[172:175], a[160:163], v[8:11]
  ds_read_b128 v[176:179], v248 offset:47104
  buffer_load_dwordx4 v241, s[8:11], s42 offen offset:1024 lds
  v_mfma_f32_16x16x32_bf16 v[12:15], v[172:175], a[164:167], v[12:15]
  ds_read_b128 v[156:159], v247 offset:49152
  v_mfma_f32_16x16x32_bf16 v[12:15], v[148:151], a[144:147], v[12:15]
  v_mfma_f32_16x16x32_bf16 v[16:19], v[148:151], a[148:151], v[16:19]
  ds_read_b128 v[180:183], v248 offset:49152
  v_mfma_f32_16x16x32_bf16 v[16:19], v[172:175], a[168:171], v[16:19]
  ds_read_b128 v[160:163], v247 offset:51200
  s_add_u32 m0, s41, 0
  v_mfma_f32_16x16x32_bf16 v[20:23], v[172:175], a[172:175], v[20:23]
  buffer_load_dwordx4 v242, s[12:15], s43 offen offset:0 lds
  v_mfma_f32_16x16x32_bf16 v[20:23], v[148:151], a[152:155], v[20:23]
  ds_read_b128 v[184:187], v248 offset:51200
  v_mfma_f32_16x16x32_bf16 v[24:27], v[148:151], a[156:159], v[24:27]
  ds_read_b128 v[164:167], v247 offset:53248
  v_mfma_f32_16x16x32_bf16 v[24:27], v[172:175], a[176:179], v[24:27]
  ds_read_b128 v[188:191], v248 offset:53248
  s_waitcnt lgkmcnt(6)
  v_mfma_f32_16x16x32_bf16 v[44:47], v[176:179], a[176:179], v[44:47]
  v_mfma_f32_16x16x32_bf16 v[44:47], v[152:155], a[156:159], v[44:47]
  ds_read_b128 v[168:171], v247 offset:55296
  buffer_load_dwordx4 v243, s[12:15], s43 offen offset:1024 lds
  v_mfma_f32_16x16x32_bf16 v[40:43], v[152:155], a[152:155], v[40:43]
  ds_read_b128 v[192:195], v248 offset:55296
  v_mfma_f32_16x16x32_bf16 v[40:43], v[176:179], a[172:175], v[40:43]
  v_mfma_f32_16x16x32_bf16 v[36:39], v[176:179], a[168:171], v[36:39]
  v_mfma_f32_16x16x32_bf16 v[36:39], v[152:155], a[148:151], v[36:39]
  v_lshlrev_b32 v3, 4, v0
  v_mfma_f32_16x16x32_bf16 v[32:35], v[152:155], a[144:147], v[32:35]
  buffer_load_dwordx4 v244, s[12:15], s43 offen offset:2048 lds
  v_add_u32 v252, s74, v3
  v_mfma_f32_16x16x32_bf16 v[32:35], v[176:179], a[164:167], v[32:35]
  v_add_u32 v253, 4096, v252
  v_mfma_f32_16x16x32_bf16 v[28:31], v[176:179], a[160:163], v[28:31]
  v_cmp_le_u32 vcc, 144, v0
  v_mfma_f32_16x16x32_bf16 v[28:31], v[152:155], a[140:143], v[28:31]
  s_waitcnt lgkmcnt(6)
  v_add_u32 v3, s65, v3
  v_mfma_f32_16x16x32_bf16 v[48:51], v[156:159], a[140:143], v[48:51]
  v_cmp_le_u32 s[28:29], s66, v0
  v_mfma_f32_16x16x32_bf16 v[48:51], v[180:183], a[160:163], v[48:51]
  buffer_load_dwordx4 v245, s[12:15], s43 offen offset:3072 lds
  v_cndmask_b32 v253, v253, v3, vcc
  v_mfma_f32_16x16x32_bf16 v[52:55], v[180:183], a[164:167], v[52:55]
  v_add_u32 v3, 7424, v3
  v_mfma_f32_16x16x32_bf16 v[52:55], v[156:159], a[144:147], v[52:55]
  v_cmp_le_u32 vcc, 240, v0
  v_mfma_f32_16x16x32_bf16 v[56:59], v[156:159], a[148:151], v[56:59]
  v_cndmask_b32 v253, v253, v3, s[28:29]
  v_mfma_f32_16x16x32_bf16 v[56:59], v[180:183], a[168:171], v[56:59]
  s_add_u32 m0, s41, 4096
  v_mov_b32 v3, 1073741824
  v_mfma_f32_16x16x32_bf16 v[60:63], v[180:183], a[172:175], v[60:63]
  buffer_load_dwordx4 v246, s[12:15], s43 offen offset:0 lds
  v_cndmask_b32 v253, v253, v3, vcc
  v_mfma_f32_16x16x32_bf16 v[60:63], v[156:159], a[152:155], v[60:63]
  v_and_b32 v1, 15, v7
  v_mfma_f32_16x16x32_bf16 v[64:67], v[156:159], a[156:159], v[64:67]
  v_lshrrev_b32 v2, 4, v7
  v_mfma_f32_16x16x32_bf16 v[64:67], v[180:183], a[176:179], v[64:67]
  s_waitcnt lgkmcnt(0)
  v_mfma_f32_16x16x32_bf16 v[84:87], v[160:163], a[156:159], v[84:87]
  v_mfma_f32_16x16x32_bf16 v[84:87], v[184:187], a[176:179], v[84:87]
  s_waitcnt vmcnt(11)
  v_cmp_ne_u32 vcc, s39, v255
  s_nop 1
  s_cmp_lg_u64 vcc, 0
  s_cbranch_scc1 k_n_sa_slow
k_n_sa_ok:
  s_barrier
  v_mfma_f32_16x16x32_bf16 v[80:83], v[184:187], a[172:175], v[80:83]
  ds_read_b128 v[148:151], v128 offset:0
  v_mov_b32 v146, 819200
  s_mov_b32 m0, s72
  s_nop 0
  buffer_load_dwordx4 v252, s[16:19], 0 offen sc1 lds
  v_mfma_f32_16x16x32_bf16 v[80:83], v[160:163], a[152:155], v[80:83]
  ds_read_b128 v[172:175], v129 offset:0
  buffer_load_dword v147, v146, s[16:19], 0 offen sc1
  s_add_u32 m0, s72, 4096
  s_nop 0
  buffer_load_dwordx4 v253, s[16:19], 0 offen sc1 lds
  v_mfma_f32_16x16x32_bf16 v[76:79], v[160:163], a[148:151], v[76:79]
  ds_read_b64_tr_b16 v[196:197], v130 offset:0
  v_mov_b32 v3, s39
  v_lshlrev_b32 v6, 25, v7
  buffer_store_dword v3, v6, s[16:19], s73 offen sc1
  v_mfma_f32_16x16x32_bf16 v[76:79], v[184:187], a[168:171], v[76:79]
  ds_read_b64_tr_b16 v[198:199], v130 offset:1280
  s_add_u32 s68, s46, 0
  v_mfma_f32_16x16x32_bf16 v[72:75], v[184:187], a[164:167], v[72:75]
  ds_read_b64_tr_b16 v[216:217], v130 offset:10240
  v_mfma_f32_16x16x32_bf16 v[72:75], v[160:163], a[144:147], v[72:75]
  ds_read_b64_tr_b16 v[218:219], v130 offset:11520
  v_mfma_f32_16x16x32_bf16 v[68:71], v[160:163], a[140:143], v[68:71]
  ds_read_b64_tr_b16 v[200:201], v131 offset:0
  v_mfma_f32_16x16x32_bf16 v[68:71], v[184:187], a[160:163], v[68:71]
  ds_read_b64_tr_b16 v[202:203], v131 offset:1280
  v_mfma_f32_16x16x32_bf16 v[88:91], v[188:191], a[160:163], v[88:91]
  ds_read_b64_tr_b16 v[220:221], v131 offset:10240
  buffer_load_dwordx4 a[0:3], v4, s[16:19], s68 offen offset:0 sc1
  v_mfma_f32_16x16x32_bf16 v[88:91], v[164:167], a[140:143], v[88:91]
  ds_read_b64_tr_b16 v[222:223], v131 offset:11520
  v_mfma_f32_16x16x32_bf16 v[92:95], v[164:167], a[144:147], v[92:95]
  ds_read_b64_tr_b16 v[204:205], v130 offset:64
  v_mfma_f32_16x16x32_bf16 v[92:95], v[188:191], a[164:167], v[92:95]
  ds_read_b64_tr_b16 v[206:207], v130 offset:1344
  v_mfma_f32_16x16x32_bf16 v[96:99], v[188:191], a[168:171], v[96:99]
  ds_read_b64_tr_b16 v[224:225], v130 offset:10304
  v_mfma_f32_16x16x32_bf16 v[96:99], v[164:167], a[148:151], v[96:99]
  ds_read_b64_tr_b16 v[226:227], v130 offset:11584
  buffer_load_dwordx4 a[4:7], v4, s[16:19], s68 offen offset:1024 sc1
  v_mfma_f32_16x16x32_bf16 v[100:103], v[164:167], a[152:155], v[100:103]
  ds_read_b64_tr_b16 v[208:209], v131 offset:64
  v_mfma_f32_16x16x32_bf16 v[100:103], v[188:191], a[172:175], v[100:103]
  ds_read_b64_tr_b16 v[210:211], v131 offset:1344
  v_mfma_f32_16x16x32_bf16 v[104:107], v[188:191], a[176:179], v[104:107]
  ds_read_b64_tr_b16 v[228:229], v131 offset:10304
  v_mfma_f32_16x16x32_bf16 v[104:107], v[164:167], a[156:159], v[104:107]
  ds_read_b64_tr_b16 v[230:231], v131 offset:11584
  v_mfma_f32_16x16x32_bf16 v[124:127], v[168:171], a[156:159], v[124:127]
  ds_read_b64_tr_b16 v[212:213], v132 offset:0
  buffer_load_dwordx4 a[8:11], v4, s[16:19], s68 offen offset:2048 sc1
  v_mfma_f32_16x16x32_bf16 v[124:127], v[192:195], a[176:179], v[124:127]
  ds_read_b64_tr_b16 v[214:215], v132 offset:1280
  v_mfma_f32_16x16x32_bf16 v[120:123], v[192:195], a[172:175], v[120:123]
  ds_read_b64_tr_b16 v[232:233], v132 offset:10240
  v_mfma_f32_16x16x32_bf16 v[120:123], v[168:171], a[152:155], v[120:123]
  ds_read_b64_tr_b16 v[234:235], v132 offset:11520
  v_mfma_f32_16x16x32_bf16 v[116:119], v[168:171], a[148:151], v[116:119]
  v_mfma_f32_16x16x32_bf16 v[116:119], v[192:195], a[168:171], v[116:119]
  buffer_load_dwordx4 a[12:15], v4, s[16:19], s68 offen offset:3072 sc1
  v_mfma_f32_16x16x32_bf16 v[112:115], v[192:195], a[164:167], v[112:115]
  v_mfma_f32_16x16x32_bf16 v[112:115], v[168:171], a[144:147], v[112:115]
  v_mfma_f32_16x16x32_bf16 v[108:111], v[168:171], a[140:143], v[108:111]
  v_mfma_f32_16x16x32_bf16 v[108:111], v[192:195], a[160:163], v[108:111]
  s_waitcnt lgkmcnt(0)
  v_mfma_f32_16x16x32_bf16 v[8:11], v[148:151], v[196:199], v[8:11]
  ds_read_b128 v[152:155], v128 offset:2048
  v_mfma_f32_16x16x32_bf16 v[8:11], v[172:175], v[216:219], v[8:11]
  ds_read_b128 v[176:179], v129 offset:2048
  v_mfma_f32_16x16x32_bf16 v[12:15], v[172:175], v[220:223], v[12:15]
  ds_read_b128 v[156:159], v128 offset:4096
  v_mfma_f32_16x16x32_bf16 v[12:15], v[148:151], v[200:203], v[12:15]
  s_add_u32 s68, s46, 0
  v_mfma_f32_16x16x32_bf16 v[16:19], v[148:151], v[204:207], v[16:19]
  ds_read_b128 v[180:183], v129 offset:4096
  v_mfma_f32_16x16x32_bf16 v[16:19], v[172:175], v[224:227], v[16:19]
  ds_read_b128 v[160:163], v128 offset:6144
  v_mfma_f32_16x16x32_bf16 v[20:23], v[172:175], v[228:231], v[20:23]
  buffer_load_dwordx4 a[16:19], v5, s[16:19], s68 offen sc1
  v_mfma_f32_16x16x32_bf16 v[20:23], v[148:151], v[208:211], v[20:23]
  ds_read_b128 v[184:187], v129 offset:6144
  v_mfma_f32_16x16x32_bf16 v[24:27], v[148:151], v[212:215], v[24:27]
  ds_read_b128 v[164:167], v128 offset:8192
  v_mfma_f32_16x16x32_bf16 v[24:27], v[172:175], v[232:235], v[24:27]
  ds_read_b128 v[188:191], v129 offset:8192
  s_waitcnt lgkmcnt(6)
  s_add_u32 s68, s46, 131072
  v_mfma_f32_16x16x32_bf16 v[44:47], v[176:179], v[232:235], v[44:47]
  v_mfma_f32_16x16x32_bf16 v[44:47], v[152:155], v[212:215], v[44:47]
  ds_read_b128 v[168:171], v128 offset:10240
  v_mfma_f32_16x16x32_bf16 v[40:43], v[152:155], v[208:211], v[40:43]
  ds_read_b128 v[192:195], v129 offset:10240
  buffer_load_dwordx4 a[20:23], v4, s[16:19], s68 offen offset:0 sc1
  v_mfma_f32_16x16x32_bf16 v[40:43], v[176:179], v[228:231], v[40:43]
  v_mfma_f32_16x16x32_bf16 v[36:39], v[176:179], v[224:227], v[36:39]
  v_mfma_f32_16x16x32_bf16 v[36:39], v[152:155], v[204:207], v[36:39]
  buffer_load_dwordx4 a[24:27], v4, s[16:19], s68 offen offset:1024 sc1
  v_mfma_f32_16x16x32_bf16 v[32:35], v[152:155], v[200:203], v[32:35]
  v_mfma_f32_16x16x32_bf16 v[32:35], v[176:179], v[220:223], v[32:35]
  v_mfma_f32_16x16x32_bf16 v[28:31], v[176:179], v[216:219], v[28:31]
  s_mov_b32 s30, 1069066811
  buffer_load_dwordx4 a[28:31], v4, s[16:19], s68 offen offset:2048 sc1
  v_mfma_f32_16x16x32_bf16 v[28:31], v[152:155], v[196:199], v[28:31]
  s_waitcnt lgkmcnt(6)
  s_mov_b32 s31, 1069066811
  v_mfma_f32_16x16x32_bf16 v[48:51], v[156:159], v[196:199], v[48:51]
  v_accvgpr_read_b32 v240, a244
  v_mfma_f32_16x16x32_bf16 v[48:51], v[180:183], v[216:219], v[48:51]
  v_accvgpr_read_b32 v241, a245
  buffer_load_dwordx4 a[32:35], v4, s[16:19], s68 offen offset:3072 sc1
  v_mfma_f32_16x16x32_bf16 v[52:55], v[180:183], v[220:223], v[52:55]
  v_accvgpr_read_b32 v242, a246
  v_mfma_f32_16x16x32_bf16 v[52:55], v[156:159], v[200:203], v[52:55]
  v_accvgpr_read_b32 v243, a247
  v_mfma_f32_16x16x32_bf16 v[56:59], v[156:159], v[204:207], v[56:59]
  v_accvgpr_read_b32 v244, a248
  buffer_load_dwordx4 a[36:39], v5, s[16:19], s68 offen sc1
  v_mfma_f32_16x16x32_bf16 v[56:59], v[180:183], v[224:227], v[56:59]
  v_accvgpr_read_b32 v245, a249
  v_mfma_f32_16x16x32_bf16 v[60:63], v[180:183], v[228:231], v[60:63]
  v_accvgpr_read_b32 v246, a250
  v_mfma_f32_16x16x32_bf16 v[60:63], v[156:159], v[208:211], v[60:63]
  v_accvgpr_read_b32 v255, a251
  v_mfma_f32_16x16x32_bf16 v[64:67], v[156:159], v[212:215], v[64:67]
  v_mfma_f32_16x16x32_bf16 v[64:67], v[180:183], v[232:235], v[64:67]
  s_waitcnt lgkmcnt(0)
  v_mfma_f32_16x16x32_bf16 v[84:87], v[160:163], v[212:215], v[84:87]
  v_mfma_f32_16x16x32_bf16 v[84:87], v[184:187], v[232:235], v[84:87]
  s_waitcnt vmcnt(11)
  s_barrier
  v_mfma_f32_16x16x32_bf16 v[80:83], v[184:187], v[228:231], v[80:83]
  ds_read_b128 v[148:151], v247 offset:0
  v_mfma_f32_16x16x32_bf16 v[80:83], v[160:163], v[208:211], v[80:83]
  ds_read_b128 v[172:175], v248 offset:0
  v_mfma_f32_16x16x32_bf16 v[76:79], v[160:163], v[204:207], v[76:79]
  ds_read_b64_tr_b16 a[140:141], v249 offset:0
  v_mfma_f32_16x16x32_bf16 v[76:79], v[184:187], v[224:227], v[76:79]
  ds_read_b64_tr_b16 a[142:143], v249 offset:1280
  s_add_u32 s68, s46, 262144
  v_mfma_f32_16x16x32_bf16 v[72:75], v[184:187], v[220:223], v[72:75]
  ds_read_b64_tr_b16 a[160:161], v249 offset:10240
  v_mfma_f32_16x16x32_bf16 v[72:75], v[160:163], v[200:203], v[72:75]
  ds_read_b64_tr_b16 a[162:163], v249 offset:11520
  v_mfma_f32_16x16x32_bf16 v[68:71], v[160:163], v[196:199], v[68:71]
  ds_read_b64_tr_b16 a[144:145], v250 offset:0
  v_mfma_f32_16x16x32_bf16 v[68:71], v[184:187], v[216:219], v[68:71]
  ds_read_b64_tr_b16 a[146:147], v250 offset:1280
  v_mfma_f32_16x16x32_bf16 v[88:91], v[188:191], v[216:219], v[88:91]
  ds_read_b64_tr_b16 a[164:165], v250 offset:10240
  buffer_load_dwordx4 a[40:43], v4, s[16:19], s68 offen offset:0 sc1
  v_mfma_f32_16x16x32_bf16 v[88:91], v[164:167], v[196:199], v[88:91]
  ds_read_b64_tr_b16 a[166:167], v250 offset:11520
  v_mfma_f32_16x16x32_bf16 v[92:95], v[164:167], v[200:203], v[92:95]
  ds_read_b64_tr_b16 a[148:149], v249 offset:64
  v_mfma_f32_16x16x32_bf16 v[92:95], v[188:191], v[220:223], v[92:95]
  ds_read_b64_tr_b16 a[150:151], v249 offset:1344
  v_mfma_f32_16x16x32_bf16 v[96:99], v[188:191], v[224:227], v[96:99]
  ds_read_b64_tr_b16 a[168:169], v249 offset:10304
  v_mfma_f32_16x16x32_bf16 v[96:99], v[164:167], v[204:207], v[96:99]
  ds_read_b64_tr_b16 a[170:171], v249 offset:11584
  buffer_load_dwordx4 a[44:47], v4, s[16:19], s68 offen offset:1024 sc1
  v_mfma_f32_16x16x32_bf16 v[100:103], v[164:167], v[208:211], v[100:103]
  ds_read_b64_tr_b16 a[152:153], v250 offset:64
  v_mfma_f32_16x16x32_bf16 v[100:103], v[188:191], v[228:231], v[100:103]
  ds_read_b64_tr_b16 a[154:155], v250 offset:1344
  v_mfma_f32_16x16x32_bf16 v[104:107], v[188:191], v[232:235], v[104:107]
  ds_read_b64_tr_b16 a[172:173], v250 offset:10304
  v_mfma_f32_16x16x32_bf16 v[104:107], v[164:167], v[212:215], v[104:107]
  ds_read_b64_tr_b16 a[174:175], v250 offset:11584
  v_mfma_f32_16x16x32_bf16 v[124:127], v[168:171], v[212:215], v[124:127]
  ds_read_b64_tr_b16 a[156:157], v251 offset:0
  buffer_load_dwordx4 a[48:51], v4, s[16:19], s68 offen offset:2048 sc1
  v_mfma_f32_16x16x32_bf16 v[124:127], v[192:195], v[232:235], v[124:127]
  ds_read_b64_tr_b16 a[158:159], v251 offset:1280
  v_mfma_f32_16x16x32_bf16 v[120:123], v[192:195], v[228:231], v[120:123]
  ds_read_b64_tr_b16 a[176:177], v251 offset:10240
  v_mfma_f32_16x16x32_bf16 v[120:123], v[168:171], v[208:211], v[120:123]
  ds_read_b64_tr_b16 a[178:179], v251 offset:11520
  v_mfma_f32_16x16x32_bf16 v[116:119], v[168:171], v[204:207], v[116:119]
  v_readfirstlane_b32 s3, v147
  v_mfma_f32_16x16x32_bf16 v[116:119], v[192:195], v[224:227], v[116:119]
  s_xor_b32 s3, s3, s39
  buffer_load_dwordx4 a[52:55], v4, s[16:19], s68 offen offset:3072 sc1
  v_mfma_f32_16x16x32_bf16 v[112:115], v[192:195], v[220:223], v[112:115]
  s_and_b32 s38, s3, 4294959103
  s_cbranch_scc1 k_n_pw
k_n_pwr:
  v_mfma_f32_16x16x32_bf16 v[112:115], v[168:171], v[200:203], v[112:115]
  s_xor_b32 s80, s80, s3
  v_mfma_f32_16x16x32_bf16 v[108:111], v[168:171], v[196:199], v[108:111]
  s_xor_b32 s81, s81, s3
  v_mfma_f32_16x16x32_bf16 v[108:111], v[192:195], v[216:219], v[108:111]
  s_xor_b32 s82, s82, s3
  s_waitcnt lgkmcnt(0)
  v_mfma_f32_16x16x32_bf16 v[8:11], v[148:151], a[140:143], v[8:11]
  ds_read_b128 v[152:155], v247 offset:2048
  v_lshlrev_b32 v252, 2, v0
  v_add_u32 v252, 135168, v252
  v_mfma_f32_16x16x32_bf16 v[8:11], v[172:175], a[160:163], v[8:11]
  ds_read_b128 v[176:179], v248 offset:2048
  ds_read_b32 v128, v252 offset:0
  v_mfma_f32_16x16x32_bf16 v[12:15], v[172:175], a[164:167], v[12:15]
  ds_read_b128 v[156:159], v247 offset:4096
  ds_read_b32 v129, v252 offset:640
  v_mfma_f32_16x16x32_bf16 v[12:15], v[148:151], a[144:147], v[12:15]
  ds_read_b32 v130, v252 offset:1280
  s_add_u32 s68, s46, 262144
  v_mfma_f32_16x16x32_bf16 v[16:19], v[148:151], a[148:151], v[16:19]
  ds_read_b128 v[180:183], v248 offset:4096
  ds_read_b32 v131, v252 offset:1920
  v_mfma_f32_16x16x32_bf16 v[16:19], v[172:175], a[168:171], v[16:19]
  ds_read_b128 v[160:163], v247 offset:6144
  ds_read_b32 v132, v252 offset:2560
  ds_read_b32 v133, v252 offset:3200
  v_mfma_f32_16x16x32_bf16 v[20:23], v[172:175], a[172:175], v[20:23]
  ds_read_b32 v134, v252 offset:3840
  buffer_load_dwordx4 a[56:59], v5, s[16:19], s68 offen sc1
  v_mfma_f32_16x16x32_bf16 v[20:23], v[148:151], a[152:155], v[20:23]
  ds_read_b128 v[184:187], v248 offset:6144
  ds_read_b32 v135, v252 offset:4480
  v_mfma_f32_16x16x32_bf16 v[24:27], v[148:151], a[156:159], v[24:27]
  ds_read_b128 v[164:167], v247 offset:8192
  ds_read_b32 v136, v252 offset:5120
  v_mfma_f32_16x16x32_bf16 v[24:27], v[172:175], a[176:179], v[24:27]
  ds_read_b128 v[188:191], v248 offset:8192
  s_waitcnt lgkmcnt(15)
  ds_read_b32 v137, v252 offset:5760
  s_add_u32 s68, s46, 393216
  v_mfma_f32_16x16x32_bf16 v[44:47], v[176:179], a[176:179], v[44:47]
  v_mfma_f32_16x16x32_bf16 v[44:47], v[152:155], a[156:159], v[44:47]
  ds_read_b128 v[168:171], v247 offset:10240
  v_mfma_f32_16x16x32_bf16 v[40:43], v[152:155], a[152:155], v[40:43]
  ds_read_b128 v[192:195], v248 offset:10240
  buffer_load_dwordx4 a[60:63], v4, s[16:19], s68 offen offset:0 sc1
  v_mfma_f32_16x16x32_bf16 v[40:43], v[176:179], a[172:175], v[40:43]
  v_mfma_f32_16x16x32_bf16 v[36:39], v[176:179], a[168:171], v[36:39]
  v_mfma_f32_16x16x32_bf16 v[36:39], v[152:155], a[148:151], v[36:39]
  s_waitcnt lgkmcnt(2)
  buffer_load_dwordx4 a[64:67], v4, s[16:19], s68 offen offset:1024 sc1
  v_mfma_f32_16x16x32_bf16 v[32:35], v[152:155], a[144:147], v[32:35]
  v_add_f32 v128, v128, v129
  v_mfma_f32_16x16x32_bf16 v[32:35], v[176:179], a[164:167], v[32:35]
  v_add_f32 v128, v128, v130
  v_mfma_f32_16x16x32_bf16 v[28:31], v[176:179], a[160:163], v[28:31]
  v_add_f32 v128, v128, v131
  buffer_load_dwordx4 a[68:71], v4, s[16:19], s68 offen offset:2048 sc1
  v_mfma_f32_16x16x32_bf16 v[28:31], v[152:155], a[140:143], v[28:31]
  s_waitcnt lgkmcnt(13)
  v_add_f32 v128, v128, v132
  v_mfma_f32_16x16x32_bf16 v[48:51], v[156:159], a[140:143], v[48:51]
  v_add_f32 v128, v128, v133
  v_mfma_f32_16x16x32_bf16 v[48:51], v[180:183], a[160:163], v[48:51]
  v_add_f32 v128, v128, v134
  buffer_load_dwordx4 a[72:75], v4, s[16:19], s68 offen offset:3072 sc1
  v_mfma_f32_16x16x32_bf16 v[52:55], v[180:183], a[164:167], v[52:55]
  v_add_f32 v128, v128, v135
  v_mfma_f32_16x16x32_bf16 v[52:55], v[156:159], a[144:147], v[52:55]
  v_add_f32 v128, v128, v136
  v_mfma_f32_16x16x32_bf16 v[56:59], v[156:159], a[148:151], v[56:59]
  v_add_f32 v128, v128, v137
  buffer_load_dwordx4 a[76:79], v5, s[16:19], s68 offen sc1
  v_mfma_f32_16x16x32_bf16 v[56:59], v[180:183], a[168:171], v[56:59]
  ds_write_b32 v252, v128 offset:8192
  v_mfma_f32_16x16x32_bf16 v[60:63], v[180:183], a[172:175], v[60:63]
  v_mfma_f32_16x16x32_bf16 v[60:63], v[156:159], a[152:155], v[60:63]
  v_mfma_f32_16x16x32_bf16 v[64:67], v[156:159], a[156:159], v[64:67]
  v_mfma_f32_16x16x32_bf16 v[64:67], v[180:183], a[176:179], v[64:67]
  s_waitcnt lgkmcnt(0)
  v_mfma_f32_16x16x32_bf16 v[84:87], v[160:163], a[156:159], v[84:87]
  v_mfma_f32_16x16x32_bf16 v[84:87], v[184:187], a[176:179], v[84:87]
  s_barrier
  v_mfma_f32_16x16x32_bf16 v[80:83], v[184:187], a[172:175], v[80:83]
  s_mul_i32 s28, s51, 384
  v_mfma_f32_16x16x32_bf16 v[80:83], v[160:163], a[152:155], v[80:83]
  s_add_u32 s28, s28, 141568
  v_mfma_f32_16x16x32_bf16 v[76:79], v[160:163], a[148:151], v[76:79]
  v_lshlrev_b32 v6, 2, v1
  v_mfma_f32_16x16x32_bf16 v[76:79], v[184:187], a[168:171], v[76:79]
  v_add_u32 v252, s34, v6
  s_add_u32 s68, s46, 524288
  v_mfma_f32_16x16x32_bf16 v[72:75], v[184:187], a[164:167], v[72:75]
  v_lshl_add_u32 v3, v2, 4, s28
  v_mfma_f32_16x16x32_bf16 v[72:75], v[160:163], a[144:147], v[72:75]
  ds_read_b32 v128, v252 offset:0
  v_mfma_f32_16x16x32_bf16 v[68:71], v[160:163], a[140:143], v[68:71]
  ds_read_b32 v132, v252 offset:64
  buffer_load_dwordx4 a[80:83], v4, s[16:19], s68 offen offset:0 sc1
  v_mfma_f32_16x16x32_bf16 v[68:71], v[184:187], a[160:163], v[68:71]
  ds_read_b32 v136, v252 offset:128
  v_mfma_f32_16x16x32_bf16 v[88:91], v[188:191], a[160:163], v[88:91]
  ds_read_b32 v140, v252 offset:192
  v_mfma_f32_16x16x32_bf16 v[88:91], v[164:167], a[140:143], v[88:91]
  ds_read_b32 v144, v252 offset:256
  buffer_load_dwordx4 a[84:87], v4, s[16:19], s68 offen offset:1024 sc1
  v_mfma_f32_16x16x32_bf16 v[92:95], v[164:167], a[144:147], v[92:95]
  ds_read_b128 v[196:199], v3 offset:0
  v_mfma_f32_16x16x32_bf16 v[92:95], v[188:191], a[164:167], v[92:95]
  ds_read_b128 v[200:203], v3 offset:64
  v_mfma_f32_16x16x32_bf16 v[96:99], v[188:191], a[168:171], v[96:99]
  ds_read_b128 v[204:207], v3 offset:128
  buffer_load_dwordx4 a[88:91], v4, s[16:19], s68 offen offset:2048 sc1
  v_mfma_f32_16x16x32_bf16 v[96:99], v[164:167], a[148:151], v[96:99]
  ds_read_b128 v[208:211], v3 offset:192
  v_mfma_f32_16x16x32_bf16 v[100:103], v[164:167], a[152:155], v[100:103]
  ds_read_b128 v[212:215], v3 offset:256
  v_mfma_f32_16x16x32_bf16 v[100:103], v[188:191], a[172:175], v[100:103]
  ds_read_b128 v[216:219], v3 offset:320
  buffer_load_dwordx4 a[92:95], v4, s[16:19], s68 offen offset:3072 sc1
  v_mfma_f32_16x16x32_bf16 v[104:107], v[188:191], a[176:179], v[104:107]
  ds_read_b128 v[220:223], v3 offset:768
  v_mfma_f32_16x16x32_bf16 v[104:107], v[164:167], a[156:159], v[104:107]
  ds_read_b128 v[224:227], v3 offset:832
  v_mfma_f32_16x16x32_bf16 v[124:127], v[168:171], a[156:159], v[124:127]
  ds_read_b128 v[228:231], v3 offset:896
  buffer_load_dwordx4 a[96:99], v5, s[16:19], s68 offen sc1
  v_mfma_f32_16x16x32_bf16 v[124:127], v[192:195], a[176:179], v[124:127]
  ds_read_b128 v[232:235], v3 offset:960
  v_mfma_f32_16x16x32_bf16 v[120:123], v[192:195], a[172:175], v[120:123]
  ds_read_b128 v[236:239], v3 offset:1024
  v_mfma_f32_16x16x32_bf16 v[120:123], v[168:171], a[152:155], v[120:123]
  ds_read_b128 v[148:151], v3 offset:1088
  s_add_u32 s68, s46, 655360
  v_mfma_f32_16x16x32_bf16 v[116:119], v[168:171], a[148:151], v[116:119]
  v_mfma_f32_16x16x32_bf16 v[116:119], v[192:195], a[168:171], v[116:119]
  v_mfma_f32_16x16x32_bf16 v[112:115], v[192:195], a[164:167], v[112:115]
  buffer_load_dwordx4 a[100:103], v4, s[16:19], s68 offen offset:0 sc1
  v_mfma_f32_16x16x32_bf16 v[112:115], v[168:171], a[144:147], v[112:115]
  v_mfma_f32_16x16x32_bf16 v[108:111], v[168:171], a[140:143], v[108:111]
  v_mfma_f32_16x16x32_bf16 v[108:111], v[192:195], a[160:163], v[108:111]
  v_mov_b32 v164, 0x358637bd
  v_mov_b32 v165, 0x358637bd
  v_mov_b32 v166, 0x3f803f80
  s_waitcnt lgkmcnt(0)
  v_pk_fma_f32 v[8:9], v[196:197], v[128:129], v[8:9] op_sel_hi:[1,0,1]
  v_pk_fma_f32 v[10:11], v[198:199], v[128:129], v[10:11] op_sel_hi:[1,0,1]
  s_add_u32 s68, s46, 655360
  buffer_load_dwordx4 a[104:107], v4, s[16:19], s68 offen offset:1024 sc1
  v_pk_fma_f32 v[12:13], v[196:197], v[132:133], v[12:13] op_sel_hi:[1,0,1]
  v_pk_fma_f32 v[14:15], v[198:199], v[132:133], v[14:15] op_sel_hi:[1,0,1]
  v_pk_fma_f32 v[16:17], v[196:197], v[136:137], v[16:17] op_sel_hi:[1,0,1]
  v_pk_fma_f32 v[18:19], v[198:199], v[136:137], v[18:19] op_sel_hi:[1,0,1]
  v_pk_fma_f32 v[20:21], v[196:197], v[140:141], v[20:21] op_sel_hi:[1,0,1]
  v_pk_fma_f32 v[22:23], v[198:199], v[140:141], v[22:23] op_sel_hi:[1,0,1]
  v_pk_fma_f32 v[24:25], v[196:197], v[144:145], v[24:25] op_sel_hi:[1,0,1]
  v_pk_fma_f32 v[26:27], v[198:199], v[144:145], v[26:27] op_sel_hi:[1,0,1]
  v_pk_mul_f32 v[8:9], v[8:9], v[220:221]
  v_pk_mul_f32 v[10:11], v[10:11], v[222:223]
  v_pk_mul_f32 v[12:13], v[12:13], v[220:221]
  v_pk_mul_f32 v[14:15], v[14:15], v[222:223]
  buffer_load_dwordx4 a[108:111], v4, s[16:19], s68 offen offset:2048 sc1
  v_pk_mul_f32 v[16:17], v[16:17], v[220:221]
  v_pk_mul_f32 v[18:19], v[18:19], v[222:223]
  v_pk_mul_f32 v[20:21], v[20:21], v[220:221]
  v_pk_mul_f32 v[22:23], v[22:23], v[222:223]
  v_pk_mul_f32 v[24:25], v[24:25], v[220:221]
  v_pk_mul_f32 v[26:27], v[26:27], v[222:223]
  v_pk_mul_f32 v[152:153], v[8:9], s[30:31]
  v_pk_mul_f32 v[154:155], v[10:11], s[30:31]
  v_pk_mul_f32 v[156:157], v[12:13], s[30:31]
  v_pk_mul_f32 v[158:159], v[14:15], s[30:31]
  v_pk_mul_f32 v[160:161], v[16:17], s[30:31]
  v_pk_mul_f32 v[162:163], v[18:19], s[30:31]
  buffer_load_dwordx4 a[112:115], v4, s[16:19], s68 offen offset:3072 sc1
  v_exp_f32_e64 v152, v152 clamp
  v_exp_f32_e64 v153, v153 clamp
  v_exp_f32_e64 v154, v154 clamp
  v_exp_f32_e64 v155, v155 clamp
  v_exp_f32_e64 v156, v156 clamp
  v_exp_f32_e64 v157, v157 clamp
  v_exp_f32_e64 v158, v158 clamp
  v_exp_f32_e64 v159, v159 clamp
  v_exp_f32_e64 v160, v160 clamp
  v_exp_f32_e64 v161, v161 clamp
  v_exp_f32_e64 v162, v162 clamp
  v_exp_f32_e64 v163, v163 clamp
  v_cvt_pk_bf16_f32 v184, v16, v17
  buffer_load_dwordx4 a[116:119], v5, s[16:19], s68 offen sc1
  v_cvt_pk_bf16_f32 v185, v18, v19
  v_cvt_pk_bf16_f32 v188, v20, v21
  v_cvt_pk_bf16_f32 v189, v22, v23
  v_cvt_pk_bf16_f32 v192, v24, v25
  v_cvt_pk_bf16_f32 v193, v26, v27
  v_cndmask_b32 v184, v184, v166, s[32:33]
  v_cndmask_b32 v185, v185, v166, s[32:33]
  v_pk_add_f32 v[8:9], v[8:9], 1.0 op_sel_hi:[1,0]
  v_pk_add_f32 v[10:11], v[10:11], 1.0 op_sel_hi:[1,0]
  v_pk_add_f32 v[12:13], v[12:13], 1.0 op_sel_hi:[1,0]
  v_pk_add_f32 v[14:15], v[14:15], 1.0 op_sel_hi:[1,0]
  v_pk_add_f32 v[16:17], v[16:17], 1.0 op_sel_hi:[1,0]
  s_add_u32 s68, s46, 786432
  s_cmp_lt_u32 s20, 3
  s_cselect_b32 s68, s68, 1073741824
  buffer_load_dwordx4 a[120:123], v4, s[16:19], s68 offen offset:0 sc1
  v_pk_add_f32 v[18:19], v[18:19], 1.0 op_sel_hi:[1,0]
  v_max_f32 v8, v8, v152
  v_max_f32 v9, v9, v153
  v_max_f32 v10, v10, v154
  v_max_f32 v11, v11, v155
  v_max_f32 v12, v12, v156
  v_max_f32 v13, v13, v157
  v_max_f32 v14, v14, v158
  v_max_f32 v15, v15, v159
  v_max_f32 v16, v16, v160
  v_max_f32 v17, v17, v161
  v_max_f32_e64 v18, v18, v162
  buffer_load_dwordx4 a[124:127], v4, s[16:19], s68 offen offset:1024 sc1
  v_max_f32_e64 v19, v19, v163
  v_pk_add_f32 v[8:9], v[8:9], v[164:165]
  v_pk_add_f32 v[10:11], v[10:11], v[164:165]
  v_pk_add_f32 v[12:13], v[12:13], v[164:165]
  v_pk_add_f32 v[14:15], v[14:15], v[164:165]
  v_pk_add_f32 v[16:17], v[16:17], v[164:165]
  v_pk_add_f32 v[18:19], v[18:19], v[164:165]
  v_cvt_pk_bf16_f32 v172, v8, v9
  v_cvt_pk_bf16_f32 v173, v10, v11
  v_cvt_pk_bf16_f32 v176, v12, v13
  v_cvt_pk_bf16_f32 v177, v14, v15
  v_cvt_pk_bf16_f32 v180, v16, v17
  v_cvt_pk_bf16_f32 v181, v18, v19
  v_pk_fma_f32 v[28:29], v[200:201], v[128:129], v[28:29] op_sel_hi:[1,0,1]
  v_pk_fma_f32 v[30:31], v[202:203], v[128:129], v[30:31] op_sel_hi:[1,0,1]
  buffer_load_dwordx4 a[128:131], v4, s[16:19], s68 offen offset:2048 sc1
  v_pk_fma_f32 v[32:33], v[200:201], v[132:133], v[32:33] op_sel_hi:[1,0,1]
  v_pk_fma_f32 v[34:35], v[202:203], v[132:133], v[34:35] op_sel_hi:[1,0,1]
  v_pk_fma_f32 v[36:37], v[200:201], v[136:137], v[36:37] op_sel_hi:[1,0,1]
  v_pk_fma_f32 v[38:39], v[202:203], v[136:137], v[38:39] op_sel_hi:[1,0,1]
  v_pk_fma_f32 v[40:41], v[200:201], v[140:141], v[40:41] op_sel_hi:[1,0,1]
  v_pk_fma_f32 v[42:43], v[202:203], v[140:141], v[42:43] op_sel_hi:[1,0,1]
  v_pk_fma_f32 v[44:45], v[200:201], v[144:145], v[44:45] op_sel_hi:[1,0,1]
  v_pk_fma_f32 v[46:47], v[202:203], v[144:145], v[46:47] op_sel_hi:[1,0,1]
  v_pk_mul_f32 v[28:29], v[28:29], v[224:225]
  v_pk_mul_f32 v[30:31], v[30:31], v[226:227]
  v_pk_mul_f32 v[32:33], v[32:33], v[224:225]
  v_pk_mul_f32 v[34:35], v[34:35], v[226:227]
  v_pk_mul_f32 v[36:37], v[36:37], v[224:225]
  v_pk_mul_f32 v[38:39], v[38:39], v[226:227]
  buffer_load_dwordx4 a[132:135], v4, s[16:19], s68 offen offset:3072 sc1
  v_pk_mul_f32 v[40:41], v[40:41], v[224:225]
  v_pk_mul_f32 v[42:43], v[42:43], v[226:227]
  v_pk_mul_f32 v[44:45], v[44:45], v[224:225]
  v_pk_mul_f32 v[46:47], v[46:47], v[226:227]
  v_pk_mul_f32 v[152:153], v[28:29], s[30:31]
  v_pk_mul_f32 v[154:155], v[30:31], s[30:31]
  v_pk_mul_f32 v[156:157], v[32:33], s[30:31]
  v_pk_mul_f32 v[158:159], v[34:35], s[30:31]
  v_pk_mul_f32 v[160:161], v[36:37], s[30:31]
  v_pk_mul_f32 v[162:163], v[38:39], s[30:31]
  v_exp_f32_e64 v152, v152 clamp
  v_exp_f32_e64 v153, v153 clamp
  v_exp_f32_e64 v154, v154 clamp
  v_exp_f32_e64 v155, v155 clamp
  v_exp_f32_e64 v156, v156 clamp
  buffer_load_dwordx4 a[136:139], v5, s[16:19], s68 offen sc1
  v_exp_f32_e64 v157, v157 clamp
  v_exp_f32_e64 v158, v158 clamp
  v_exp_f32_e64 v159, v159 clamp
  v_exp_f32_e64 v160, v160 clamp
  v_exp_f32_e64 v161, v161 clamp
  v_exp_f32_e64 v162, v162 clamp
  v_exp_f32_e64 v163, v163 clamp
  v_cvt_pk_bf16_f32 v186, v36, v37
  v_cvt_pk_bf16_f32 v187, v38, v39
  v_cvt_pk_bf16_f32 v190, v40, v41
  v_cvt_pk_bf16_f32 v191, v42, v43
  v_cvt_pk_bf16_f32 v194, v44, v45
  v_cvt_pk_bf16_f32 v195, v46, v47
  v_cndmask_b32 v186, v186, v166, s[32:33]
  v_cndmask_b32 v187, v187, v166, s[32:33]
  s_add_u32 m0, s69, 0
  s_add_u32 s71, s70, 0
  buffer_load_dwordx4 v4, s[16:19], s71 offen offset:0 sc1 lds
  v_pk_add_f32 v[28:29], v[28:29], 1.0 op_sel_hi:[1,0]
  v_pk_add_f32 v[30:31], v[30:31], 1.0 op_sel_hi:[1,0]
  v_pk_add_f32 v[32:33], v[32:33], 1.0 op_sel_hi:[1,0]
  v_pk_add_f32 v[34:35], v[34:35], 1.0 op_sel_hi:[1,0]
  v_pk_add_f32 v[36:37], v[36:37], 1.0 op_sel_hi:[1,0]
  v_pk_add_f32 v[38:39], v[38:39], 1.0 op_sel_hi:[1,0]
  v_max_f32 v28, v28, v152
  v_max_f32 v29, v29, v153
  v_max_f32 v30, v30, v154
  v_max_f32 v31, v31, v155
  v_max_f32 v32, v32, v156
  v_max_f32 v33, v33, v157
  v_max_f32 v34, v34, v158
  v_max_f32 v35, v35, v159
  v_max_f32_e64 v36, v36, v160
  buffer_load_dwordx4 v4, s[16:19], s71 offen offset:1024 sc1 lds
  v_max_f32 v37, v37, v161
  v_max_f32 v38, v38, v162
  v_max_f32_e64 v39, v39, v163
  v_pk_add_f32 v[28:29], v[28:29], v[164:165]
  v_pk_add_f32 v[30:31], v[30:31], v[164:165]
  v_pk_add_f32 v[32:33], v[32:33], v[164:165]
  v_pk_add_f32 v[34:35], v[34:35], v[164:165]
  v_pk_add_f32 v[36:37], v[36:37], v[164:165]
  v_pk_add_f32 v[38:39], v[38:39], v[164:165]
  v_cvt_pk_bf16_f32 v174, v28, v29
  v_cvt_pk_bf16_f32 v175, v30, v31
  v_cvt_pk_bf16_f32 v178, v32, v33
  v_cvt_pk_bf16_f32 v179, v34, v35
  v_cvt_pk_bf16_f32 v182, v36, v37
  v_cvt_pk_bf16_f32 v183, v38, v39
  v_mfma_f32_16x16x32_bf16 v[8:11], v[172:175], v[184:187], 0
  v_mfma_f32_16x16x32_bf16 v[12:15], v[172:175], v[188:191], 0
  v_mfma_f32_16x16x32_bf16 v[16:19], v[176:179], v[184:187], 0
  v_mfma_f32_16x16x32_bf16 v[20:23], v[176:179], v[188:191], 0
  v_mfma_f32_16x16x32_bf16 v[24:27], v[176:179], v[192:195], 0
  v_mfma_f32_16x16x32_bf16 v[28:31], v[180:183], v[184:187], 0
  v_mfma_f32_16x16x32_bf16 v[32:35], v[180:183], v[188:191], 0
  v_mfma_f32_16x16x32_bf16 v[36:39], v[180:183], v[192:195], 0
  v_pk_fma_f32 v[48:49], v[204:205], v[128:129], v[48:49] op_sel_hi:[1,0,1]
  v_pk_fma_f32 v[50:51], v[206:207], v[128:129], v[50:51] op_sel_hi:[1,0,1]
  buffer_load_dwordx4 v4, s[16:19], s71 offen offset:2048 sc1 lds
  v_pk_fma_f32 v[52:53], v[204:205], v[132:133], v[52:53] op_sel_hi:[1,0,1]
  v_pk_fma_f32 v[54:55], v[206:207], v[132:133], v[54:55] op_sel_hi:[1,0,1]
  v_pk_fma_f32 v[56:57], v[204:205], v[136:137], v[56:57] op_sel_hi:[1,0,1]
  v_pk_fma_f32 v[58:59], v[206:207], v[136:137], v[58:59] op_sel_hi:[1,0,1]
  v_pk_fma_f32 v[60:61], v[204:205], v[140:141], v[60:61] op_sel_hi:[1,0,1]
  v_pk_fma_f32 v[62:63], v[206:207], v[140:141], v[62:63] op_sel_hi:[1,0,1]
  v_pk_fma_f32 v[64:65], v[204:205], v[144:145], v[64:65] op_sel_hi:[1,0,1]
  v_pk_fma_f32 v[66:67], v[206:207], v[144:145], v[66:67] op_sel_hi:[1,0,1]
  v_pk_mul_f32 v[48:49], v[48:49], v[228:229]
  v_pk_mul_f32 v[50:51], v[50:51], v[230:231]
  v_pk_mul_f32 v[52:53], v[52:53], v[228:229]
  v_pk_mul_f32 v[54:55], v[54:55], v[230:231]
  v_pk_mul_f32 v[56:57], v[56:57], v[228:229]
  v_pk_mul_f32 v[58:59], v[58:59], v[230:231]
  buffer_load_dwordx4 v4, s[16:19], s71 offen offset:3072 sc1 lds
  v_pk_mul_f32 v[60:61], v[60:61], v[228:229]
  v_pk_mul_f32 v[62:63], v[62:63], v[230:231]
  v_pk_mul_f32 v[64:65], v[64:65], v[228:229]
  v_pk_mul_f32 v[66:67], v[66:67], v[230:231]
  v_pk_mul_f32 v[152:153], v[48:49], s[30:31]
  v_pk_mul_f32 v[154:155], v[50:51], s[30:31]
  v_pk_mul_f32 v[156:157], v[52:53], s[30:31]
  v_pk_mul_f32 v[158:159], v[54:55], s[30:31]
  v_pk_mul_f32 v[160:161], v[56:57], s[30:31]
  v_pk_mul_f32 v[162:163], v[58:59], s[30:31]
  v_exp_f32_e64 v152, v152 clamp
  v_exp_f32_e64 v153, v153 clamp
  v_exp_f32_e64 v154, v154 clamp
  v_exp_f32_e64 v155, v155 clamp
  v_exp_f32_e64 v156, v156 clamp
  s_add_u32 m0, s69, 4096
  s_add_u32 s71, s70, 0
  s_nop 0
  buffer_load_dwordx4 v5, s[16:19], s71 offen offset:0 sc1 lds
  v_exp_f32_e64 v157, v157 clamp
  v_exp_f32_e64 v158, v158 clamp
  v_exp_f32_e64 v159, v159 clamp
  v_exp_f32_e64 v160, v160 clamp
  v_exp_f32_e64 v161, v161 clamp
  v_exp_f32_e64 v162, v162 clamp
  v_exp_f32_e64 v163, v163 clamp
  v_cvt_pk_bf16_f32 v184, v56, v57
  v_cvt_pk_bf16_f32 v185, v58, v59
  v_cvt_pk_bf16_f32 v188, v60, v61
  v_cvt_pk_bf16_f32 v189, v62, v63
  v_cvt_pk_bf16_f32 v192, v64, v65
  v_cvt_pk_bf16_f32 v193, v66, v67
  v_cndmask_b32 v184, v184, v166, s[32:33]
  v_cndmask_b32 v185, v185, v166, s[32:33]
  s_add_u32 m0, s69, 20480
  s_add_u32 s71, s70, 65536
  buffer_load_dwordx4 v4, s[16:19], s71 offen offset:0 sc1 lds
  v_pk_add_f32 v[48:49], v[48:49], 1.0 op_sel_hi:[1,0]
  v_pk_add_f32 v[50:51], v[50:51], 1.0 op_sel_hi:[1,0]
  v_pk_add_f32 v[52:53], v[52:53], 1.0 op_sel_hi:[1,0]
  v_pk_add_f32 v[54:55], v[54:55], 1.0 op_sel_hi:[1,0]
  v_pk_add_f32 v[56:57], v[56:57], 1.0 op_sel_hi:[1,0]
  v_pk_add_f32 v[58:59], v[58:59], 1.0 op_sel_hi:[1,0]
  v_max_f32 v48, v48, v152
  v_max_f32 v49, v49, v153
  v_max_f32 v50, v50, v154
  v_max_f32 v51, v51, v155
  v_max_f32 v52, v52, v156
  v_max_f32 v53, v53, v157
  v_max_f32 v54, v54, v158
  v_max_f32 v55, v55, v159
  v_max_f32_e64 v56, v56, v160
  buffer_load_dwordx4 v4, s[16:19], s71 offen offset:1024 sc1 lds
  v_max_f32 v57, v57, v161
  v_max_f32 v58, v58, v162
  v_max_f32_e64 v59, v59, v163
  v_pk_add_f32 v[48:49], v[48:49], v[164:165]
  v_pk_add_f32 v[50:51], v[50:51], v[164:165]
  v_pk_add_f32 v[52:53], v[52:53], v[164:165]
  v_pk_add_f32 v[54:55], v[54:55], v[164:165]
  v_pk_add_f32 v[56:57], v[56:57], v[164:165]
  v_pk_add_f32 v[58:59], v[58:59], v[164:165]
  v_cvt_pk_bf16_f32 v172, v48, v49
  v_cvt_pk_bf16_f32 v173, v50, v51
  v_cvt_pk_bf16_f32 v176, v52, v53
  v_cvt_pk_bf16_f32 v177, v54, v55
  v_cvt_pk_bf16_f32 v180, v56, v57
  v_cvt_pk_bf16_f32 v181, v58, v59
  v_pk_fma_f32 v[68:69], v[208:209], v[128:129], v[68:69] op_sel_hi:[1,0,1]
  v_pk_fma_f32 v[70:71], v[210:211], v[128:129], v[70:71] op_sel_hi:[1,0,1]
  buffer_load_dwordx4 v4, s[16:19], s71 offen offset:2048 sc1 lds
  v_pk_fma_f32 v[72:73], v[208:209], v[132:133], v[72:73] op_sel_hi:[1,0,1]
  v_pk_fma_f32 v[74:75], v[210:211], v[132:133], v[74:75] op_sel_hi:[1,0,1]
  v_pk_fma_f32 v[76:77], v[208:209], v[136:137], v[76:77] op_sel_hi:[1,0,1]
  v_pk_fma_f32 v[78:79], v[210:211], v[136:137], v[78:79] op_sel_hi:[1,0,1]
  v_pk_fma_f32 v[80:81], v[208:209], v[140:141], v[80:81] op_sel_hi:[1,0,1]
  v_pk_fma_f32 v[82:83], v[210:211], v[140:141], v[82:83] op_sel_hi:[1,0,1]
  v_pk_fma_f32 v[84:85], v[208:209], v[144:145], v[84:85] op_sel_hi:[1,0,1]
  v_pk_fma_f32 v[86:87], v[210:211], v[144:145], v[86:87] op_sel_hi:[1,0,1]
  v_pk_mul_f32 v[68:69], v[68:69], v[232:233]
  v_pk_mul_f32 v[70:71], v[70:71], v[234:235]
  v_pk_mul_f32 v[72:73], v[72:73], v[232:233]
  v_pk_mul_f32 v[74:75], v[74:75], v[234:235]
  v_pk_mul_f32 v[76:77], v[76:77], v[232:233]
  v_pk_mul_f32 v[78:79], v[78:79], v[234:235]
  buffer_load_dwordx4 v4, s[16:19], s71 offen offset:3072 sc1 lds
  v_pk_mul_f32 v[80:81], v[80:81], v[232:233]
  v_pk_mul_f32 v[82:83], v[82:83], v[234:235]
  v_pk_mul_f32 v[84:85], v[84:85], v[232:233]
  v_pk_mul_f32 v[86:87], v[86:87], v[234:235]
  v_pk_mul_f32 v[152:153], v[68:69], s[30:31]
  v_pk_mul_f32 v[154:155], v[70:71], s[30:31]
  v_pk_mul_f32 v[156:157], v[72:73], s[30:31]
  v_pk_mul_f32 v[158:159], v[74:75], s[30:31]
  v_pk_mul_f32 v[160:161], v[76:77], s[30:31]
  v_pk_mul_f32 v[162:163], v[78:79], s[30:31]
  v_exp_f32_e64 v152, v152 clamp
  v_exp_f32_e64 v153, v153 clamp
  v_exp_f32_e64 v154, v154 clamp
  v_exp_f32_e64 v155, v155 clamp
  v_exp_f32_e64 v156, v156 clamp
  s_add_u32 m0, s69, 24576
  s_add_u32 s71, s70, 65536
  buffer_load_dwordx4 v5, s[16:19], s71 offen offset:0 sc1 lds
  v_exp_f32_e64 v157, v157 clamp
  v_exp_f32_e64 v158, v158 clamp
  v_exp_f32_e64 v159, v159 clamp
  v_exp_f32_e64 v160, v160 clamp
  v_exp_f32_e64 v161, v161 clamp
  v_exp_f32_e64 v162, v162 clamp
  v_exp_f32_e64 v163, v163 clamp
  v_cvt_pk_bf16_f32 v186, v76, v77
  v_cvt_pk_bf16_f32 v187, v78, v79
  v_cvt_pk_bf16_f32 v190, v80, v81
  v_cvt_pk_bf16_f32 v191, v82, v83
  v_cvt_pk_bf16_f32 v194, v84, v85
  v_cvt_pk_bf16_f32 v195, v86, v87
  v_cndmask_b32 v186, v186, v166, s[32:33]
  v_cndmask_b32 v187, v187, v166, s[32:33]
  s_add_u32 m0, s69, 40960
  s_add_u32 s71, s70, 131072
  buffer_load_dwordx4 v4, s[16:19], s71 offen offset:0 sc1 lds
  v_pk_add_f32 v[68:69], v[68:69], 1.0 op_sel_hi:[1,0]
  v_pk_add_f32 v[70:71], v[70:71], 1.0 op_sel_hi:[1,0]
  v_pk_add_f32 v[72:73], v[72:73], 1.0 op_sel_hi:[1,0]
  v_pk_add_f32 v[74:75], v[74:75], 1.0 op_sel_hi:[1,0]
  v_pk_add_f32 v[76:77], v[76:77], 1.0 op_sel_hi:[1,0]
  v_pk_add_f32 v[78:79], v[78:79], 1.0 op_sel_hi:[1,0]
  v_max_f32 v68, v68, v152
  v_max_f32 v69, v69, v153
  v_max_f32 v70, v70, v154
  v_max_f32 v71, v71, v155
  v_max_f32 v72, v72, v156
  v_max_f32 v73, v73, v157
  v_max_f32 v74, v74, v158
  v_max_f32 v75, v75, v159
  v_max_f32_e64 v76, v76, v160
  buffer_load_dwordx4 v4, s[16:19], s71 offen offset:1024 sc1 lds
  v_max_f32 v77, v77, v161
  v_max_f32 v78, v78, v162
  v_max_f32_e64 v79, v79, v163
  v_pk_add_f32 v[68:69], v[68:69], v[164:165]
  v_pk_add_f32 v[70:71], v[70:71], v[164:165]
  v_pk_add_f32 v[72:73], v[72:73], v[164:165]
  v_pk_add_f32 v[74:75], v[74:75], v[164:165]
  v_pk_add_f32 v[76:77], v[76:77], v[164:165]
  v_pk_add_f32 v[78:79], v[78:79], v[164:165]
  v_cvt_pk_bf16_f32 v174, v68, v69
  v_cvt_pk_bf16_f32 v175, v70, v71
  v_cvt_pk_bf16_f32 v178, v72, v73
  v_cvt_pk_bf16_f32 v179, v74, v75
  v_cvt_pk_bf16_f32 v182, v76, v77
  v_cvt_pk_bf16_f32 v183, v78, v79
  s_cmp_eq_u32 s36, 1
  s_cbranch_scc1 k_kvs1
  v_mfma_f32_16x16x32_bf16 v[8:11], v[172:175], v[184:187], v[8:11]
  v_mfma_f32_16x16x32_bf16 v[12:15], v[172:175], v[188:191], v[12:15]
  v_mfma_f32_16x16x32_bf16 v[16:19], v[176:179], v[184:187], v[16:19]
  v_mfma_f32_16x16x32_bf16 v[20:23], v[176:179], v[188:191], v[20:23]
  v_mfma_f32_16x16x32_bf16 v[24:27], v[176:179], v[192:195], v[24:27]
  v_mfma_f32_16x16x32_bf16 v[28:31], v[180:183], v[184:187], v[28:31]
  v_mfma_f32_16x16x32_bf16 v[32:35], v[180:183], v[188:191], v[32:35]
  v_mfma_f32_16x16x32_bf16 v[36:39], v[180:183], v[192:195], v[36:39]
k_kvs1:
  v_pk_fma_f32 v[88:89], v[212:213], v[128:129], v[88:89] op_sel_hi:[1,0,1]
  v_pk_fma_f32 v[90:91], v[214:215], v[128:129], v[90:91] op_sel_hi:[1,0,1]
  buffer_load_dwordx4 v4, s[16:19], s71 offen offset:2048 sc1 lds
  v_pk_fma_f32 v[92:93], v[212:213], v[132:133], v[92:93] op_sel_hi:[1,0,1]
  v_pk_fma_f32 v[94:95], v[214:215], v[132:133], v[94:95] op_sel_hi:[1,0,1]
  v_pk_fma_f32 v[96:97], v[212:213], v[136:137], v[96:97] op_sel_hi:[1,0,1]
  v_pk_fma_f32 v[98:99], v[214:215], v[136:137], v[98:99] op_sel_hi:[1,0,1]
  v_pk_fma_f32 v[100:101], v[212:213], v[140:141], v[100:101] op_sel_hi:[1,0,1]
  v_pk_fma_f32 v[102:103], v[214:215], v[140:141], v[102:103] op_sel_hi:[1,0,1]
  v_pk_fma_f32 v[104:105], v[212:213], v[144:145], v[104:105] op_sel_hi:[1,0,1]
  v_pk_fma_f32 v[106:107], v[214:215], v[144:145], v[106:107] op_sel_hi:[1,0,1]
  v_pk_mul_f32 v[88:89], v[88:89], v[236:237]
  v_pk_mul_f32 v[90:91], v[90:91], v[238:239]
  v_pk_mul_f32 v[92:93], v[92:93], v[236:237]
  v_pk_mul_f32 v[94:95], v[94:95], v[238:239]
  v_pk_mul_f32 v[96:97], v[96:97], v[236:237]
  v_pk_mul_f32 v[98:99], v[98:99], v[238:239]
  buffer_load_dwordx4 v4, s[16:19], s71 offen offset:3072 sc1 lds
  v_pk_mul_f32 v[100:101], v[100:101], v[236:237]
  v_pk_mul_f32 v[102:103], v[102:103], v[238:239]
  v_pk_mul_f32 v[104:105], v[104:105], v[236:237]
  v_pk_mul_f32 v[106:107], v[106:107], v[238:239]
  v_pk_mul_f32 v[152:153], v[88:89], s[30:31]
  v_pk_mul_f32 v[154:155], v[90:91], s[30:31]
  v_pk_mul_f32 v[156:157], v[92:93], s[30:31]
  v_pk_mul_f32 v[158:159], v[94:95], s[30:31]
  v_pk_mul_f32 v[160:161], v[96:97], s[30:31]
  v_pk_mul_f32 v[162:163], v[98:99], s[30:31]
  v_exp_f32_e64 v152, v152 clamp
  v_exp_f32_e64 v153, v153 clamp
  v_exp_f32_e64 v154, v154 clamp
  v_exp_f32_e64 v155, v155 clamp
  v_exp_f32_e64 v156, v156 clamp
  s_add_u32 m0, s69, 45056
  s_add_u32 s71, s70, 131072
  buffer_load_dwordx4 v5, s[16:19], s71 offen offset:0 sc1 lds
  v_exp_f32_e64 v157, v157 clamp
  v_exp_f32_e64 v158, v158 clamp
  v_exp_f32_e64 v159, v159 clamp
  v_exp_f32_e64 v160, v160 clamp
  v_exp_f32_e64 v161, v161 clamp
  v_exp_f32_e64 v162, v162 clamp
  v_exp_f32_e64 v163, v163 clamp
  v_cvt_pk_bf16_f32 v184, v96, v97
  v_cvt_pk_bf16_f32 v185, v98, v99
  v_cvt_pk_bf16_f32 v188, v100, v101
  v_cvt_pk_bf16_f32 v189, v102, v103
  v_cvt_pk_bf16_f32 v192, v104, v105
  v_cvt_pk_bf16_f32 v193, v106, v107
  v_cndmask_b32 v184, v184, v166, s[32:33]
  v_cndmask_b32 v185, v185, v166, s[32:33]
  s_add_u32 m0, s69, 61440
  s_add_u32 s71, s70, 196608
  buffer_load_dwordx4 v4, s[16:19], s71 offen offset:0 sc1 lds
  v_pk_add_f32 v[88:89], v[88:89], 1.0 op_sel_hi:[1,0]
  v_pk_add_f32 v[90:91], v[90:91], 1.0 op_sel_hi:[1,0]
  v_pk_add_f32 v[92:93], v[92:93], 1.0 op_sel_hi:[1,0]
  v_pk_add_f32 v[94:95], v[94:95], 1.0 op_sel_hi:[1,0]
  v_pk_add_f32 v[96:97], v[96:97], 1.0 op_sel_hi:[1,0]
  v_pk_add_f32 v[98:99], v[98:99], 1.0 op_sel_hi:[1,0]
  v_max_f32 v88, v88, v152
  v_max_f32 v89, v89, v153
  v_max_f32 v90, v90, v154
  v_max_f32 v91, v91, v155
  v_max_f32 v92, v92, v156
  v_max_f32 v93, v93, v157
  v_max_f32 v94, v94, v158
  v_max_f32 v95, v95, v159
  v_max_f32_e64 v96, v96, v160
  buffer_load_dwordx4 v4, s[16:19], s71 offen offset:1024 sc1 lds
  v_max_f32 v97, v97, v161
  v_max_f32 v98, v98, v162
  v_max_f32_e64 v99, v99, v163
  v_pk_add_f32 v[88:89], v[88:89], v[164:165]
  v_pk_add_f32 v[90:91], v[90:91], v[164:165]
  v_pk_add_f32 v[92:93], v[92:93], v[164:165]
  v_pk_add_f32 v[94:95], v[94:95], v[164:165]
  v_pk_add_f32 v[96:97], v[96:97], v[164:165]
  v_pk_add_f32 v[98:99], v[98:99], v[164:165]
  v_cvt_pk_bf16_f32 v172, v88, v89
  v_cvt_pk_bf16_f32 v173, v90, v91
  v_cvt_pk_bf16_f32 v176, v92, v93
  v_cvt_pk_bf16_f32 v177, v94, v95
  v_cvt_pk_bf16_f32 v180, v96, v97
  v_cvt_pk_bf16_f32 v181, v98, v99
  v_pk_fma_f32 v[108:109], v[216:217], v[128:129], v[108:109] op_sel_hi:[1,0,1]
  v_pk_fma_f32 v[110:111], v[218:219], v[128:129], v[110:111] op_sel_hi:[1,0,1]
  v_pk_fma_f32 v[112:113], v[216:217], v[132:133], v[112:113] op_sel_hi:[1,0,1]
  v_pk_fma_f32 v[114:115], v[218:219], v[132:133], v[114:115] op_sel_hi:[1,0,1]
  v_pk_fma_f32 v[116:117], v[216:217], v[136:137], v[116:117] op_sel_hi:[1,0,1]
  v_pk_fma_f32 v[118:119], v[218:219], v[136:137], v[118:119] op_sel_hi:[1,0,1]
  v_pk_fma_f32 v[120:121], v[216:217], v[140:141], v[120:121] op_sel_hi:[1,0,1]
  v_pk_fma_f32 v[122:123], v[218:219], v[140:141], v[122:123] op_sel_hi:[1,0,1]
  v_pk_fma_f32 v[124:125], v[216:217], v[144:145], v[124:125] op_sel_hi:[1,0,1]
  v_pk_fma_f32 v[126:127], v[218:219], v[144:145], v[126:127] op_sel_hi:[1,0,1]
  v_pk_mul_f32 v[108:109], v[108:109], v[148:149]
  v_pk_mul_f32 v[110:111], v[110:111], v[150:151]
  v_pk_mul_f32 v[112:113], v[112:113], v[148:149]
  v_pk_mul_f32 v[114:115], v[114:115], v[150:151]
  v_pk_mul_f32 v[116:117], v[116:117], v[148:149]
  v_pk_mul_f32 v[118:119], v[118:119], v[150:151]
  v_pk_mul_f32 v[120:121], v[120:121], v[148:149]
  v_pk_mul_f32 v[122:123], v[122:123], v[150:151]
  v_pk_mul_f32 v[124:125], v[124:125], v[148:149]
  v_pk_mul_f32 v[126:127], v[126:127], v[150:151]
  v_pk_mul_f32 v[152:153], v[108:109], s[30:31]
  v_pk_mul_f32 v[154:155], v[110:111], s[30:31]
  v_pk_mul_f32 v[156:157], v[112:113], s[30:31]
  v_pk_mul_f32 v[158:159], v[114:115], s[30:31]
  v_pk_mul_f32 v[160:161], v[116:117], s[30:31]
  v_pk_mul_f32 v[162:163], v[118:119], s[30:31]
  v_exp_f32_e64 v152, v152 clamp
  v_exp_f32_e64 v153, v153 clamp
  v_exp_f32_e64 v154, v154 clamp
  v_exp_f32_e64 v155, v155 clamp
  v_exp_f32_e64 v156, v156 clamp
  v_exp_f32_e64 v157, v157 clamp
  v_exp_f32_e64 v158, v158 clamp
  v_exp_f32_e64 v159, v159 clamp
  v_exp_f32_e64 v160, v160 clamp
  v_exp_f32_e64 v161, v161 clamp
  v_exp_f32_e64 v162, v162 clamp
  v_exp_f32_e64 v163, v163 clamp
  v_cvt_pk_bf16_f32 v186, v116, v117
  v_cvt_pk_bf16_f32 v187, v118, v119
  v_cvt_pk_bf16_f32 v190, v120, v121
  v_cvt_pk_bf16_f32 v191, v122, v123
  v_cvt_pk_bf16_f32 v194, v124, v125
  v_cvt_pk_bf16_f32 v195, v126, v127
  v_cndmask_b32 v186, v186, v166, s[32:33]
  v_cndmask_b32 v187, v187, v166, s[32:33]
  v_pk_add_f32 v[108:109], v[108:109], 1.0 op_sel_hi:[1,0]
  v_pk_add_f32 v[110:111], v[110:111], 1.0 op_sel_hi:[1,0]
  v_pk_add_f32 v[112:113], v[112:113], 1.0 op_sel_hi:[1,0]
  v_pk_add_f32 v[114:115], v[114:115], 1.0 op_sel_hi:[1,0]
  v_pk_add_f32 v[116:117], v[116:117], 1.0 op_sel_hi:[1,0]
  v_pk_add_f32 v[118:119], v[118:119], 1.0 op_sel_hi:[1,0]
  v_max_f32 v108, v108, v152
  v_max_f32 v109, v109, v153
  v_max_f32 v110, v110, v154
  v_max_f32 v111, v111, v155
  v_max_f32 v112, v112, v156
  v_max_f32 v113, v113, v157
  v_max_f32 v114, v114, v158
  v_max_f32 v115, v115, v159
  v_max_f32 v116, v116, v160
  v_max_f32 v117, v117, v161
  v_max_f32 v118, v118, v162
  v_max_f32 v119, v119, v163
  v_pk_add_f32 v[108:109], v[108:109], v[164:165]
  v_pk_add_f32 v[110:111], v[110:111], v[164:165]
  v_pk_add_f32 v[112:113], v[112:113], v[164:165]
  v_pk_add_f32 v[114:115], v[114:115], v[164:165]
  v_pk_add_f32 v[116:117], v[116:117], v[164:165]
  v_pk_add_f32 v[118:119], v[118:119], v[164:165]
  v_cvt_pk_bf16_f32 v174, v108, v109
  v_cvt_pk_bf16_f32 v175, v110, v111
  v_cvt_pk_bf16_f32 v178, v112, v113
  v_cvt_pk_bf16_f32 v179, v114, v115
  v_cvt_pk_bf16_f32 v182, v116, v117
  v_cvt_pk_bf16_f32 v183, v118, v119
  s_cmp_eq_u32 s36, 1
  s_cbranch_scc1 k_kvs2
  v_mfma_f32_16x16x32_bf16 v[8:11], v[172:175], v[184:187], v[8:11]
  v_mfma_f32_16x16x32_bf16 v[12:15], v[172:175], v[188:191], v[12:15]
  v_mfma_f32_16x16x32_bf16 v[16:19], v[176:179], v[184:187], v[16:19]
  v_mfma_f32_16x16x32_bf16 v[20:23], v[176:179], v[188:191], v[20:23]
  v_mfma_f32_16x16x32_bf16 v[24:27], v[176:179], v[192:195], v[24:27]
  v_mfma_f32_16x16x32_bf16 v[28:31], v[180:183], v[184:187], v[28:31]
  v_mfma_f32_16x16x32_bf16 v[32:35], v[180:183], v[188:191], v[32:35]
  v_mfma_f32_16x16x32_bf16 v[36:39], v[180:183], v[192:195], v[36:39]
k_kvs2:
  s_mul_i32 s28, s51, 1792
  s_add_u32 s37, s37, s28
  s_lshl_b32 s29, s52, 12
  s_add_u32 s28, s28, s29
  s_add_u32 s28, s28, 145408
  v_lshlrev_b32 v2, 2, v7
  v_add_u32 v3, s28, v2
  s_cmp_eq_u32 s51, 0
  s_cselect_b32 s28, 64, 8
  v_cmp_gt_u32 vcc, s28, v7
  v_mov_b32 v6, 1073741824
  ds_write_b128 v240, v[8:11]
  ds_write_b128 v241, v[12:15]
  ds_write_b128 v242, v[16:19]
  ds_write_b128 v243, v[20:23]
  ds_write_b128 v244, v[24:27]
  ds_write_b128 v245, v[28:31]
  ds_write_b128 v246, v[32:35]
  ds_write_b128 v255, v[36:39]
  v_cndmask_b32 v6, v6, v2, vcc
  s_waitcnt lgkmcnt(0)
  s_barrier
  ds_read2st64_b32 v[72:73], v3 offset0:0 offset1:32
  ds_read2st64_b32 v[74:75], v3 offset0:1 offset1:33
  ds_read2st64_b32 v[76:77], v3 offset0:2 offset1:34
  ds_read2st64_b32 v[78:79], v3 offset0:3 offset1:35
  ds_read2st64_b32 v[80:81], v3 offset0:4 offset1:36
  ds_read2st64_b32 v[82:83], v3 offset0:5 offset1:37
  ds_read2st64_b32 v[84:85], v3 offset0:6 offset1:38
  s_waitcnt lgkmcnt(6)
  v_add_f32 v72, v72, v73
  buffer_atomic_add_f32 v72, v2, s[16:19], s37 offen offset:0
  s_waitcnt lgkmcnt(5)
  v_add_f32 v74, v74, v75
  buffer_atomic_add_f32 v74, v2, s[16:19], s37 offen offset:256
  s_waitcnt lgkmcnt(4)
  v_add_f32 v76, v76, v77
  buffer_atomic_add_f32 v76, v2, s[16:19], s37 offen offset:512
  s_waitcnt lgkmcnt(3)
  v_add_f32 v78, v78, v79
  buffer_atomic_add_f32 v78, v2, s[16:19], s37 offen offset:768
  s_waitcnt lgkmcnt(2)
  v_add_f32 v80, v80, v81
  buffer_atomic_add_f32 v80, v2, s[16:19], s37 offen offset:1024
  s_waitcnt lgkmcnt(1)
  v_add_f32 v82, v82, v83
  buffer_atomic_add_f32 v82, v2, s[16:19], s37 offen offset:1280
  s_waitcnt lgkmcnt(0)
  v_add_f32 v84, v84, v85
  buffer_atomic_add_f32 v84, v6, s[16:19], s37 offen offset:1536
  s_branch k_p2
k_end:
  s_endpgm
k_race:
  s_waitcnt vmcnt(0)
  s_barrier
  v_mov_b32 v3, s39
  v_lshlrev_b32 v6, 25, v7
  buffer_store_dword v3, v6, s[16:19], s49 offen sc1
  s_cmp_lg_u32 s20, 0
  s_cbranch_scc1 k_race2
  s_cmp_eq_u32 s2, 2
  s_cbranch_scc1 k_race2
  s_mov_b32 s29, s2
  s_lshl_b32 s28, s29, 13
  s_add_u32 s28, s28, 786432
  v_lshlrev_b32 v6, 25, v7
  s_mov_b32 s56, s36
  s_and_b32 s57, s37, 0xffff
  s_mov_b32 s58, 256
  s_mov_b32 s59, 0x20000
  v_mov_b32 v3, 0
  buffer_atomic_add v3, v6, s[16:19], s28 offen sc0
  v_mov_b32 v1, 1
  s_mov_b32 s30, 12
  s_mov_b32 s31, 1
  s_waitcnt vmcnt(0)
k_race0:
  buffer_atomic_add v1, v6, s[56:59], 0 offen offset:4 sc0
  s_sub_u32 s30, s30, 1
  s_waitcnt vmcnt(0)
  v_readfirstlane_b32 s38, v1
  v_mov_b32 v1, 0
  s_and_b32 s38, s38, 1
  s_cmp_eq_u32 s38, s31
  s_cselect_b32 s30, 0, s30
  s_mov_b32 s31, 0
  s_cmp_lg_u32 s30, 0
  s_cbranch_scc1 k_race0
  s_mov_b32 s30, 8
k_race1:
  v_mov_b32 v3, 0
  buffer_atomic_add v3, v6, s[16:19], s28 offen sc0
  s_sub_u32 s30, s30, 1
  s_cmp_lg_u32 s30, 0
  s_waitcnt vmcnt(0)
  s_cbranch_scc1 k_race1
  v_mov_b32 v3, 1
  buffer_atomic_add v3, v6, s[56:59], 0 offen sc0
  s_lshl_b32 s29, s29, 13
  s_xor_b32 s29, s29, s39
  s_waitcnt vmcnt(0)
  v_readfirstlane_b32 s30, v3
  v_mov_b32 v3, s29
  s_nop 0
  s_bitcmp0_b32 s30, 0
  s_mov_b32 s28, 1073741824
  s_cselect_b32 s28, 819200, s28
  buffer_store_dword v3, v6, s[16:19], s28 offen sc1
k_race2:
  s_mov_b32 s61, 1073741824
  s_mov_b32 s62, 1073741824
  s_mov_b32 s63, 1073741824
  s_mov_b32 s75, 1073741824
  s_mov_b32 s80, 1073741824
  s_mov_b32 s81, 1073741824
  s_mov_b32 s82, 1073741824
  s_mov_b32 s83, 1073741824
  v_add_u32 v128, 90112, v247
  v_add_u32 v129, 90112, v248
  v_add_u32 v130, 90112, v249
  v_add_u32 v131, 90112, v250
  v_add_u32 v132, 90112, v251
  s_cmp_le_u32 s54, 8
  s_cselect_b32 s44, 9, 8
  s_lshl_b32 s42, s44, 7
  s_mul_i32 s43, s44, s45
  s_branch k_t_join
k_t_sa_slow:
  s_mov_b32 s38, 200000
k_t_sa_again:
  s_sleep 2
  buffer_load_dword v255, v6, s[16:19], 0 offen sc1
  s_sub_u32 s38, s38, 1
  s_cmp_eq_u32 s38, 0
  s_cbranch_scc1 k_t_sa_ok
  s_waitcnt vmcnt(0)
  v_cmp_ne_u32 vcc, s39, v255
  s_nop 1
  s_cmp_lg_u64 vcc, 0
  s_cbranch_scc1 k_t_sa_again
  s_branch k_t_sa_ok
k_t_pw:
  s_mov_b32 s40, 200000
k_t_pw1:
  s_sleep 4
  buffer_load_dword v147, v146, s[16:19], 0 offen sc1
  s_waitcnt vmcnt(0)
  v_readfirstlane_b32 s3, v147
  s_sub_u32 s40, s40, 1
  s_xor_b32 s3, s3, s39
  s_and_b32 s38, s3, 4294959103
  s_cselect_b32 s38, s40, 0
  s_and_b32 s3, s3, 8192
  s_cmp_lg_u32 s38, 0
  s_cbranch_scc1 k_t_pw1
  s_branch k_t_pwr
k_n_sa_slow:
  s_mov_b32 s38, 200000
k_n_sa_again:
  s_sleep 2
  buffer_load_dword v255, v6, s[16:19], 0 offen sc1
  s_sub_u32 s38, s38, 1
  s_cmp_eq_u32 s38, 0
  s_cbranch_scc1 k_n_sa_ok
  s_waitcnt vmcnt(0)
  v_cmp_ne_u32 vcc, s39, v255
  s_nop 1
  s_cmp_lg_u64 vcc, 0
  s_cbranch_scc1 k_n_sa_again
  s_branch k_n_sa_ok
k_n_pw:
  s_mov_b32 s40, 200000
k_n_pw1:
  s_sleep 4
  buffer_load_dword v147, v146, s[16:19], 0 offen sc1
  s_waitcnt vmcnt(0)
  v_readfirstlane_b32 s3, v147
  s_sub_u32 s40, s40, 1
  s_xor_b32 s3, s3, s39
  s_and_b32 s38, s3, 4294959103
  s_cselect_b32 s38, s40, 0
  s_and_b32 s3, s3, 8192
  s_cmp_lg_u32 s38, 0
  s_cbranch_scc1 k_n_pw1
  s_branch k_n_pwr
k_s1_slow:
  s_mov_b32 s38, 200000
k_s1_again:
  s_sleep 2
  buffer_load_dword v255, v239, s[16:19], 0 offen sc1
  s_sub_u32 s38, s38, 1
  s_cmp_eq_u32 s38, 0
  s_cbranch_scc1 k_s1_ok
  s_waitcnt vmcnt(0)
  v_cmp_ne_u32 vcc, s39, v255
  s_nop 1
  s_cmp_lg_u64 vcc, 0
  s_cbranch_scc1 k_s1_again
  s_branch k_s1_ok
k_sw_slow:
  s_mov_b32 s38, 200000
k_sw_again:
  s_sleep 2
  buffer_load_dword v255, v238, s[16:19], 0 offen sc1
  s_sub_u32 s38, s38, 1
  s_cmp_eq_u32 s38, 0
  s_cbranch_scc1 k_sw_ok
  s_waitcnt vmcnt(0)
  v_cmp_ne_u32 vcc, s39, v255
  s_nop 1
  s_cmp_lg_u64 vcc, 0
  s_cbranch_scc1 k_sw_again
  s_branch k_sw_ok
k_so_slow:
  s_mov_b32 s38, 200000
k_so_again:
  s_sleep 2
  buffer_load_dword v255, v254, s[16:19], 0 offen sc1
  s_sub_u32 s38, s38, 1
  s_cmp_eq_u32 s38, 0
  s_cbranch_scc1 k_so_ok
  s_waitcnt vmcnt(0)
  v_cmp_ne_u32 vcc, s39, v255
  s_nop 1
  s_cmp_lg_u64 vcc, 0
  s_cbranch_scc1 k_so_again
  s_branch k_so_ok
k_sx_slow:
  s_mov_b32 s38, 200000
k_sx_again:
  s_sleep 2
  buffer_load_dword v255, v254, s[16:19], 0 offen sc1
  s_sub_u32 s38, s38, 1
  s_cmp_eq_u32 s38, 0
  s_cbranch_scc1 k_sx_ok
  s_waitcnt vmcnt(0)
  v_cmp_ne_u32 vcc, s39, v255
  s_nop 1
  s_cmp_lg_u64 vcc, 0
  s_cbranch_scc1 k_sx_again
  s_branch k_sx_ok
.section .rodata,"a"
.p2align 6
.amdhsa_kernel recurrent_scan__linear_attn_block__dense_activation_silu__prompt_kernel
  .amdhsa_next_free_vgpr 512
  .amdhsa_next_free_sgpr 102
  .amdhsa_accum_offset 256
  .amdhsa_group_segment_fixed_size 0
  .amdhsa_kernarg_size 72
  .amdhsa_user_sgpr_count 2
  .amdhsa_user_sgpr_kernarg_segment_ptr 1
  .amdhsa_system_sgpr_workgroup_id_x 1
.end_amdhsa_kernel
```
